```python
import torch

def _softmax(x, axis=-1):
    return torch.softmax(x, dim=axis)
def _gelu(x):
    return torch.nn.functional.gelu(x, approximate="tanh")
def _silu(x):
    return torch.nn.functional.silu(x)
def _sigmoid(x):
    return torch.sigmoid(x)
def _layernorm(x, axis=-1, eps=1e-5):
    m = x.mean(dim=axis, keepdim=True)
    v = x.var(dim=axis, keepdim=True, unbiased=False)
    return (x - m) / torch.sqrt(v + eps)
def _scatter_add(tgt, idx, src, axis=0):
    return tgt.clone().index_add_(axis, idx, src)
def _segment_sum(src, seg, n):
    out = torch.zeros((n,) + src.shape[1:], dtype=src.dtype)
    return out.index_add_(0, seg, src)
def _pad(x, pw):
    flat = tuple(v for pair in reversed(pw) for v in pair)
    return torch.nn.functional.pad(x, flat)

kernel_name = 'parallel_sum__spectral_fnet__dense_activation_squared_relu__prompt'

def setup_inputs():

    _w = (lambda a: (lambda t: t.to(torch.bfloat16) if t.is_floating_point() else t)(torch.as_tensor(a)))
    def _A_setup():
        B, S, D = 1, 2048, 640
        ns = torch.arange(S)[:, None] * torch.arange(S)[None, :]
        nd = torch.arange(D)[:, None] * torch.arange(D)[None, :]
        Ws_re = torch.cos(-2.0 * torch.pi * ns / S).to(float)
        Ws_im = torch.sin(-2.0 * torch.pi * ns / S).to(float)
        Wd_re = torch.cos(-2.0 * torch.pi * nd / D).to(float)
        Wd_im = torch.sin(-2.0 * torch.pi * nd / D).to(float)
        return {
            "x": _w((lambda *s: torch.randn(*s, dtype=torch.bfloat16) * 0.05)(B, S, D)),
            "dft_seq_re": _w(Ws_re),
            "dft_seq_im": _w(Ws_im),
            "dft_hid_re": _w(Wd_re),
            "dft_hid_im": _w(Wd_im),
        }
    _A_in = _A_setup()

    def _B_setup():
        B, S, D, F = 1, 2048, 640, 1728
        return {
            "x": _w((lambda *s: torch.randn(*s, dtype=torch.bfloat16) * 0.05)(B, S, D)),
            "w1": _w((lambda *s: torch.randn(*s, dtype=torch.bfloat16) * 0.2)(D, F)),
            "b1": _w((lambda *s: torch.randn(*s, dtype=torch.bfloat16) * 0.2)(F)),
            "w2": _w((lambda *s: torch.randn(*s, dtype=torch.bfloat16) * 0.2)(F, D)),
            "b2": _w((lambda *s: torch.randn(*s, dtype=torch.bfloat16) * 0.2)(D)),
        }
    _B_in = _B_setup()

    return {
        "A_x": _A_in["x"],
        "A_dft_seq_re": _A_in["dft_seq_re"],
        "A_dft_seq_im": _A_in["dft_seq_im"],
        "A_dft_hid_re": _A_in["dft_hid_re"],
        "A_dft_hid_im": _A_in["dft_hid_im"],
        "B_x": _B_in["x"],
        "B_w1": _B_in["w1"],
        "B_b1": _B_in["b1"],
        "B_w2": _B_in["w2"],
        "B_b2": _B_in["b2"],
    }

def reference(A_x, A_dft_seq_re, A_dft_seq_im, A_dft_hid_re, A_dft_hid_im, B_x, B_w1, B_b1, B_w2, B_b2):
    def _A_ref(x, dft_seq_re, dft_seq_im, dft_hid_re, dft_hid_im):
        a = torch.einsum("bsd,ed->bse", x, dft_hid_re)
        b = torch.einsum("bsd,ed->bse", x, dft_hid_im)
        y = torch.einsum("ts,bse->bte", dft_seq_re, a) - torch.einsum("ts,bse->bte", dft_seq_im, b)
        return y

    def _B_ref(x, w1, b1, w2, b2):
        h = torch.einsum("bsd,df->bsf", x, w1) + b1
        zero = torch.zeros_like(h)
        r = torch.where(h > zero, h, zero)
        h = r * r
        out = torch.einsum("bsf,fd->bsd", h, w2) + b2
        return out

    x = A_x
    xn = _layernorm(x, axis=-1)
    return x + _A_ref(xn, A_dft_seq_re, A_dft_seq_im, A_dft_hid_re, A_dft_hid_im) + _B_ref(xn, B_w1, B_b1, B_w2, B_b2)
```

```asm
; @launch grid=(256,1,1) block=(256,1,1) lds=163840
.amdgcn_target "amdgcn-amd-amdhsa--gfx950"
.text
.globl parallel_sum__spectral_fnet__dense_activation_squared_relu__prompt_kernel
.p2align 8
.type parallel_sum__spectral_fnet__dense_activation_squared_relu__prompt_kernel,@function
parallel_sum__spectral_fnet__dense_activation_squared_relu__prompt_kernel:
    s_cmp_ge_u32 s2, 256
    s_cbranch_scc1 L_end
    s_load_dwordx2 s[66:67], s[0:1], 0
    s_load_dwordx8 s[68:75], s[0:1], 48
    s_load_dwordx4 s[76:79], s[0:1], 80
    s_load_dwordx2 s[80:81], s[0:1], 96
    s_getpc_b64 s[82:83]
L_pc:
    s_bfe_u32 s3, s2, 0x40003
    s_lshl_b32 s3, s3, 5
    v_lshrrev_b32 v3, 6, v0
    v_lshl_add_u32 v3, v3, 3, s3
    v_and_b32 v2, 63, v0
    v_add_lshl_u32 v2, v2, v3, 7
    s_mov_b64 exec, 0xff
    global_load_dword v29, v2, s[82:83]
    s_mov_b64 exec, -1
    s_add_u32 s82, s82, L_ftab-L_pc
    s_addc_u32 s83, s83, 0
    v_lshrrev_b32 v4, 6, v0
    v_and_b32 v1, 63, v0
    v_readfirstlane_b32 s30, v4
    s_bfe_u32 s31, s2, 0x10004
    s_and_b32 s45, s2, 7
    s_bfe_u32 s46, s2, 0x10003
    s_lshl_b32 s45, s45, 1
    s_add_u32 s32, s45, s46
    s_lshr_b32 s33, s2, 5
    s_sub_u32 s47, 32, s32
    s_cmp_eq_u32 s32, 0
    s_cselect_b32 s47, 16, s47
    s_bitcmp1_b32 s30, 1
    s_cselect_b32 s34, s47, s32
    s_and_b32 s48, s30, 1
    s_lshl_b32 s48, s48, 5
    s_add_u32 s34, s34, s48
    s_mov_b32 s3, s47
    v_lshrrev_b32 v16, 3, v1
    v_lshrrev_b32 v17, 4, v1
    v_and_b32 v18, 7, v1
    v_xor_b32 v19, v18, v17
    s_mov_b32 s49, 81920
    v_mul_lo_u32 v20, s49, v16
    v_lshl_add_u32 v2, v19, 4, v20
    v_xor_b32 v19, 4, v19
    v_lshl_add_u32 v3, v19, 4, v20
    v_add_u32 v3, 654336, v3
    s_mul_i32 s36, s34, 1280
    s_add_u32 s37, s36, 1308672
    s_lshl_b32 s39, s30, 12
    s_waitcnt lgkmcnt(0)
    s_mov_b32 s4, s66
    s_and_b32 s5, s67, 0xffff
    s_mov_b32 s6, 2621440
    s_mov_b32 s7, 0x20000
    s_add_u32 m0, s39, 0
    s_nop 0
    buffer_load_dwordx4 v2, s[4:7], s36 offen  lds
    buffer_load_dwordx4 v3, s[4:7], s36 offen offset:1024  lds
    buffer_load_dwordx4 v2, s[4:7], s37 offen offset:2048  lds
    buffer_load_dwordx4 v3, s[4:7], s37 offen offset:3072  lds
    s_sub_u32 s50, 6, s31
    s_cmp_ge_u32 s33, s50
    s_cbranch_scc1 L_S
    s_mul_i32 s35, s31, 28
    s_lshl_b32 s45, s33, 2
    s_add_u32 s35, s35, s45
    v_and_b32 v18, 15, v1
    v_lshlrev_b32 v19, 2, v17
    v_xor_b32 v18, v18, v19
    s_movk_i32 s51, 3456
    v_mul_u32_u24 v19, s51, v17
    v_lshl_add_u32 v4, v18, 4, v19
    v_add_u32 v5, 12800, v4
    v_add_u32 v6, 25600, v4
    v_add_u32 v7, 38400, v4
    s_lshl_b32 s38, s35, 6
    s_mul_i32 s45, s30, 55296
    s_add_u32 s38, s38, s45
    s_mul_i32 s40, s30, 4096
    s_add_u32 s40, s40, 65536
    s_lshl_b32 s46, s35, 6
    v_and_b32 v22, 63, v1
    v_lshl_add_u32 v22, v22, 2, s46
    v_mov_b32 v190, 1073741824
    v_and_b32 v191, 3, v1
    v_lshrrev_b32 v189, 2, v1
    s_mul_i32 s51, s31, 6
    s_add_u32 s51, s51, s33
    s_mul_i32 s51, s51, 3
    s_mul_i32 s63, s31, 12
    s_add_u32 s63, s63, s33
    s_add_u32 s63, s63, 12
    s_lshl_b32 s63, s63, 7
    s_add_u32 s51, s31, 2
    s_cmp_lt_u32 s33, s51
    s_cselect_b32 s63, s63, 1073741824
    v_mov_b32 v188, s63
    s_lshl_b32 s51, s35, 6
    v_lshl_add_u32 v194, v191, 7, s51
    v_cmp_eq_u32 vcc, 2, v191
    s_nop 1
    v_cndmask_b32 v194, v194, v188, vcc
    v_cmp_eq_u32 vcc, 3, v191
    s_nop 1
    v_cndmask_b32 v194, v194, v190, vcc
    s_lshl_b32 s51, s32, 2
    s_add_u32 s51, s51, s30
    v_lshl_add_u32 v188, v189, 6, s51
    v_mul_u32_u24 v188, 0xd80, v188
    v_add_u32 v194, v194, v188
    v_cmp_gt_u32 vcc, 36, v1
    s_nop 1
    v_cndmask_b32 v194, v190, v194, vcc
    s_mov_b32 s63, 0
    s_waitcnt lgkmcnt(0)
    global_load_dword v23, v22, s[70:71]
    v_bfe_u32 v21, v1, 0, 3
    v_mul_u32_u24 v21, 0xa0, v21
    global_load_dword v29, v21, s[74:75]
    s_mov_b32 s8, s68
    s_and_b32 s9, s69, 0xffff
    s_mov_b32 s10, 2211840
    s_mov_b32 s11, 0x20000
    s_add_u32 s63, s63, 221184
    buffer_load_dword v29, v194, s[8:11], s63 offen
    s_add_u32 m0, s40, 0
    s_add_u32 s36, s36, 128
    s_add_u32 s37, s37, 128
    buffer_load_dwordx4 v4, s[8:11], s38 offen offset:0  lds
    buffer_load_dwordx4 v5, s[8:11], s38 offen offset:1024  lds
    buffer_load_dwordx4 v6, s[8:11], s38 offen offset:2048  lds
    buffer_load_dwordx4 v7, s[8:11], s38 offen offset:3072  lds
    s_add_u32 s38, s38, 221184
    s_mul_i32 s45, s31, 6
    s_add_u32 s45, s45, s33
    s_lshl_b32 s45, s45, 2
    s_add_u32 s45, s45, s30
    s_sub_u32 s45, s45, 12
    s_cmp_lt_u32 s45, 32
    s_cselect_b32 s49, 0, 1073741824
    s_cselect_b32 s45, s45, 0
    s_bitcmp1_b32 s45, 4
    s_cselect_b32 s47, s3, s32
    s_bfe_u32 s48, s45, 0x10003
    s_lshl_b32 s48, s48, 5
    s_add_u32 s47, s47, s48
    s_and_b32 s48, s45, 7
    s_lshl_b32 s48, s48, 8
    s_add_u32 s47, s47, s48
    s_mul_i32 s60, s47, 1280
    s_lshl_b32 s47, s32, 5
    s_add_u32 s47, s47, s45
    s_lshl_b32 s65, s47, 6
    s_add_u32 s65, s65, 11911168
    v_lshrrev_b32 v184, 4, v1
    s_mov_b32 s50, 81920
    v_mul_lo_u32 v185, s50, v184
    v_and_b32 v186, 15, v1
    v_lshlrev_b32 v186, 4, v186
    v_add3_u32 v135, v186, v185, s49
    v_lshl_add_u32 v136, v184, 4, s49
    buffer_load_dwordx4 v[160:163], v135, s[4:7], s60 offen offset:0
    buffer_load_dwordx4 v[164:167], v135, s[4:7], s60 offen offset:256
    buffer_load_dwordx4 v[168:171], v135, s[4:7], s60 offen offset:512
    buffer_load_dwordx4 v[172:175], v135, s[4:7], s60 offen offset:768
    buffer_load_dwordx4 v[176:179], v135, s[4:7], s60 offen offset:1024
    s_mov_b32 s12, s72
    s_and_b32 s13, s73, 0xffff
    s_mov_b32 s14, 2211840
    s_mov_b32 s15, 0x20000
    s_mov_b32 s16, s80
    s_and_b32 s17, s81, 0xffff
    s_mov_b32 s18, 12386304
    s_mov_b32 s19, 0x20000
    s_mov_b32 s20, s76
    s_and_b32 s21, s77, 0xffff
    s_mov_b32 s22, 2621440
    s_mov_b32 s23, 0x20000
    s_mov_b64 s[24:25], s[70:71]
    s_mov_b64 s[26:27], s[74:75]
    s_mov_b64 s[28:29], s[78:79]
    s_or_b32 s45, s2, s30
    s_cmp_lg_u32 s45, 0
    s_cbranch_scc1 L_non1
    s_memrealtime s[46:47]
    s_waitcnt lgkmcnt(0)
    s_or_b32 s45, s46, 1
    v_mov_b32 v16, 0
    v_mov_b32 v17, s45
    global_store_dword v16, v17, s[28:29] sc1
L_non1:
    v_lshl_add_u32 v16, v1, 2, s30
    v_lshlrev_b32 v16, 21, v16
    s_mov_b64 exec, 0x3
    buffer_load_dword v29, v16, s[16:19], 0 offen sc1
    s_mov_b64 exec, 3
    buffer_load_dword v29, v16, s[20:23], 0 offen sc1
    s_mov_b64 exec, -1
    s_mov_b32 s44, 0x3f803f80
    s_sub_u32 s47, 32, s32
    s_cmp_eq_u32 s32, 0
    s_cselect_b32 s47, 16, s47
    s_cmp_eq_u32 s31, 1
    s_cselect_b32 s41, s47, s32
    s_mov_b32 s42, s33
    s_mul_i32 s61, s30, 14
    s_cmp_eq_u32 s30, 3
    s_cselect_b32 s61, 41, s61
    v_and_b32 v16, 31, v1
    v_lshrrev_b32 v17, 5, v1
    v_bfe_u32 v18, v1, 1, 3
    v_xor_b32 v18, v18, v17
    v_lshlrev_b32 v19, 7, v16
    v_add_u32 v19, s39, v19
    v_lshl_add_u32 v8, v18, 4, v19
    v_xor_b32 v9, 32, v8
    v_xor_b32 v10, 64, v8
    v_xor_b32 v11, 96, v8
    v_bfe_u32 v20, v1, 2, 2
    v_lshl_add_u32 v18, v17, 3, v20
    v_mul_u32_u24 v18, 256, v18
    v_bfe_u32 v19, v1, 4, 1
    v_lshl_add_u32 v18, v19, 5, v18
    v_and_b32 v19, 3, v1
    v_lshl_add_u32 v18, v19, 3, v18
    v_add_u32 v18, 65536, v18
    s_add_u32 s45, s30, 0
    s_and_b32 s45, s45, 3
    v_xor_b32 v19, s45, v20
    v_lshl_add_u32 v12, v19, 6, v18
    s_mul_i32 s53, s34, 54
    s_add_u32 s53, s53, s35
    s_add_u32 s53, s53, s45
    s_lshl_b32 s53, s53, 11
    s_add_u32 s45, s30, 1
    s_and_b32 s45, s45, 3
    v_xor_b32 v19, s45, v20
    v_lshl_add_u32 v13, v19, 6, v18
    s_mul_i32 s54, s34, 54
    s_add_u32 s54, s54, s35
    s_add_u32 s54, s54, s45
    s_lshl_b32 s54, s54, 11
    s_add_u32 s45, s30, 2
    s_and_b32 s45, s45, 3
    v_xor_b32 v19, s45, v20
    v_lshl_add_u32 v14, v19, 6, v18
    s_mul_i32 s55, s34, 54
    s_add_u32 s55, s55, s35
    s_add_u32 s55, s55, s45
    s_lshl_b32 s55, s55, 11
    s_add_u32 s45, s30, 3
    s_and_b32 s45, s45, 3
    v_xor_b32 v19, s45, v20
    v_lshl_add_u32 v15, v19, 6, v18
    s_mul_i32 s56, s34, 54
    s_add_u32 s56, s56, s35
    s_add_u32 s56, s56, s45
    s_lshl_b32 s56, s56, 11
    s_lshl_b32 s57, s2, 2
    s_add_u32 s57, s57, s30
    s_lshl_b32 s57, s57, 7
    s_add_u32 s57, s57, 11960320
    v_and_b32 v16, 15, v1
    v_bfe_u32 v17, v1, 4, 1
    v_mov_b32 v18, s44
    v_cmp_eq_u32 vcc, v16, v17
    s_nop 1
    v_cndmask_b32 v18, 0, v18, vcc
    v_accvgpr_write_b32 a192, v18
    v_accvgpr_write_b32 a193, v18
    v_accvgpr_write_b32 a194, v18
    v_accvgpr_write_b32 a195, v18
    v_lshlrev_b32 v31, 4, v1
    v_lshlrev_b32 v30, 10, v17
    v_lshrrev_b32 v17, 5, v1
    v_lshl_add_u32 v30, v17, 8, v30
    v_lshl_add_u32 v30, v16, 4, v30
    s_mul_i32 s45, s31, 6
    s_add_u32 s45, s45, s33
    s_lshl_b32 s45, s45, 2
    s_add_u32 s45, s45, s30
    s_mul_i32 s46, s32, 27
    s_add_u32 s46, s46, s45
    s_lshr_b32 s47, s46, 3
    s_and_b32 s48, s46, 7
    s_mul_i32 s58, s47, 40960
    s_mul_i32 s50, s48, 160
    s_add_u32 s58, s58, s50
    s_mul_i32 s62, s48, 54
    s_add_u32 s62, s62, s47
    s_mul_i32 s62, s62, 5120
    s_add_u32 s62, s62, 9699328
    s_lshl_b32 s64, s46, 7
    s_add_u32 s64, s64, 12189696
    s_cmp_lt_u32 s45, 27
    s_cselect_b32 s49, 0, 1073741824
    s_cselect_b32 s58, s58, 0
    v_add_u32 v184, 0, v1
    v_mul_u32_u24 v185, 0x667, v184
    v_lshrrev_b32 v185, 14, v185
    v_mul_u32_u24 v185, 0x460, v185
    v_lshl_add_u32 v137, v1, 4, s49
    s_add_u32 m0, s39, 16384
    v_add_u32 v128, v137, v185
    v_add_u32 v184, 64, v1
    v_mul_u32_u24 v185, 0x667, v184
    v_lshrrev_b32 v185, 14, v185
    v_mul_u32_u24 v185, 0x460, v185
    v_add_u32 v129, v137, v185
    v_add_u32 v184, 128, v1
    v_mul_u32_u24 v185, 0x667, v184
    buffer_load_dwordx4 v2, s[4:7], s36 offen  lds
    v_lshrrev_b32 v185, 14, v185
    v_mul_u32_u24 v185, 0x460, v185
    v_add_u32 v130, v137, v185
    v_add_u32 v184, 192, v1
    v_mul_u32_u24 v185, 0x667, v184
    v_lshrrev_b32 v185, 14, v185
    v_mul_u32_u24 v185, 0x460, v185
    v_add_u32 v131, v137, v185
    buffer_load_dwordx4 v3, s[4:7], s36 offen offset:1024  lds
    v_add_u32 v184, 256, v1
    v_mul_u32_u24 v185, 0x667, v184
    v_lshrrev_b32 v185, 14, v185
    v_mul_u32_u24 v185, 0x460, v185
    v_add_u32 v132, v137, v185
    v_add_u32 v132, 0x1000, v132
    s_mul_i32 s3, s30, 5120
    s_add_u32 s3, s3, 131072
    buffer_load_dwordx4 v2, s[4:7], s37 offen offset:2048  lds
    v_lshrrev_b32 v184, 5, v1
    v_lshlrev_b32 v184, 4, v184
    v_bfe_u32 v185, v1, 4, 1
    v_lshl_add_u32 v184, v185, 2, v184
    v_bfe_u32 v185, v1, 2, 2
    v_add_u32 v184, v184, v185
    v_mul_u32_u24 v184, 160, v184
    v_add_u32 v184, s3, v184
    buffer_load_dwordx4 v3, s[4:7], s37 offen offset:3072  lds
    v_and_b32 v185, 3, v1
    v_lshl_add_u32 v133, v185, 4, v184
    v_lshl_add_u32 v134, v185, 3, v184
    s_add_u32 s45, s30, 1
    s_and_b32 s46, s45, 1
    s_bfe_u32 s45, s45, 0x10001
    s_lshl_b32 s45, s45, 5
    s_add_u32 s45, s45, s41
    s_add_u32 m0, s40, 16384
    s_add_u32 s36, s36, 128
    s_add_u32 s37, s37, 128
    s_lshl_b32 s46, s46, 10
    s_add_u32 s78, s45, s46
    s_add_u32 s45, s30, 2
    s_and_b32 s46, s45, 1
    s_bfe_u32 s45, s45, 0x10001
    s_lshl_b32 s45, s45, 5
    s_add_u32 s45, s45, s41
    s_lshl_b32 s46, s46, 10
    buffer_load_dwordx4 v4, s[8:11], s38 offen offset:0  lds
    s_add_u32 s79, s45, s46
    s_add_u32 s45, s30, 3
    s_and_b32 s46, s45, 1
    s_bfe_u32 s45, s45, 0x10001
    s_lshl_b32 s45, s45, 5
    s_add_u32 s45, s45, s41
    s_lshl_b32 s46, s46, 10
    s_add_u32 s80, s45, s46
    buffer_load_dwordx4 v5, s[8:11], s38 offen offset:1024  lds
    s_add_u32 s45, s30, 4
    s_and_b32 s46, s45, 1
    s_bfe_u32 s45, s45, 0x10001
    s_lshl_b32 s45, s45, 5
    s_add_u32 s45, s45, s41
    s_lshl_b32 s46, s46, 10
    s_add_u32 s81, s45, s46
    s_lshl_b32 s45, s32, 2
    buffer_load_dwordx4 v6, s[8:11], s38 offen offset:2048  lds
    s_add_u32 s45, s45, s30
    s_lshl_b32 s45, s45, 9
    s_add_u32 s45, s45, 11911168
    v_and_b32 v19, 31, v1
    v_lshl_add_u32 v19, v19, 4, s45
    v_add_u32 v20, s61, v1
    v_min_u32 v20, 53, v20
    s_lshl_b32 s45, s42, 7
    buffer_load_dwordx4 v7, s[8:11], s38 offen offset:3072  lds
    s_add_u32 s45, s45, 12189696
    v_lshlrev_b32 v20, 10, v20
    v_add_u32 v20, s45, v20
    s_mul_i32 s70, s42, 54
    s_add_u32 s70, s70, s61
    s_mul_i32 s70, s70, 5120
    s_add_u32 s70, s70, 9699328
    s_cmp_ge_u32 s30, 2
    s_cselect_b32 s45, 1073741824, 0
    v_add_u32 v192, s45, v31
    s_add_u32 s38, s38, 221184
    v_mov_b32 v28, 0
    global_load_dword v28, v28, s[28:29] sc1
    s_waitcnt vmcnt(16)
    s_barrier
    ds_read_b128 a[0:3], v8 offset:0
    ds_read_b64_tr_b16 v[96:97], v12 offset:0
    ds_read_b64_tr_b16 v[98:99], v12 offset:1024
    ds_read_b64_tr_b16 v[100:101], v13 offset:0
    ds_read_b64_tr_b16 v[102:103], v13 offset:1024
    ds_read_b64_tr_b16 v[104:105], v14 offset:0
    ds_read_b64_tr_b16 v[106:107], v14 offset:1024
    ds_read_b64_tr_b16 v[108:109], v15 offset:0
    ds_read_b64_tr_b16 v[110:111], v15 offset:1024
    ds_read_b128 a[4:7], v9 offset:0
    ds_read_b128 a[8:11], v10 offset:0
    ds_read_b128 a[12:15], v11 offset:0
    s_waitcnt lgkmcnt(7)
    v_mfma_f32_32x32x16_bf16 v[32:47], v[96:99], a[0:3], 0
    v_mfma_f32_16x16x32_bf16 a[196:199], a[192:195], v[96:99], 0
    ds_read_b64_tr_b16 v[112:113], v12 offset:4096
    ds_read_b64_tr_b16 v[114:115], v12 offset:5120
    ds_read_b64_tr_b16 v[116:117], v13 offset:4096
    s_add_u32 m0, s39, 32768
    s_nop 0
    buffer_load_dwordx4 v2, s[4:7], s36 offen  lds
    v_mfma_f32_32x32x16_bf16 v[48:63], v[100:103], a[0:3], 0
    ds_read_b64_tr_b16 v[118:119], v13 offset:5120
    ds_read_b64_tr_b16 v[120:121], v14 offset:4096
    ds_read_b64_tr_b16 v[122:123], v14 offset:5120
    ds_read_b64_tr_b16 v[124:125], v15 offset:4096
    s_waitcnt lgkmcnt(10)
    v_mfma_f32_32x32x16_bf16 v[64:79], v[104:107], a[0:3], 0
    ds_read_b64_tr_b16 v[126:127], v15 offset:5120
    buffer_load_dwordx4 v3, s[4:7], s36 offen offset:1024  lds
    v_mfma_f32_32x32x16_bf16 v[80:95], v[108:111], a[0:3], 0
    buffer_load_dwordx4 v2, s[4:7], s37 offen offset:2048  lds
    s_waitcnt lgkmcnt(4)
    v_mfma_f32_32x32x16_bf16 v[32:47], v[112:115], a[4:7], v[32:47]
    v_mfma_f32_16x16x32_bf16 a[196:199], a[192:195], v[112:115], a[196:199]
    ds_read_b64_tr_b16 v[96:97], v12 offset:8192
    ds_read_b64_tr_b16 v[98:99], v12 offset:9216
    ds_read_b64_tr_b16 v[100:101], v13 offset:8192
    buffer_load_dwordx4 v3, s[4:7], s37 offen offset:3072  lds
    v_mfma_f32_32x32x16_bf16 v[48:63], v[116:119], a[4:7], v[48:63]
    ds_read_b64_tr_b16 v[102:103], v13 offset:9216
    ds_read_b64_tr_b16 v[104:105], v14 offset:8192
    ds_read_b64_tr_b16 v[106:107], v14 offset:9216
    ds_read_b64_tr_b16 v[108:109], v15 offset:8192
    s_add_u32 m0, s40, 32768
    s_add_u32 s36, s36, 128
    s_add_u32 s37, s37, 128
    s_waitcnt lgkmcnt(7)
    v_mfma_f32_32x32x16_bf16 v[64:79], v[120:123], a[4:7], v[64:79]
    ds_read_b64_tr_b16 v[110:111], v15 offset:9216
    buffer_load_dwordx4 v4, s[8:11], s38 offen offset:0  lds
    v_mfma_f32_32x32x16_bf16 v[80:95], v[124:127], a[4:7], v[80:95]
    buffer_load_dwordx4 v5, s[8:11], s38 offen offset:1024  lds
    s_waitcnt vmcnt(17)
    s_mov_b32 s45, 0xbf803f80
    v_mov_b32 v180, 0
    v_mov_b32 v181, 0
    v_mov_b32 v182, 0
    v_dot2c_f32_bf16 v180, s44, v160
    v_dot2c_f32_bf16 v181, v160, v160
    v_dot2c_f32_bf16 v182, s45, v160
    v_dot2c_f32_bf16 v180, s44, v161
    v_dot2c_f32_bf16 v181, v161, v161
    v_dot2c_f32_bf16 v182, s45, v161
    v_dot2c_f32_bf16 v180, s44, v162
    v_dot2c_f32_bf16 v181, v162, v162
    v_dot2c_f32_bf16 v182, s45, v162
    v_dot2c_f32_bf16 v180, s44, v163
    v_dot2c_f32_bf16 v181, v163, v163
    v_dot2c_f32_bf16 v182, s45, v163
    v_dot2c_f32_bf16 v180, s44, v164
    v_dot2c_f32_bf16 v181, v164, v164
    v_dot2c_f32_bf16 v182, s45, v164
    v_dot2c_f32_bf16 v180, s44, v165
    v_dot2c_f32_bf16 v181, v165, v165
    v_dot2c_f32_bf16 v182, s45, v165
    v_dot2c_f32_bf16 v180, s44, v166
    v_dot2c_f32_bf16 v181, v166, v166
    v_dot2c_f32_bf16 v182, s45, v166
    v_dot2c_f32_bf16 v180, s44, v167
    v_dot2c_f32_bf16 v181, v167, v167
    v_dot2c_f32_bf16 v182, s45, v167
    v_dot2c_f32_bf16 v180, s44, v168
    v_dot2c_f32_bf16 v181, v168, v168
    v_dot2c_f32_bf16 v182, s45, v168
    v_dot2c_f32_bf16 v180, s44, v169
    v_dot2c_f32_bf16 v181, v169, v169
    v_dot2c_f32_bf16 v182, s45, v169
    v_dot2c_f32_bf16 v180, s44, v170
    v_dot2c_f32_bf16 v181, v170, v170
    v_dot2c_f32_bf16 v182, s45, v170
    v_dot2c_f32_bf16 v180, s44, v171
    v_dot2c_f32_bf16 v181, v171, v171
    v_dot2c_f32_bf16 v182, s45, v171
    v_dot2c_f32_bf16 v180, s44, v172
    v_dot2c_f32_bf16 v181, v172, v172
    v_dot2c_f32_bf16 v182, s45, v172
    v_dot2c_f32_bf16 v180, s44, v173
    v_dot2c_f32_bf16 v181, v173, v173
    v_dot2c_f32_bf16 v182, s45, v173
    v_dot2c_f32_bf16 v180, s44, v174
    v_dot2c_f32_bf16 v181, v174, v174
    v_dot2c_f32_bf16 v182, s45, v174
    v_dot2c_f32_bf16 v180, s44, v175
    v_dot2c_f32_bf16 v181, v175, v175
    v_dot2c_f32_bf16 v182, s45, v175
    v_dot2c_f32_bf16 v180, s44, v176
    v_dot2c_f32_bf16 v181, v176, v176
    v_dot2c_f32_bf16 v182, s45, v176
    v_dot2c_f32_bf16 v180, s44, v177
    v_dot2c_f32_bf16 v181, v177, v177
    v_dot2c_f32_bf16 v182, s45, v177
    v_dot2c_f32_bf16 v180, s44, v178
    v_dot2c_f32_bf16 v181, v178, v178
    v_dot2c_f32_bf16 v182, s45, v178
    v_dot2c_f32_bf16 v180, s44, v179
    v_dot2c_f32_bf16 v181, v179, v179
    v_dot2c_f32_bf16 v182, s45, v179
    s_waitcnt lgkmcnt(4)
    v_mfma_f32_32x32x16_bf16 v[32:47], v[96:99], a[8:11], v[32:47]
    v_mfma_f32_16x16x32_bf16 a[196:199], a[192:195], v[96:99], a[196:199]
    ds_read_b64_tr_b16 v[112:113], v12 offset:12288
    ds_read_b64_tr_b16 v[114:115], v12 offset:13312
    ds_read_b64_tr_b16 v[116:117], v13 offset:12288
    buffer_load_dwordx4 v6, s[8:11], s38 offen offset:2048  lds
    v_add_f32_dpp v180, v180, v180 row_ror:8 row_mask:0xf bank_mask:0xf
    v_add_f32_dpp v181, v181, v181 row_ror:8 row_mask:0xf bank_mask:0xf
    v_add_f32_dpp v182, v182, v182 row_ror:8 row_mask:0xf bank_mask:0xf
    v_mfma_f32_32x32x16_bf16 v[48:63], v[100:103], a[8:11], v[48:63]
    ds_read_b64_tr_b16 v[118:119], v13 offset:13312
    ds_read_b64_tr_b16 v[120:121], v14 offset:12288
    ds_read_b64_tr_b16 v[122:123], v14 offset:13312
    ds_read_b64_tr_b16 v[124:125], v15 offset:12288
    v_add_f32_dpp v180, v180, v180 row_ror:4 row_mask:0xf bank_mask:0xf
    v_add_f32_dpp v181, v181, v181 row_ror:4 row_mask:0xf bank_mask:0xf
    v_add_f32_dpp v182, v182, v182 row_ror:4 row_mask:0xf bank_mask:0xf
    s_waitcnt lgkmcnt(7)
    v_mfma_f32_32x32x16_bf16 v[64:79], v[104:107], a[8:11], v[64:79]
    ds_read_b64_tr_b16 v[126:127], v15 offset:13312
    buffer_load_dwordx4 v7, s[8:11], s38 offen offset:3072  lds
    s_add_u32 s38, s38, 221184
    s_add_u32 m0, s3, 0
    s_nop 0
    buffer_load_dwordx4 v128, s[12:15], s58 offen offset:0  lds
    buffer_load_dwordx4 v129, s[12:15], s58 offen offset:1024  lds
    buffer_load_dwordx4 v130, s[12:15], s58 offen offset:2048  lds
    buffer_load_dwordx4 v131, s[12:15], s58 offen offset:3072  lds
    s_add_u32 m0, s3, 4096
    s_nop 0
    buffer_load_dwordx4 v132, s[12:15], s58 offen offset:0  lds
    s_add_u32 m0, s39, 49152
    v_add_f32_dpp v180, v180, v180 row_ror:2 row_mask:0xf bank_mask:0xf
    v_add_f32_dpp v181, v181, v181 row_ror:2 row_mask:0xf bank_mask:0xf
    v_mfma_f32_32x32x16_bf16 v[80:95], v[108:111], a[8:11], v[80:95]
    buffer_load_dwordx4 v2, s[4:7], s36 offen  lds
    v_add_f32_dpp v182, v182, v182 row_ror:2 row_mask:0xf bank_mask:0xf
    v_add_f32_dpp v180, v180, v180 row_ror:1 row_mask:0xf bank_mask:0xf
    v_add_f32_dpp v181, v181, v181 row_ror:1 row_mask:0xf bank_mask:0xf
    s_waitcnt vmcnt(15)
    s_barrier
    s_waitcnt lgkmcnt(4)
    v_mfma_f32_32x32x16_bf16 v[32:47], v[112:115], a[12:15], v[32:47]
    v_mfma_f32_16x16x32_bf16 a[196:199], a[192:195], v[112:115], a[196:199]
    ds_read_b128 a[16:19], v8 offset:16384
    ds_read_b64_tr_b16 v[96:97], v12 offset:16384
    ds_read_b64_tr_b16 v[98:99], v12 offset:17408
    ds_read_b64_tr_b16 v[100:101], v13 offset:16384
    buffer_load_dwordx4 v3, s[4:7], s36 offen offset:1024  lds
    v_lshlrev_b32 v16, 16, v23
    v_and_b32 v17, 0xffff0000, v23
    v_add_f32_dpp v182, v182, v182 row_ror:1 row_mask:0xf bank_mask:0xf
    v_mul_f32 v180, 0x3acccccd, v180
    v_mul_f32 v181, 0x3acccccd, v181
    v_mfma_f32_32x32x16_bf16 v[48:63], v[116:119], a[12:15], v[48:63]
    ds_read_b64_tr_b16 v[102:103], v13 offset:17408
    ds_read_b64_tr_b16 v[104:105], v14 offset:16384
    ds_read_b64_tr_b16 v[106:107], v14 offset:17408
    v_lshlrev_b32 v18, 3, v1
    v_fma_f32 v181, -v180, v180, v181
    v_max_f32 v181, 0, v181
    s_waitcnt lgkmcnt(7)
    v_mfma_f32_32x32x16_bf16 v[64:79], v[120:123], a[12:15], v[64:79]
    ds_read_b64_tr_b16 v[108:109], v15 offset:16384
    ds_read_b64_tr_b16 v[110:111], v15 offset:17408
    buffer_load_dwordx4 v2, s[4:7], s37 offen offset:2048  lds
    v_add_u32 v18, 162304, v18
    v_add_f32 v181, 0x3727c5ac, v181
    v_rsq_f32 v183, v181
    v_sqrt_f32 v187, v181
    v_mfma_f32_32x32x16_bf16 v[80:95], v[124:127], a[12:15], v[80:95]
    ds_read_b128 a[20:23], v9 offset:16384
    buffer_load_dwordx4 v3, s[4:7], s37 offen offset:3072  lds
    s_add_u32 m0, s40, 49152
    s_add_u32 s36, s36, 128
    s_add_u32 s37, s37, 128
    ds_write_b64 v18, v[16:17]
    v_sub_f32 v186, 0, v180
    v_mul_f32 v188, v182, v183
    s_waitcnt lgkmcnt(6)
    v_mfma_f32_32x32x16_bf16 v[32:47], v[96:99], a[16:19], v[32:47]
    v_mfma_f32_16x16x32_bf16 a[196:199], a[192:195], v[96:99], a[196:199]
    ds_read_b64_tr_b16 v[112:113], v12 offset:20480
    ds_read_b64_tr_b16 v[114:115], v12 offset:21504
    ds_read_b64_tr_b16 v[116:117], v13 offset:20480
    buffer_load_dwordx4 v4, s[8:11], s38 offen offset:0  lds
    v_mfma_f32_32x32x16_bf16 v[48:63], v[100:103], a[16:19], v[48:63]
    ds_read_b64_tr_b16 v[118:119], v13 offset:21504
    ds_read_b64_tr_b16 v[120:121], v14 offset:20480
    ds_read_b64_tr_b16 v[122:123], v14 offset:21504
    ds_read_b64_tr_b16 v[124:125], v15 offset:20480
    s_waitcnt lgkmcnt(9)
    v_mfma_f32_32x32x16_bf16 v[64:79], v[104:107], a[16:19], v[64:79]
    ds_read_b64_tr_b16 v[126:127], v15 offset:21504
    buffer_load_dwordx4 v5, s[8:11], s38 offen offset:1024  lds
    v_mfma_f32_32x32x16_bf16 v[80:95], v[108:111], a[16:19], v[80:95]
    ds_read_b128 a[24:27], v10 offset:16384
    ds_read_b128 a[28:31], v11 offset:16384
    buffer_load_dwordx4 v6, s[8:11], s38 offen offset:2048  lds
    s_waitcnt lgkmcnt(6)
    v_mfma_f32_32x32x16_bf16 v[32:47], v[112:115], a[20:23], v[32:47]
    v_mfma_f32_16x16x32_bf16 a[196:199], a[192:195], v[112:115], a[196:199]
    ds_read_b64_tr_b16 v[96:97], v12 offset:24576
    ds_read_b64_tr_b16 v[98:99], v12 offset:25600
    ds_read_b64_tr_b16 v[100:101], v13 offset:24576
    buffer_load_dwordx4 v7, s[8:11], s38 offen offset:3072  lds
    s_add_u32 s38, s38, 221184
    s_waitcnt vmcnt(8)
    ds_read_b64_tr_b16 v[140:141], v133 offset:0
    v_mfma_f32_32x32x16_bf16 v[48:63], v[116:119], a[20:23], v[48:63]
    ds_read_b64_tr_b16 v[102:103], v13 offset:25600
    ds_read_b64_tr_b16 v[104:105], v14 offset:24576
    ds_read_b64_tr_b16 v[106:107], v14 offset:25600
    ds_read_b64_tr_b16 v[108:109], v15 offset:24576
    s_add_u32 m0, s39, 0
    ds_read_b64_tr_b16 v[142:143], v133 offset:1280
    s_waitcnt lgkmcnt(11)
    v_mfma_f32_32x32x16_bf16 v[64:79], v[120:123], a[20:23], v[64:79]
    ds_read_b64_tr_b16 v[110:111], v15 offset:25600
    buffer_load_dwordx4 v2, s[4:7], s36 offen  lds
    ds_read_b64_tr_b16 v[144:145], v133 offset:8
    ds_read_b64_tr_b16 v[146:147], v133 offset:1288
    v_mfma_f32_32x32x16_bf16 v[80:95], v[124:127], a[20:23], v[80:95]
    buffer_load_dwordx4 v3, s[4:7], s36 offen offset:1024  lds
    ds_read_b64_tr_b16 v[148:149], v133 offset:64
    s_waitcnt lgkmcnt(8)
    v_mfma_f32_32x32x16_bf16 v[32:47], v[96:99], a[24:27], v[32:47]
    v_mfma_f32_16x16x32_bf16 a[196:199], a[192:195], v[96:99], a[196:199]
    ds_read_b64_tr_b16 v[112:113], v12 offset:28672
    ds_read_b64_tr_b16 v[114:115], v12 offset:29696
    ds_read_b64_tr_b16 v[116:117], v13 offset:28672
    buffer_load_dwordx4 v2, s[4:7], s37 offen offset:2048  lds
    ds_read_b64_tr_b16 v[150:151], v133 offset:1344
    v_mfma_f32_32x32x16_bf16 v[48:63], v[100:103], a[24:27], v[48:63]
    ds_read_b64_tr_b16 v[118:119], v13 offset:29696
    ds_read_b64_tr_b16 v[120:121], v14 offset:28672
    ds_read_b64_tr_b16 v[122:123], v14 offset:29696
    ds_read_b64_tr_b16 v[124:125], v15 offset:28672
    ds_read_b64_tr_b16 v[152:153], v133 offset:72
    ds_read_b64_tr_b16 v[154:155], v133 offset:1352
    s_waitcnt lgkmcnt(13)
    v_mfma_f32_32x32x16_bf16 v[64:79], v[104:107], a[24:27], v[64:79]
    ds_read_b64_tr_b16 v[126:127], v15 offset:29696
    buffer_load_dwordx4 v3, s[4:7], s37 offen offset:3072  lds
    ds_read_b64_tr_b16 v[156:157], v134 offset:128
    v_mfma_f32_32x32x16_bf16 v[80:95], v[108:111], a[24:27], v[80:95]
    s_add_u32 m0, s40, 0
    s_add_u32 s36, s36, 128
    s_add_u32 s37, s37, 128
    ds_read_b64_tr_b16 v[158:159], v134 offset:1408
    buffer_store_dwordx4 v[140:143], v137, s[16:19], s62 offen offset:0 sc1
    s_barrier
    s_waitcnt lgkmcnt(8)
    v_mfma_f32_32x32x16_bf16 v[32:47], v[112:115], a[28:31], v[32:47]
    v_mfma_f32_16x16x32_bf16 a[196:199], a[192:195], v[112:115], a[196:199]
    ds_read_b128 a[0:3], v8 offset:32768
    ds_read_b64_tr_b16 v[96:97], v12 offset:32768
    ds_read_b64_tr_b16 v[98:99], v12 offset:33792
    ds_read_b64_tr_b16 v[100:101], v13 offset:32768
    buffer_load_dwordx4 v4, s[8:11], s38 offen offset:0  lds
    v_mfma_f32_32x32x16_bf16 v[48:63], v[116:119], a[28:31], v[48:63]
    ds_read_b64_tr_b16 v[102:103], v13 offset:33792
    ds_read_b64_tr_b16 v[104:105], v14 offset:32768
    ds_read_b64_tr_b16 v[106:107], v14 offset:33792
    buffer_store_dwordx4 v[144:147], v137, s[16:19], s62 offen offset:1024 sc1
    s_waitcnt lgkmcnt(9)
    v_mfma_f32_32x32x16_bf16 v[64:79], v[120:123], a[28:31], v[64:79]
    ds_read_b64_tr_b16 v[108:109], v15 offset:32768
    ds_read_b64_tr_b16 v[110:111], v15 offset:33792
    buffer_load_dwordx4 v5, s[8:11], s38 offen offset:1024  lds
    v_mfma_f32_32x32x16_bf16 v[80:95], v[124:127], a[28:31], v[80:95]
    ds_read_b128 a[4:7], v9 offset:32768
    buffer_store_dwordx4 v[148:151], v137, s[16:19], s62 offen offset:2048 sc1
    s_waitcnt lgkmcnt(5)
    v_mfma_f32_32x32x16_bf16 v[32:47], v[96:99], a[0:3], v[32:47]
    v_mfma_f32_16x16x32_bf16 a[196:199], a[192:195], v[96:99], a[196:199]
    ds_read_b64_tr_b16 v[112:113], v12 offset:36864
    ds_read_b64_tr_b16 v[114:115], v12 offset:37888
    ds_read_b64_tr_b16 v[116:117], v13 offset:36864
    buffer_load_dwordx4 v6, s[8:11], s38 offen offset:2048  lds
    v_mfma_f32_32x32x16_bf16 v[48:63], v[100:103], a[0:3], v[48:63]
    ds_read_b64_tr_b16 v[118:119], v13 offset:37888
    ds_read_b64_tr_b16 v[120:121], v14 offset:36864
    ds_read_b64_tr_b16 v[122:123], v14 offset:37888
    ds_read_b64_tr_b16 v[124:125], v15 offset:36864
    buffer_store_dwordx4 v[152:155], v137, s[16:19], s62 offen offset:3072 sc1
    s_waitcnt lgkmcnt(8)
    v_mfma_f32_32x32x16_bf16 v[64:79], v[104:107], a[0:3], v[64:79]
    ds_read_b64_tr_b16 v[126:127], v15 offset:37888
    buffer_load_dwordx4 v7, s[8:11], s38 offen offset:3072  lds
    s_add_u32 s38, s38, 221184
    v_mfma_f32_32x32x16_bf16 v[80:95], v[108:111], a[0:3], v[80:95]
    ds_read_b128 a[8:11], v10 offset:32768
    ds_read_b128 a[12:15], v11 offset:32768
    s_add_u32 m0, s39, 16384
    s_add_u32 s62, s62, 4096
    buffer_store_dwordx4 v[156:159], v137, s[16:19], s62 offen offset:0 sc1
    s_waitcnt lgkmcnt(6)
    v_mfma_f32_32x32x16_bf16 v[32:47], v[112:115], a[4:7], v[32:47]
    v_mfma_f32_16x16x32_bf16 a[196:199], a[192:195], v[112:115], a[196:199]
    ds_read_b64_tr_b16 v[96:97], v12 offset:40960
    ds_read_b64_tr_b16 v[98:99], v12 offset:41984
    ds_read_b64_tr_b16 v[100:101], v13 offset:40960
    buffer_load_dwordx4 v2, s[4:7], s36 offen  lds
    v_mfma_f32_32x32x16_bf16 v[48:63], v[116:119], a[4:7], v[48:63]
    ds_read_b64_tr_b16 v[102:103], v13 offset:41984
    ds_read_b64_tr_b16 v[104:105], v14 offset:40960
    ds_read_b64_tr_b16 v[106:107], v14 offset:41984
    ds_read_b64_tr_b16 v[108:109], v15 offset:40960
    s_waitcnt lgkmcnt(9)
    v_mfma_f32_32x32x16_bf16 v[64:79], v[120:123], a[4:7], v[64:79]
    ds_read_b64_tr_b16 v[110:111], v15 offset:41984
    buffer_load_dwordx4 v3, s[4:7], s36 offen offset:1024  lds
    v_mfma_f32_32x32x16_bf16 v[80:95], v[124:127], a[4:7], v[80:95]
    s_waitcnt lgkmcnt(4)
    v_mfma_f32_32x32x16_bf16 v[32:47], v[96:99], a[8:11], v[32:47]
    v_mfma_f32_16x16x32_bf16 a[196:199], a[192:195], v[96:99], a[196:199]
    ds_read_b64_tr_b16 v[112:113], v12 offset:45056
    ds_read_b64_tr_b16 v[114:115], v12 offset:46080
    ds_read_b64_tr_b16 v[116:117], v13 offset:45056
    buffer_load_dwordx4 v2, s[4:7], s37 offen offset:2048  lds
    v_mfma_f32_32x32x16_bf16 v[48:63], v[100:103], a[8:11], v[48:63]
    ds_read_b64_tr_b16 v[118:119], v13 offset:46080
    ds_read_b64_tr_b16 v[120:121], v14 offset:45056
    ds_read_b64_tr_b16 v[122:123], v14 offset:46080
    ds_read_b64_tr_b16 v[124:125], v15 offset:45056
    s_waitcnt lgkmcnt(7)
    v_mfma_f32_32x32x16_bf16 v[64:79], v[104:107], a[8:11], v[64:79]
    ds_read_b64_tr_b16 v[126:127], v15 offset:46080
    buffer_load_dwordx4 v3, s[4:7], s37 offen offset:3072  lds
    v_mfma_f32_32x32x16_bf16 v[80:95], v[108:111], a[8:11], v[80:95]
    s_add_u32 m0, s40, 16384
    s_add_u32 s36, s36, 128
    s_add_u32 s37, s37, 128
    v_readfirstlane_b32 s43, v28
    s_mov_b32 s51, 0
    s_cmp_lg_u32 s43, 0
    s_cbranch_scc1 L_nok2
L_nlp3:
    v_mov_b32 v28, 0
    global_load_dword v28, v28, s[28:29] sc1
    s_waitcnt vmcnt(0)
    v_readfirstlane_b32 s43, v28
    s_add_u32 s51, s51, 1
    s_cmp_gt_u32 s51, 100000
    s_cbranch_scc1 L_nok2
    s_cmp_eq_u32 s43, 0
    s_cbranch_scc1 L_nlp3
L_nok2:
    v_mov_b32 v189, s43
    s_mov_b32 exec_lo, 0x00010001
    s_mov_b32 exec_hi, 0x00010001
    buffer_store_dwordx4 v[186:189], v136, s[16:19], s65 offen sc1
    s_waitcnt vmcnt(5)
    s_mov_b64 exec, 1
    buffer_store_dword v189, v137, s[16:19], s64 offen sc1
    s_mov_b64 exec, -1
    s_barrier
    s_waitcnt lgkmcnt(4)
    v_mfma_f32_32x32x16_bf16 v[32:47], v[112:115], a[12:15], v[32:47]
    v_mfma_f32_16x16x32_bf16 a[196:199], a[192:195], v[112:115], a[196:199]
    ds_read_b128 a[16:19], v8 offset:49152
    ds_read_b64_tr_b16 v[96:97], v12 offset:49152
    ds_read_b64_tr_b16 v[98:99], v12 offset:50176
    ds_read_b64_tr_b16 v[100:101], v13 offset:49152
    buffer_load_dwordx4 v4, s[8:11], s38 offen offset:0  lds
    v_mfma_f32_32x32x16_bf16 v[48:63], v[116:119], a[12:15], v[48:63]
    ds_read_b64_tr_b16 v[102:103], v13 offset:50176
    ds_read_b64_tr_b16 v[104:105], v14 offset:49152
    ds_read_b64_tr_b16 v[106:107], v14 offset:50176
    s_waitcnt lgkmcnt(7)
    v_mfma_f32_32x32x16_bf16 v[64:79], v[120:123], a[12:15], v[64:79]
    ds_read_b64_tr_b16 v[108:109], v15 offset:49152
    ds_read_b64_tr_b16 v[110:111], v15 offset:50176
    buffer_load_dwordx4 v5, s[8:11], s38 offen offset:1024  lds
    v_mfma_f32_32x32x16_bf16 v[80:95], v[124:127], a[12:15], v[80:95]
    ds_read_b128 a[20:23], v9 offset:49152
    s_waitcnt lgkmcnt(5)
    v_mfma_f32_32x32x16_bf16 v[32:47], v[96:99], a[16:19], v[32:47]
    v_mfma_f32_16x16x32_bf16 a[196:199], a[192:195], v[96:99], a[196:199]
    ds_read_b64_tr_b16 v[112:113], v12 offset:53248
    ds_read_b64_tr_b16 v[114:115], v12 offset:54272
    ds_read_b64_tr_b16 v[116:117], v13 offset:53248
    buffer_load_dwordx4 v6, s[8:11], s38 offen offset:2048  lds
    v_mfma_f32_32x32x16_bf16 v[48:63], v[100:103], a[16:19], v[48:63]
    ds_read_b64_tr_b16 v[118:119], v13 offset:54272
    ds_read_b64_tr_b16 v[120:121], v14 offset:53248
    ds_read_b64_tr_b16 v[122:123], v14 offset:54272
    ds_read_b64_tr_b16 v[124:125], v15 offset:53248
    s_waitcnt lgkmcnt(8)
    v_mfma_f32_32x32x16_bf16 v[64:79], v[104:107], a[16:19], v[64:79]
    ds_read_b64_tr_b16 v[126:127], v15 offset:54272
    buffer_load_dwordx4 v7, s[8:11], s38 offen offset:3072  lds
    s_add_u32 s38, s38, 221184
    v_mfma_f32_32x32x16_bf16 v[80:95], v[108:111], a[16:19], v[80:95]
    ds_read_b128 a[24:27], v10 offset:49152
    ds_read_b128 a[28:31], v11 offset:49152
    s_add_u32 m0, s39, 32768
    s_waitcnt lgkmcnt(6)
    v_mfma_f32_32x32x16_bf16 v[32:47], v[112:115], a[20:23], v[32:47]
    v_mfma_f32_16x16x32_bf16 a[196:199], a[192:195], v[112:115], a[196:199]
    ds_read_b64_tr_b16 v[96:97], v12 offset:57344
    ds_read_b64_tr_b16 v[98:99], v12 offset:58368
    ds_read_b64_tr_b16 v[100:101], v13 offset:57344
    buffer_load_dwordx4 v2, s[4:7], s36 offen  lds
    v_mfma_f32_32x32x16_bf16 v[48:63], v[116:119], a[20:23], v[48:63]
    ds_read_b64_tr_b16 v[102:103], v13 offset:58368
    ds_read_b64_tr_b16 v[104:105], v14 offset:57344
    ds_read_b64_tr_b16 v[106:107], v14 offset:58368
    ds_read_b64_tr_b16 v[108:109], v15 offset:57344
    s_waitcnt lgkmcnt(9)
    v_mfma_f32_32x32x16_bf16 v[64:79], v[120:123], a[20:23], v[64:79]
    ds_read_b64_tr_b16 v[110:111], v15 offset:58368
    buffer_load_dwordx4 v3, s[4:7], s36 offen offset:1024  lds
    v_mfma_f32_32x32x16_bf16 v[80:95], v[124:127], a[20:23], v[80:95]
    s_waitcnt lgkmcnt(4)
    v_mfma_f32_32x32x16_bf16 v[32:47], v[96:99], a[24:27], v[32:47]
    v_mfma_f32_16x16x32_bf16 a[196:199], a[192:195], v[96:99], a[196:199]
    ds_read_b64_tr_b16 v[112:113], v12 offset:61440
    ds_read_b64_tr_b16 v[114:115], v12 offset:62464
    ds_read_b64_tr_b16 v[116:117], v13 offset:61440
    buffer_load_dwordx4 v2, s[4:7], s37 offen offset:2048  lds
    v_mfma_f32_32x32x16_bf16 v[48:63], v[100:103], a[24:27], v[48:63]
    ds_read_b64_tr_b16 v[118:119], v13 offset:62464
    ds_read_b64_tr_b16 v[120:121], v14 offset:61440
    ds_read_b64_tr_b16 v[122:123], v14 offset:62464
    ds_read_b64_tr_b16 v[124:125], v15 offset:61440
    s_waitcnt lgkmcnt(7)
    v_mfma_f32_32x32x16_bf16 v[64:79], v[104:107], a[24:27], v[64:79]
    ds_read_b64_tr_b16 v[126:127], v15 offset:62464
    buffer_load_dwordx4 v3, s[4:7], s37 offen offset:3072  lds
    v_mfma_f32_32x32x16_bf16 v[80:95], v[108:111], a[24:27], v[80:95]
    s_add_u32 m0, s40, 32768
    s_add_u32 s36, s36, 128
    s_add_u32 s37, s37, 128
    s_barrier
    s_waitcnt lgkmcnt(4)
    v_mfma_f32_32x32x16_bf16 v[32:47], v[112:115], a[28:31], v[32:47]
    v_mfma_f32_16x16x32_bf16 a[196:199], a[192:195], v[112:115], a[196:199]
    ds_read_b128 a[0:3], v8 offset:0
    ds_read_b64_tr_b16 v[96:97], v12 offset:0
    ds_read_b64_tr_b16 v[98:99], v12 offset:1024
    ds_read_b64_tr_b16 v[100:101], v13 offset:0
    buffer_load_dwordx4 v4, s[8:11], s38 offen offset:0  lds
    v_mfma_f32_32x32x16_bf16 v[48:63], v[116:119], a[28:31], v[48:63]
    ds_read_b64_tr_b16 v[102:103], v13 offset:1024
    ds_read_b64_tr_b16 v[104:105], v14 offset:0
    ds_read_b64_tr_b16 v[106:107], v14 offset:1024
    s_waitcnt lgkmcnt(7)
    v_mfma_f32_32x32x16_bf16 v[64:79], v[120:123], a[28:31], v[64:79]
    ds_read_b64_tr_b16 v[108:109], v15 offset:0
    ds_read_b64_tr_b16 v[110:111], v15 offset:1024
    buffer_load_dwordx4 v5, s[8:11], s38 offen offset:1024  lds
    v_mfma_f32_32x32x16_bf16 v[80:95], v[124:127], a[28:31], v[80:95]
    ds_read_b128 a[4:7], v9 offset:0
    s_waitcnt lgkmcnt(5)
    v_mfma_f32_32x32x16_bf16 v[32:47], v[96:99], a[0:3], v[32:47]
    v_mfma_f32_16x16x32_bf16 a[196:199], a[192:195], v[96:99], a[196:199]
    ds_read_b64_tr_b16 v[112:113], v12 offset:4096
    ds_read_b64_tr_b16 v[114:115], v12 offset:5120
    ds_read_b64_tr_b16 v[116:117], v13 offset:4096
    buffer_load_dwordx4 v6, s[8:11], s38 offen offset:2048  lds
    v_mfma_f32_32x32x16_bf16 v[48:63], v[100:103], a[0:3], v[48:63]
    ds_read_b64_tr_b16 v[118:119], v13 offset:5120
    ds_read_b64_tr_b16 v[120:121], v14 offset:4096
    ds_read_b64_tr_b16 v[122:123], v14 offset:5120
    ds_read_b64_tr_b16 v[124:125], v15 offset:4096
    s_waitcnt lgkmcnt(8)
    v_mfma_f32_32x32x16_bf16 v[64:79], v[104:107], a[0:3], v[64:79]
    ds_read_b64_tr_b16 v[126:127], v15 offset:5120
    buffer_load_dwordx4 v7, s[8:11], s38 offen offset:3072  lds
    s_add_u32 s38, s38, 221184
    v_mfma_f32_32x32x16_bf16 v[80:95], v[108:111], a[0:3], v[80:95]
    ds_read_b128 a[8:11], v10 offset:0
    ds_read_b128 a[12:15], v11 offset:0
    s_add_u32 m0, s39, 49152
    s_waitcnt lgkmcnt(6)
    v_mfma_f32_32x32x16_bf16 v[32:47], v[112:115], a[4:7], v[32:47]
    v_mfma_f32_16x16x32_bf16 a[196:199], a[192:195], v[112:115], a[196:199]
    ds_read_b64_tr_b16 v[96:97], v12 offset:8192
    ds_read_b64_tr_b16 v[98:99], v12 offset:9216
    ds_read_b64_tr_b16 v[100:101], v13 offset:8192
    buffer_load_dwordx4 v2, s[4:7], s36 offen  lds
    v_mfma_f32_32x32x16_bf16 v[48:63], v[116:119], a[4:7], v[48:63]
    ds_read_b64_tr_b16 v[102:103], v13 offset:9216
    ds_read_b64_tr_b16 v[104:105], v14 offset:8192
    ds_read_b64_tr_b16 v[106:107], v14 offset:9216
    ds_read_b64_tr_b16 v[108:109], v15 offset:8192
    s_waitcnt lgkmcnt(9)
    v_mfma_f32_32x32x16_bf16 v[64:79], v[120:123], a[4:7], v[64:79]
    ds_read_b64_tr_b16 v[110:111], v15 offset:9216
    buffer_load_dwordx4 v3, s[4:7], s36 offen offset:1024  lds
    v_mfma_f32_32x32x16_bf16 v[80:95], v[124:127], a[4:7], v[80:95]
    s_waitcnt lgkmcnt(4)
    v_mfma_f32_32x32x16_bf16 v[32:47], v[96:99], a[8:11], v[32:47]
    v_mfma_f32_16x16x32_bf16 a[196:199], a[192:195], v[96:99], a[196:199]
    ds_read_b64_tr_b16 v[112:113], v12 offset:12288
    ds_read_b64_tr_b16 v[114:115], v12 offset:13312
    ds_read_b64_tr_b16 v[116:117], v13 offset:12288
    buffer_load_dwordx4 v2, s[4:7], s37 offen offset:2048  lds
    v_mfma_f32_32x32x16_bf16 v[48:63], v[100:103], a[8:11], v[48:63]
    ds_read_b64_tr_b16 v[118:119], v13 offset:13312
    ds_read_b64_tr_b16 v[120:121], v14 offset:12288
    ds_read_b64_tr_b16 v[122:123], v14 offset:13312
    ds_read_b64_tr_b16 v[124:125], v15 offset:12288
    s_waitcnt lgkmcnt(7)
    v_mfma_f32_32x32x16_bf16 v[64:79], v[104:107], a[8:11], v[64:79]
    ds_read_b64_tr_b16 v[126:127], v15 offset:13312
    buffer_load_dwordx4 v3, s[4:7], s37 offen offset:3072  lds
    v_mfma_f32_32x32x16_bf16 v[80:95], v[108:111], a[8:11], v[80:95]
    s_add_u32 m0, s40, 49152
    s_add_u32 s36, s36, 128
    s_add_u32 s37, s37, 128
    s_waitcnt vmcnt(12)
    s_barrier
    s_waitcnt lgkmcnt(4)
    v_mfma_f32_32x32x16_bf16 v[32:47], v[112:115], a[12:15], v[32:47]
    v_mfma_f32_16x16x32_bf16 a[196:199], a[192:195], v[112:115], a[196:199]
    ds_read_b128 a[16:19], v8 offset:16384
    ds_read_b64_tr_b16 v[96:97], v12 offset:16384
    ds_read_b64_tr_b16 v[98:99], v12 offset:17408
    ds_read_b64_tr_b16 v[100:101], v13 offset:16384
    buffer_load_dwordx4 v4, s[8:11], s38 offen offset:0  lds
    v_mfma_f32_32x32x16_bf16 v[48:63], v[116:119], a[12:15], v[48:63]
    ds_read_b64_tr_b16 v[102:103], v13 offset:17408
    ds_read_b64_tr_b16 v[104:105], v14 offset:16384
    ds_read_b64_tr_b16 v[106:107], v14 offset:17408
    s_waitcnt lgkmcnt(7)
    v_mfma_f32_32x32x16_bf16 v[64:79], v[120:123], a[12:15], v[64:79]
    ds_read_b64_tr_b16 v[108:109], v15 offset:16384
    ds_read_b64_tr_b16 v[110:111], v15 offset:17408
    buffer_load_dwordx4 v5, s[8:11], s38 offen offset:1024  lds
    v_mfma_f32_32x32x16_bf16 v[80:95], v[124:127], a[12:15], v[80:95]
    ds_read_b128 a[20:23], v9 offset:16384
    s_waitcnt lgkmcnt(5)
    v_mfma_f32_32x32x16_bf16 v[32:47], v[96:99], a[16:19], v[32:47]
    v_mfma_f32_16x16x32_bf16 a[196:199], a[192:195], v[96:99], a[196:199]
    ds_read_b64_tr_b16 v[112:113], v12 offset:20480
    ds_read_b64_tr_b16 v[114:115], v12 offset:21504
    ds_read_b64_tr_b16 v[116:117], v13 offset:20480
    buffer_load_dwordx4 v6, s[8:11], s38 offen offset:2048  lds
    v_mfma_f32_32x32x16_bf16 v[48:63], v[100:103], a[16:19], v[48:63]
    ds_read_b64_tr_b16 v[118:119], v13 offset:21504
    ds_read_b64_tr_b16 v[120:121], v14 offset:20480
    ds_read_b64_tr_b16 v[122:123], v14 offset:21504
    ds_read_b64_tr_b16 v[124:125], v15 offset:20480
    s_waitcnt lgkmcnt(8)
    v_mfma_f32_32x32x16_bf16 v[64:79], v[104:107], a[16:19], v[64:79]
    ds_read_b64_tr_b16 v[126:127], v15 offset:21504
    buffer_load_dwordx4 v7, s[8:11], s38 offen offset:3072  lds
    s_add_u32 s38, s38, 221184
    v_mfma_f32_32x32x16_bf16 v[80:95], v[108:111], a[16:19], v[80:95]
    ds_read_b128 a[24:27], v10 offset:16384
    ds_read_b128 a[28:31], v11 offset:16384
    s_add_u32 m0, s39, 0
    s_waitcnt lgkmcnt(6)
    v_mfma_f32_32x32x16_bf16 v[32:47], v[112:115], a[20:23], v[32:47]
    v_mfma_f32_16x16x32_bf16 a[196:199], a[192:195], v[112:115], a[196:199]
    ds_read_b64_tr_b16 v[96:97], v12 offset:24576
    ds_read_b64_tr_b16 v[98:99], v12 offset:25600
    ds_read_b64_tr_b16 v[100:101], v13 offset:24576
    buffer_load_dwordx4 v2, s[4:7], s36 offen  lds
    v_mfma_f32_32x32x16_bf16 v[48:63], v[116:119], a[20:23], v[48:63]
    ds_read_b64_tr_b16 v[102:103], v13 offset:25600
    ds_read_b64_tr_b16 v[104:105], v14 offset:24576
    ds_read_b64_tr_b16 v[106:107], v14 offset:25600
    ds_read_b64_tr_b16 v[108:109], v15 offset:24576
    s_waitcnt lgkmcnt(9)
    v_mfma_f32_32x32x16_bf16 v[64:79], v[120:123], a[20:23], v[64:79]
    ds_read_b64_tr_b16 v[110:111], v15 offset:25600
    buffer_load_dwordx4 v3, s[4:7], s36 offen offset:1024  lds
    v_mfma_f32_32x32x16_bf16 v[80:95], v[124:127], a[20:23], v[80:95]
    s_waitcnt lgkmcnt(4)
    v_mfma_f32_32x32x16_bf16 v[32:47], v[96:99], a[24:27], v[32:47]
    v_mfma_f32_16x16x32_bf16 a[196:199], a[192:195], v[96:99], a[196:199]
    ds_read_b64_tr_b16 v[112:113], v12 offset:28672
    ds_read_b64_tr_b16 v[114:115], v12 offset:29696
    ds_read_b64_tr_b16 v[116:117], v13 offset:28672
    buffer_load_dwordx4 v2, s[4:7], s37 offen offset:2048  lds
    v_mfma_f32_32x32x16_bf16 v[48:63], v[100:103], a[24:27], v[48:63]
    ds_read_b64_tr_b16 v[118:119], v13 offset:29696
    ds_read_b64_tr_b16 v[120:121], v14 offset:28672
    ds_read_b64_tr_b16 v[122:123], v14 offset:29696
    ds_read_b64_tr_b16 v[124:125], v15 offset:28672
    s_waitcnt lgkmcnt(7)
    v_mfma_f32_32x32x16_bf16 v[64:79], v[104:107], a[24:27], v[64:79]
    ds_read_b64_tr_b16 v[126:127], v15 offset:29696
    buffer_load_dwordx4 v3, s[4:7], s37 offen offset:3072  lds
    v_mfma_f32_32x32x16_bf16 v[80:95], v[108:111], a[24:27], v[80:95]
    s_add_u32 m0, s40, 0
    s_add_u32 s36, s36, 128
    s_add_u32 s37, s37, 128
    s_waitcnt vmcnt(12)
    s_barrier
    s_waitcnt lgkmcnt(4)
    v_mfma_f32_32x32x16_bf16 v[32:47], v[112:115], a[28:31], v[32:47]
    v_mfma_f32_16x16x32_bf16 a[196:199], a[192:195], v[112:115], a[196:199]
    ds_read_b128 a[0:3], v8 offset:32768
    ds_read_b64_tr_b16 v[96:97], v12 offset:32768
    ds_read_b64_tr_b16 v[98:99], v12 offset:33792
    ds_read_b64_tr_b16 v[100:101], v13 offset:32768
    buffer_load_dwordx4 v4, s[8:11], s38 offen offset:0  lds
    v_mfma_f32_32x32x16_bf16 v[48:63], v[116:119], a[28:31], v[48:63]
    ds_read_b64_tr_b16 v[102:103], v13 offset:33792
    ds_read_b64_tr_b16 v[104:105], v14 offset:32768
    ds_read_b64_tr_b16 v[106:107], v14 offset:33792
    s_waitcnt lgkmcnt(7)
    v_mfma_f32_32x32x16_bf16 v[64:79], v[120:123], a[28:31], v[64:79]
    ds_read_b64_tr_b16 v[108:109], v15 offset:32768
    ds_read_b64_tr_b16 v[110:111], v15 offset:33792
    buffer_load_dwordx4 v5, s[8:11], s38 offen offset:1024  lds
    v_mfma_f32_32x32x16_bf16 v[80:95], v[124:127], a[28:31], v[80:95]
    ds_read_b128 a[4:7], v9 offset:32768
    s_waitcnt lgkmcnt(5)
    v_mfma_f32_32x32x16_bf16 v[32:47], v[96:99], a[0:3], v[32:47]
    v_mfma_f32_16x16x32_bf16 a[196:199], a[192:195], v[96:99], a[196:199]
    ds_read_b64_tr_b16 v[112:113], v12 offset:36864
    ds_read_b64_tr_b16 v[114:115], v12 offset:37888
    ds_read_b64_tr_b16 v[116:117], v13 offset:36864
    buffer_load_dwordx4 v6, s[8:11], s38 offen offset:2048  lds
    v_mfma_f32_32x32x16_bf16 v[48:63], v[100:103], a[0:3], v[48:63]
    ds_read_b64_tr_b16 v[118:119], v13 offset:37888
    ds_read_b64_tr_b16 v[120:121], v14 offset:36864
    ds_read_b64_tr_b16 v[122:123], v14 offset:37888
    ds_read_b64_tr_b16 v[124:125], v15 offset:36864
    s_waitcnt lgkmcnt(8)
    v_mfma_f32_32x32x16_bf16 v[64:79], v[104:107], a[0:3], v[64:79]
    ds_read_b64_tr_b16 v[126:127], v15 offset:37888
    buffer_load_dwordx4 v7, s[8:11], s38 offen offset:3072  lds
    s_add_u32 s38, s38, 221184
    v_mfma_f32_32x32x16_bf16 v[80:95], v[108:111], a[0:3], v[80:95]
    ds_read_b128 a[8:11], v10 offset:32768
    ds_read_b128 a[12:15], v11 offset:32768
    s_add_u32 m0, s39, 16384
    buffer_load_dword v21, v20, s[16:19], 0 offen sc1
    s_waitcnt lgkmcnt(6)
    v_mfma_f32_32x32x16_bf16 v[32:47], v[112:115], a[4:7], v[32:47]
    v_mfma_f32_16x16x32_bf16 a[196:199], a[192:195], v[112:115], a[196:199]
    ds_read_b64_tr_b16 v[96:97], v12 offset:40960
    ds_read_b64_tr_b16 v[98:99], v12 offset:41984
    ds_read_b64_tr_b16 v[100:101], v13 offset:40960
    buffer_load_dwordx4 v2, s[4:7], s36 offen  lds
    v_mfma_f32_32x32x16_bf16 v[48:63], v[116:119], a[4:7], v[48:63]
    ds_read_b64_tr_b16 v[102:103], v13 offset:41984
    ds_read_b64_tr_b16 v[104:105], v14 offset:40960
    ds_read_b64_tr_b16 v[106:107], v14 offset:41984
    ds_read_b64_tr_b16 v[108:109], v15 offset:40960
    s_waitcnt lgkmcnt(9)
    v_mfma_f32_32x32x16_bf16 v[64:79], v[120:123], a[4:7], v[64:79]
    ds_read_b64_tr_b16 v[110:111], v15 offset:41984
    buffer_load_dwordx4 v3, s[4:7], s36 offen offset:1024  lds
    v_mfma_f32_32x32x16_bf16 v[80:95], v[124:127], a[4:7], v[80:95]
    s_waitcnt lgkmcnt(4)
    v_mfma_f32_32x32x16_bf16 v[32:47], v[96:99], a[8:11], v[32:47]
    v_mfma_f32_16x16x32_bf16 a[196:199], a[192:195], v[96:99], a[196:199]
    ds_read_b64_tr_b16 v[112:113], v12 offset:45056
    ds_read_b64_tr_b16 v[114:115], v12 offset:46080
    ds_read_b64_tr_b16 v[116:117], v13 offset:45056
    buffer_load_dwordx4 v2, s[4:7], s37 offen offset:2048  lds
    v_mfma_f32_32x32x16_bf16 v[48:63], v[100:103], a[8:11], v[48:63]
    ds_read_b64_tr_b16 v[118:119], v13 offset:46080
    ds_read_b64_tr_b16 v[120:121], v14 offset:45056
    ds_read_b64_tr_b16 v[122:123], v14 offset:46080
    ds_read_b64_tr_b16 v[124:125], v15 offset:45056
    s_waitcnt lgkmcnt(7)
    v_mfma_f32_32x32x16_bf16 v[64:79], v[104:107], a[8:11], v[64:79]
    ds_read_b64_tr_b16 v[126:127], v15 offset:46080
    buffer_load_dwordx4 v3, s[4:7], s37 offen offset:3072  lds
    v_mfma_f32_32x32x16_bf16 v[80:95], v[108:111], a[8:11], v[80:95]
    s_add_u32 m0, s40, 16384
    s_add_u32 s36, s36, 128
    s_add_u32 s37, s37, 128
    s_waitcnt vmcnt(13)
    s_barrier
    s_waitcnt lgkmcnt(4)
    v_mfma_f32_32x32x16_bf16 v[32:47], v[112:115], a[12:15], v[32:47]
    v_mfma_f32_16x16x32_bf16 a[196:199], a[192:195], v[112:115], a[196:199]
    ds_read_b128 a[16:19], v8 offset:49152
    ds_read_b64_tr_b16 v[96:97], v12 offset:49152
    ds_read_b64_tr_b16 v[98:99], v12 offset:50176
    ds_read_b64_tr_b16 v[100:101], v13 offset:49152
    buffer_load_dwordx4 v4, s[8:11], s38 offen offset:0  lds
    v_mfma_f32_32x32x16_bf16 v[48:63], v[116:119], a[12:15], v[48:63]
    ds_read_b64_tr_b16 v[102:103], v13 offset:50176
    ds_read_b64_tr_b16 v[104:105], v14 offset:49152
    ds_read_b64_tr_b16 v[106:107], v14 offset:50176
    s_waitcnt lgkmcnt(7)
    v_mfma_f32_32x32x16_bf16 v[64:79], v[120:123], a[12:15], v[64:79]
    ds_read_b64_tr_b16 v[108:109], v15 offset:49152
    ds_read_b64_tr_b16 v[110:111], v15 offset:50176
    buffer_load_dwordx4 v5, s[8:11], s38 offen offset:1024  lds
    v_mfma_f32_32x32x16_bf16 v[80:95], v[124:127], a[12:15], v[80:95]
    ds_read_b128 a[20:23], v9 offset:49152
    s_waitcnt vmcnt(6)
    s_mov_b32 exec_lo, 0x3fff
    s_mov_b32 exec_hi, 0x0
    v_cmp_ne_u32 vcc, s43, v21
    s_mov_b32 s51, 0
    s_cbranch_vccz L_ok4
L_lp5:
    s_sleep 1
    buffer_load_dword v21, v20, s[16:19], 0 offen sc1
    s_waitcnt vmcnt(0)
    v_cmp_ne_u32 vcc, s43, v21
    s_add_u32 s51, s51, 1
    s_cmp_gt_u32 s51, 100000
    s_cbranch_scc1 L_ok4
    s_cbranch_vccnz L_lp5
L_ok4:
    s_mov_b64 exec, -1
    s_waitcnt lgkmcnt(5)
    v_mfma_f32_32x32x16_bf16 v[32:47], v[96:99], a[16:19], v[32:47]
    v_mfma_f32_16x16x32_bf16 a[196:199], a[192:195], v[96:99], a[196:199]
    ds_read_b64_tr_b16 v[112:113], v12 offset:53248
    ds_read_b64_tr_b16 v[114:115], v12 offset:54272
    ds_read_b64_tr_b16 v[116:117], v13 offset:53248
    buffer_load_dwordx4 v6, s[8:11], s38 offen offset:2048  lds
    v_mfma_f32_32x32x16_bf16 v[48:63], v[100:103], a[16:19], v[48:63]
    ds_read_b64_tr_b16 v[118:119], v13 offset:54272
    ds_read_b64_tr_b16 v[120:121], v14 offset:53248
    ds_read_b64_tr_b16 v[122:123], v14 offset:54272
    ds_read_b64_tr_b16 v[124:125], v15 offset:53248
    s_add_u32 s62, s70, 0
    buffer_load_dwordx4 v[196:199], v31, s[16:19], s62 offen offset:0 sc1
    s_waitcnt lgkmcnt(8)
    v_mfma_f32_32x32x16_bf16 v[64:79], v[104:107], a[16:19], v[64:79]
    ds_read_b64_tr_b16 v[126:127], v15 offset:54272
    buffer_load_dwordx4 v7, s[8:11], s38 offen offset:3072  lds
    s_add_u32 s38, s38, 221184
    v_mfma_f32_32x32x16_bf16 v[80:95], v[108:111], a[16:19], v[80:95]
    ds_read_b128 a[24:27], v10 offset:49152
    ds_read_b128 a[28:31], v11 offset:49152
    s_waitcnt lgkmcnt(6)
    v_mfma_f32_32x32x16_bf16 v[32:47], v[112:115], a[20:23], v[32:47]
    v_mfma_f32_16x16x32_bf16 a[196:199], a[192:195], v[112:115], a[196:199]
    ds_read_b64_tr_b16 v[96:97], v12 offset:57344
    ds_read_b64_tr_b16 v[98:99], v12 offset:58368
    ds_read_b64_tr_b16 v[100:101], v13 offset:57344
    v_mfma_f32_32x32x16_bf16 v[48:63], v[116:119], a[20:23], v[48:63]
    ds_read_b64_tr_b16 v[102:103], v13 offset:58368
    ds_read_b64_tr_b16 v[104:105], v14 offset:57344
    ds_read_b64_tr_b16 v[106:107], v14 offset:58368
    ds_read_b64_tr_b16 v[108:109], v15 offset:57344
    s_waitcnt lgkmcnt(9)
    v_mfma_f32_32x32x16_bf16 v[64:79], v[120:123], a[20:23], v[64:79]
    ds_read_b64_tr_b16 v[110:111], v15 offset:58368
    v_mfma_f32_32x32x16_bf16 v[80:95], v[124:127], a[20:23], v[80:95]
    s_waitcnt lgkmcnt(4)
    v_mfma_f32_32x32x16_bf16 v[32:47], v[96:99], a[24:27], v[32:47]
    v_mfma_f32_16x16x32_bf16 a[196:199], a[192:195], v[96:99], a[196:199]
    ds_read_b64_tr_b16 v[112:113], v12 offset:61440
    ds_read_b64_tr_b16 v[114:115], v12 offset:62464
    ds_read_b64_tr_b16 v[116:117], v13 offset:61440
    v_mfma_f32_32x32x16_bf16 v[48:63], v[100:103], a[24:27], v[48:63]
    ds_read_b64_tr_b16 v[118:119], v13 offset:62464
    ds_read_b64_tr_b16 v[120:121], v14 offset:61440
    ds_read_b64_tr_b16 v[122:123], v14 offset:62464
    ds_read_b64_tr_b16 v[124:125], v15 offset:61440
    buffer_load_dwordx4 v[200:203], v31, s[16:19], s62 offen offset:1024 sc1
    s_waitcnt lgkmcnt(7)
    v_mfma_f32_32x32x16_bf16 v[64:79], v[104:107], a[24:27], v[64:79]
    ds_read_b64_tr_b16 v[126:127], v15 offset:62464
    v_mfma_f32_32x32x16_bf16 v[80:95], v[108:111], a[24:27], v[80:95]
    s_barrier
    s_waitcnt lgkmcnt(4)
    v_mfma_f32_32x32x16_bf16 v[32:47], v[112:115], a[28:31], v[32:47]
    v_mfma_f32_16x16x32_bf16 a[196:199], a[192:195], v[112:115], a[196:199]
    ds_read_b128 a[0:3], v8 offset:0
    ds_read_b64_tr_b16 v[96:97], v12 offset:0
    ds_read_b64_tr_b16 v[98:99], v12 offset:1024
    ds_read_b64_tr_b16 v[100:101], v13 offset:0
    buffer_load_dwordx4 v[204:207], v31, s[16:19], s62 offen offset:2048 sc1
    s_lshl_b32 s72, s30, 7
    s_add_u32 s72, s72, 162816
    v_and_b32 v22, 31, v1
    v_mfma_f32_32x32x16_bf16 v[48:63], v[116:119], a[28:31], v[48:63]
    ds_read_b64_tr_b16 v[102:103], v13 offset:1024
    ds_read_b64_tr_b16 v[104:105], v14 offset:0
    ds_read_b64_tr_b16 v[106:107], v14 offset:1024
    buffer_load_dwordx4 v[208:211], v31, s[16:19], s62 offen offset:3072 sc1
    v_lshl_add_u32 v3, v22, 2, s72
    s_add_u32 s71, s30, 0
    s_waitcnt lgkmcnt(7)
    v_mfma_f32_32x32x16_bf16 v[64:79], v[120:123], a[28:31], v[64:79]
    ds_read_b64_tr_b16 v[108:109], v15 offset:0
    ds_read_b64_tr_b16 v[110:111], v15 offset:1024
    s_add_u32 s62, s70, 4096
    buffer_load_dwordx4 v[212:215], v31, s[16:19], s62 offen offset:0 sc1
    s_and_b32 s71, s71, 3
    s_lshl_b32 s71, s71, 7
    v_mfma_f32_32x32x16_bf16 v[80:95], v[124:127], a[28:31], v[80:95]
    ds_read_b128 a[4:7], v9 offset:0
    buffer_load_dwordx4 v[24:27], v19, s[16:19], 0 offen sc1
    s_add_u32 s71, s71, 161792
    v_lshl_add_u32 v4, v22, 2, s71
    s_waitcnt lgkmcnt(5)
    v_mfma_f32_32x32x16_bf16 v[32:47], v[96:99], a[0:3], v[32:47]
    v_mfma_f32_16x16x32_bf16 a[196:199], a[192:195], v[96:99], a[196:199]
    ds_read_b64_tr_b16 v[112:113], v12 offset:4096
    ds_read_b64_tr_b16 v[114:115], v12 offset:5120
    ds_read_b64_tr_b16 v[116:117], v13 offset:4096
    s_add_u32 s62, s70, 5120
    buffer_load_dwordx4 v[216:219], v31, s[16:19], s62 offen offset:0 sc1
    s_add_u32 s71, s30, 1
    s_and_b32 s71, s71, 3
    v_mfma_f32_32x32x16_bf16 v[48:63], v[100:103], a[0:3], v[48:63]
    ds_read_b64_tr_b16 v[118:119], v13 offset:5120
    ds_read_b64_tr_b16 v[120:121], v14 offset:4096
    ds_read_b64_tr_b16 v[122:123], v14 offset:5120
    ds_read_b64_tr_b16 v[124:125], v15 offset:4096
    buffer_load_dwordx4 v[220:223], v31, s[16:19], s62 offen offset:1024 sc1
    s_lshl_b32 s71, s71, 7
    s_add_u32 s71, s71, 161792
    s_waitcnt lgkmcnt(8)
    v_mfma_f32_32x32x16_bf16 v[64:79], v[104:107], a[0:3], v[64:79]
    ds_read_b64_tr_b16 v[126:127], v15 offset:5120
    buffer_load_dwordx4 v[224:227], v31, s[16:19], s62 offen offset:2048 sc1
    v_lshl_add_u32 v5, v22, 2, s71
    s_add_u32 s71, s30, 2
    v_mfma_f32_32x32x16_bf16 v[80:95], v[108:111], a[0:3], v[80:95]
    ds_read_b128 a[8:11], v10 offset:0
    ds_read_b128 a[12:15], v11 offset:0
    s_and_b32 s71, s71, 3
    s_lshl_b32 s71, s71, 7
    s_waitcnt lgkmcnt(6)
    v_mfma_f32_32x32x16_bf16 v[32:47], v[112:115], a[4:7], v[32:47]
    v_mfma_f32_16x16x32_bf16 a[196:199], a[192:195], v[112:115], a[196:199]
    ds_read_b64_tr_b16 v[96:97], v12 offset:8192
    ds_read_b64_tr_b16 v[98:99], v12 offset:9216
    ds_read_b64_tr_b16 v[100:101], v13 offset:8192
    buffer_load_dwordx4 v[228:231], v31, s[16:19], s62 offen offset:3072 sc1
    s_add_u32 s71, s71, 161792
    v_lshl_add_u32 v6, v22, 2, s71
    v_mfma_f32_32x32x16_bf16 v[48:63], v[116:119], a[4:7], v[48:63]
    ds_read_b64_tr_b16 v[102:103], v13 offset:9216
    ds_read_b64_tr_b16 v[104:105], v14 offset:8192
    ds_read_b64_tr_b16 v[106:107], v14 offset:9216
    ds_read_b64_tr_b16 v[108:109], v15 offset:8192
    s_add_u32 s62, s70, 9216
    buffer_load_dwordx4 v[232:235], v31, s[16:19], s62 offen offset:0 sc1
    s_add_u32 s71, s30, 3
    s_and_b32 s71, s71, 3
    s_waitcnt lgkmcnt(9)
    v_mfma_f32_32x32x16_bf16 v[64:79], v[120:123], a[4:7], v[64:79]
    ds_read_b64_tr_b16 v[110:111], v15 offset:9216
    s_add_u32 s62, s70, 10240
    buffer_load_dwordx4 v[236:239], v31, s[16:19], s62 offen offset:0 sc1
    s_lshl_b32 s71, s71, 7
    s_add_u32 s71, s71, 161792
    v_mfma_f32_32x32x16_bf16 v[80:95], v[124:127], a[4:7], v[80:95]
    v_lshl_add_u32 v7, v22, 2, s71
    v_lshrrev_b32 v22, 5, v1
    s_waitcnt lgkmcnt(4)
    v_mfma_f32_32x32x16_bf16 v[32:47], v[96:99], a[8:11], v[32:47]
    v_mfma_f32_16x16x32_bf16 a[196:199], a[192:195], v[96:99], a[196:199]
    ds_read_b64_tr_b16 v[112:113], v12 offset:12288
    ds_read_b64_tr_b16 v[114:115], v12 offset:13312
    ds_read_b64_tr_b16 v[116:117], v13 offset:12288
    buffer_load_dwordx4 v[240:243], v31, s[16:19], s62 offen offset:1024 sc1
    s_waitcnt vmcnt(7)
    v_cmp_ne_u32 vcc, s43, v27
    s_mov_b32 s51, 0
    s_cbranch_vccz L_ok6
L_lp7:
    s_sleep 1
    buffer_load_dwordx4 v[24:27], v19, s[16:19], 0 offen sc1
    s_waitcnt vmcnt(0)
    v_cmp_ne_u32 vcc, s43, v27
    s_add_u32 s51, s51, 1
    s_cmp_gt_u32 s51, 100000
    s_cbranch_scc1 L_ok6
    s_cbranch_vccnz L_lp7
L_ok6:
    v_rcp_f32 v28, v25
    v_mfma_f32_32x32x16_bf16 v[48:63], v[100:103], a[8:11], v[48:63]
    ds_read_b64_tr_b16 v[118:119], v13 offset:13312
    ds_read_b64_tr_b16 v[120:121], v14 offset:12288
    ds_read_b64_tr_b16 v[122:123], v14 offset:13312
    ds_read_b64_tr_b16 v[124:125], v15 offset:12288
    buffer_load_dwordx4 v[244:247], v31, s[16:19], s62 offen offset:2048 sc1
    v_cvt_pk_bf16_f32 v176, v24, v25
    s_waitcnt lgkmcnt(7)
    v_mfma_f32_32x32x16_bf16 v[64:79], v[104:107], a[8:11], v[64:79]
    ds_read_b64_tr_b16 v[126:127], v15 offset:13312
    buffer_load_dwordx4 v[248:251], v31, s[16:19], s62 offen offset:3072 sc1
    v_lshlrev_b32 v178, 16, v176
    v_mfma_f32_32x32x16_bf16 v[80:95], v[108:111], a[8:11], v[80:95]
    v_and_b32 v179, 0xffff0000, v176
    s_barrier
    s_waitcnt lgkmcnt(4)
    v_mfma_f32_32x32x16_bf16 v[32:47], v[112:115], a[12:15], v[32:47]
    v_mfma_f32_16x16x32_bf16 a[196:199], a[192:195], v[112:115], a[196:199]
    ds_read_b128 a[16:19], v8 offset:16384
    ds_read_b64_tr_b16 v[96:97], v12 offset:16384
    ds_read_b64_tr_b16 v[98:99], v12 offset:17408
    ds_read_b64_tr_b16 v[100:101], v13 offset:16384
    s_add_u32 s62, s70, 14336
    buffer_load_dwordx4 v[252:255], v31, s[16:19], s62 offen offset:0 sc1
    v_sub_f32 v178, v24, v178
    v_mfma_f32_32x32x16_bf16 v[48:63], v[116:119], a[12:15], v[48:63]
    ds_read_b64_tr_b16 v[102:103], v13 offset:17408
    ds_read_b64_tr_b16 v[104:105], v14 offset:16384
    ds_read_b64_tr_b16 v[106:107], v14 offset:17408
    s_add_u32 s62, s70, 15360
    buffer_load_dwordx4 a[200:203], v31, s[16:19], s62 offen offset:0 sc1
    v_sub_f32 v179, v25, v179
    s_waitcnt lgkmcnt(7)
    v_mfma_f32_32x32x16_bf16 v[64:79], v[120:123], a[12:15], v[64:79]
    ds_read_b64_tr_b16 v[108:109], v15 offset:16384
    ds_read_b64_tr_b16 v[110:111], v15 offset:17408
    buffer_load_dwordx4 a[204:207], v31, s[16:19], s62 offen offset:1024 sc1
    v_cvt_pk_bf16_f32 v177, v178, v179
    v_mfma_f32_32x32x16_bf16 v[80:95], v[124:127], a[12:15], v[80:95]
    ds_read_b128 a[20:23], v9 offset:16384
    ds_read_b64_tr_b16 v[160:161], v12 offset:20480
    ds_read_b64_tr_b16 v[162:163], v12 offset:21504
    ds_read_b64_tr_b16 v[164:165], v12 offset:24576
    v_mov_b32 v172, 0
    s_waitcnt lgkmcnt(8)
    v_mfma_f32_32x32x16_bf16 v[32:47], v[96:99], a[16:19], v[32:47]
    v_mfma_f32_16x16x32_bf16 a[196:199], a[192:195], v[96:99], a[196:199]
    ds_read_b64_tr_b16 v[112:113], v12 offset:20480
    ds_read_b64_tr_b16 v[114:115], v12 offset:21504
    ds_read_b64_tr_b16 v[116:117], v13 offset:20480
    buffer_load_dwordx4 a[208:211], v31, s[16:19], s62 offen offset:2048 sc1
    v_mov_b32 v173, 0
    v_mfma_f32_32x32x16_bf16 v[48:63], v[100:103], a[16:19], v[48:63]
    ds_read_b64_tr_b16 v[118:119], v13 offset:21504
    ds_read_b64_tr_b16 v[120:121], v14 offset:20480
    ds_read_b64_tr_b16 v[122:123], v14 offset:21504
    ds_read_b64_tr_b16 v[124:125], v15 offset:20480
    buffer_load_dwordx4 a[212:215], v31, s[16:19], s62 offen offset:3072 sc1
    v_mov_b32 v174, 0
    s_waitcnt lgkmcnt(11)
    v_mfma_f32_32x32x16_bf16 v[64:79], v[104:107], a[16:19], v[64:79]
    ds_read_b64_tr_b16 v[126:127], v15 offset:21504
    s_add_u32 s62, s70, 19456
    buffer_load_dwordx4 a[216:219], v31, s[16:19], s62 offen offset:0 sc1
    v_mov_b32 v175, 0
    v_mfma_f32_32x32x16_bf16 v[80:95], v[108:111], a[16:19], v[80:95]
    ds_read_b128 a[24:27], v10 offset:16384
    ds_read_b128 a[28:31], v11 offset:16384
    ds_read_b64_tr_b16 v[166:167], v12 offset:25600
    ds_read_b64_tr_b16 v[168:169], v12 offset:28672
    ds_read_b64_tr_b16 v[170:171], v12 offset:29696
    s_mov_b32 s48, 0x05040100
    s_mov_b32 exec_hi, 0
    v_perm_b32 v172, v177, v176, s48
    v_mov_b32 v173, v176
    v_lshrrev_b32 v174, 16, v177
    s_mov_b32 exec_hi, -1
    s_waitcnt lgkmcnt(9)
    v_mfma_f32_32x32x16_bf16 v[32:47], v[112:115], a[20:23], v[32:47]
    ds_read_b64_tr_b16 v[96:97], v12 offset:24576
    ds_read_b64_tr_b16 v[98:99], v12 offset:25600
    ds_read_b64_tr_b16 v[100:101], v13 offset:24576
    s_waitcnt lgkmcnt(3)
    v_mfma_f32_16x16x32_bf16 a[196:199], a[192:195], v[160:163], a[196:199]
    v_mfma_f32_16x16x32_bf16 a[196:199], a[192:195], v[164:167], a[196:199]
    v_mfma_f32_16x16x32_bf16 a[196:199], a[192:195], v[168:171], a[196:199]
    s_add_u32 s62, s70, 20480
    buffer_load_dwordx4 a[220:223], v31, s[16:19], s62 offen offset:0 sc1
    v_mfma_f32_32x32x16_bf16 v[48:63], v[116:119], a[20:23], v[48:63]
    ds_read_b64_tr_b16 v[102:103], v13 offset:25600
    ds_read_b64_tr_b16 v[104:105], v14 offset:24576
    ds_read_b64_tr_b16 v[106:107], v14 offset:25600
    ds_read_b64_tr_b16 v[108:109], v15 offset:24576
    buffer_load_dwordx4 a[224:227], v31, s[16:19], s62 offen offset:1024 sc1
    v_mfma_f32_32x32x16_bf16 v[64:79], v[120:123], a[20:23], v[64:79]
    ds_read_b64_tr_b16 v[110:111], v15 offset:25600
    buffer_load_dwordx4 a[228:231], v31, s[16:19], s62 offen offset:2048 sc1
    v_mfma_f32_32x32x16_bf16 v[80:95], v[124:127], a[20:23], v[80:95]
    v_accvgpr_read_b32 v16, a196
    v_accvgpr_read_b32 v17, a197
    s_mov_b64 exec, 0xffff
    ds_write2_b32 v4, v16, v17 offset0:0 offset1:16
    s_mov_b64 exec, -1
    s_waitcnt lgkmcnt(5)
    v_mfma_f32_32x32x16_bf16 v[32:47], v[96:99], a[24:27], v[32:47]
    ds_read_b64_tr_b16 v[112:113], v12 offset:28672
    ds_read_b64_tr_b16 v[114:115], v12 offset:29696
    ds_read_b64_tr_b16 v[116:117], v13 offset:28672
    buffer_load_dwordx4 a[232:235], v31, s[16:19], s62 offen offset:3072 sc1
    v_mfma_f32_32x32x16_bf16 v[48:63], v[100:103], a[24:27], v[48:63]
    ds_read_b64_tr_b16 v[118:119], v13 offset:29696
    ds_read_b64_tr_b16 v[120:121], v14 offset:28672
    ds_read_b64_tr_b16 v[122:123], v14 offset:29696
    ds_read_b64_tr_b16 v[124:125], v15 offset:28672
    s_add_u32 s62, s70, 24576
    buffer_load_dwordx4 a[236:239], v31, s[16:19], s62 offen offset:0 sc1
    s_waitcnt lgkmcnt(8)
    s_waitcnt lgkmcnt(7)
    s_barrier
    v_mfma_f32_32x32x16_bf16 v[64:79], v[104:107], a[24:27], v[64:79]
    ds_read_b64_tr_b16 v[126:127], v15 offset:29696
    s_add_u32 s62, s70, 25600
    buffer_load_dwordx4 a[32:35], v31, s[16:19], s62 offen offset:0 sc1
    ds_read2_b32 v[164:165], v4 offset0:0 offset1:128
    ds_read2_b32 v[170:171], v5 offset0:0 offset1:128
    ds_read2_b32 v[100:101], v6 offset0:0 offset1:128
    ds_read2_b32 v[106:107], v7 offset0:0 offset1:128
    v_mfma_f32_32x32x16_bf16 v[80:95], v[108:111], a[24:27], v[80:95]
    s_waitcnt lgkmcnt(8)
    v_mfma_f32_32x32x16_bf16 v[32:47], v[112:115], a[28:31], v[32:47]
    buffer_load_dwordx4 a[36:39], v31, s[16:19], s62 offen offset:1024 sc1
    s_waitcnt lgkmcnt(3)
    v_cvt_pk_bf16_f32 v160, v164, v164
    v_cvt_pk_bf16_f32 v162, v165, v165
    v_and_b32 v161, 0xffff0000, v160
    v_mov_b32 v163, 0
    v_sub_f32 v161, v164, v161
    v_cvt_pk_bf16_f32 v161, v161, v165
    v_mfma_f32_32x32x16_bf16 v[48:63], v[116:119], a[28:31], v[48:63]
    buffer_load_dwordx4 a[40:43], v31, s[16:19], s62 offen offset:2048 sc1
    s_waitcnt lgkmcnt(2)
    v_cvt_pk_bf16_f32 v166, v170, v170
    v_cvt_pk_bf16_f32 v168, v171, v171
    v_and_b32 v167, 0xffff0000, v166
    v_mov_b32 v169, 0
    v_sub_f32 v167, v170, v167
    v_cvt_pk_bf16_f32 v167, v167, v171
    v_mfma_f32_32x32x16_bf16 v[64:79], v[120:123], a[28:31], v[64:79]
    buffer_load_dwordx4 a[44:47], v31, s[16:19], s62 offen offset:3072 sc1
    s_waitcnt lgkmcnt(1)
    v_cvt_pk_bf16_f32 v96, v100, v100
    v_cvt_pk_bf16_f32 v98, v101, v101
    v_and_b32 v97, 0xffff0000, v96
    v_mov_b32 v99, 0
    v_sub_f32 v97, v100, v97
    v_cvt_pk_bf16_f32 v97, v97, v101
    v_mfma_f32_32x32x16_bf16 v[80:95], v[124:127], a[28:31], v[80:95]
    s_waitcnt lgkmcnt(0)
    v_cvt_pk_bf16_f32 v102, v106, v106
    v_cvt_pk_bf16_f32 v104, v107, v107
    v_and_b32 v103, 0xffff0000, v102
    v_mov_b32 v105, 0
    v_sub_f32 v103, v106, v103
    v_cvt_pk_bf16_f32 v103, v103, v107
    v_mfma_f32_32x32x16_bf16 v[32:47], v[160:163], v[172:175], v[32:47]
    v_mfma_f32_32x32x16_bf16 v[48:63], v[166:169], v[172:175], v[48:63]
    v_mfma_f32_32x32x16_bf16 v[64:79], v[96:99], v[172:175], v[64:79]
    v_mfma_f32_32x32x16_bf16 v[80:95], v[102:105], v[172:175], v[80:95]
    s_nop 8
    v_max_f32 v32, 0, v32
    v_max_f32 v33, 0, v33
    v_max_f32 v34, 0, v34
    v_max_f32 v35, 0, v35
    v_max_f32 v36, 0, v36
    v_max_f32 v37, 0, v37
    v_max_f32 v38, 0, v38
    s_add_u32 s62, s70, 29696
    buffer_load_dwordx4 a[48:51], v31, s[16:19], s62 offen offset:0 sc1
    v_max_f32 v39, 0, v39
    v_mul_f32 v32, v28, v32
    v_mul_f32 v33, v28, v33
    v_mul_f32 v34, v28, v34
    v_mul_f32 v35, v28, v35
    v_mul_f32 v36, v28, v36
    v_mul_f32 v37, v28, v37
    v_mul_f32 v38, v28, v38
    v_mul_f32 v39, v28, v39
    v_mul_f32 v32, v32, v32
    v_mul_f32 v33, v33, v33
    v_mul_f32 v34, v34, v34
    v_mul_f32 v35, v35, v35
    v_mul_f32 v36, v36, v36
    v_mul_f32 v37, v37, v37
    v_mul_f32 v38, v38, v38
    v_mul_f32 v39, v39, v39
    v_cvt_pk_bf16_f32 v32, v32, v33
    v_cvt_pk_bf16_f32 v33, v34, v35
    v_cvt_pk_bf16_f32 v34, v36, v37
    v_cvt_pk_bf16_f32 v35, v38, v39
    buffer_store_dwordx4 v[32:35], v30, s[16:19], s53 offen offset:0 sc1
    s_add_u32 s62, s70, 30720
    buffer_load_dwordx4 a[52:55], v31, s[16:19], s62 offen offset:0 sc1
    v_max_f32 v40, 0, v40
    v_max_f32 v41, 0, v41
    v_max_f32 v42, 0, v42
    v_max_f32 v43, 0, v43
    v_max_f32 v44, 0, v44
    v_max_f32 v45, 0, v45
    v_max_f32 v46, 0, v46
    v_max_f32 v47, 0, v47
    v_mul_f32 v40, v28, v40
    v_mul_f32 v41, v28, v41
    v_mul_f32 v42, v28, v42
    v_mul_f32 v43, v28, v43
    v_mul_f32 v44, v28, v44
    v_mul_f32 v45, v28, v45
    v_mul_f32 v46, v28, v46
    v_mul_f32 v47, v28, v47
    v_mul_f32 v40, v40, v40
    v_mul_f32 v41, v41, v41
    v_mul_f32 v42, v42, v42
    v_mul_f32 v43, v43, v43
    v_mul_f32 v44, v44, v44
    v_mul_f32 v45, v45, v45
    buffer_load_dwordx4 a[56:59], v31, s[16:19], s62 offen offset:1024 sc1
    v_mul_f32 v46, v46, v46
    v_mul_f32 v47, v47, v47
    v_cvt_pk_bf16_f32 v40, v40, v41
    v_cvt_pk_bf16_f32 v41, v42, v43
    v_cvt_pk_bf16_f32 v42, v44, v45
    v_cvt_pk_bf16_f32 v43, v46, v47
    buffer_store_dwordx4 v[40:43], v30, s[16:19], s53 offen offset:512 sc1
    v_max_f32 v48, 0, v48
    v_max_f32 v49, 0, v49
    v_max_f32 v50, 0, v50
    v_max_f32 v51, 0, v51
    v_max_f32 v52, 0, v52
    v_max_f32 v53, 0, v53
    v_max_f32 v54, 0, v54
    v_max_f32 v55, 0, v55
    v_mul_f32 v48, v28, v48
    v_mul_f32 v49, v28, v49
    v_mul_f32 v50, v28, v50
    v_mul_f32 v51, v28, v51
    v_mul_f32 v52, v28, v52
    v_mul_f32 v53, v28, v53
    buffer_load_dwordx4 a[60:63], v31, s[16:19], s62 offen offset:2048 sc1
    v_mul_f32 v54, v28, v54
    v_mul_f32 v55, v28, v55
    v_mul_f32 v48, v48, v48
    v_mul_f32 v49, v49, v49
    v_mul_f32 v50, v50, v50
    v_mul_f32 v51, v51, v51
    v_mul_f32 v52, v52, v52
    v_mul_f32 v53, v53, v53
    v_mul_f32 v54, v54, v54
    v_mul_f32 v55, v55, v55
    v_cvt_pk_bf16_f32 v48, v48, v49
    v_cvt_pk_bf16_f32 v49, v50, v51
    v_cvt_pk_bf16_f32 v50, v52, v53
    v_cvt_pk_bf16_f32 v51, v54, v55
    buffer_store_dwordx4 v[48:51], v30, s[16:19], s54 offen offset:0 sc1
    v_max_f32 v56, 0, v56
    v_max_f32 v57, 0, v57
    v_max_f32 v58, 0, v58
    v_max_f32 v59, 0, v59
    v_max_f32 v60, 0, v60
    v_max_f32 v61, 0, v61
    v_max_f32 v62, 0, v62
    buffer_load_dwordx4 a[64:67], v31, s[16:19], s62 offen offset:3072 sc1
    v_max_f32 v63, 0, v63
    v_mul_f32 v56, v28, v56
    v_mul_f32 v57, v28, v57
    v_mul_f32 v58, v28, v58
    v_mul_f32 v59, v28, v59
    v_mul_f32 v60, v28, v60
    v_mul_f32 v61, v28, v61
    v_mul_f32 v62, v28, v62
    v_mul_f32 v63, v28, v63
    v_mul_f32 v56, v56, v56
    v_mul_f32 v57, v57, v57
    v_mul_f32 v58, v58, v58
    v_mul_f32 v59, v59, v59
    v_mul_f32 v60, v60, v60
    v_mul_f32 v61, v61, v61
    v_mul_f32 v62, v62, v62
    v_mul_f32 v63, v63, v63
    v_cvt_pk_bf16_f32 v56, v56, v57
    v_cvt_pk_bf16_f32 v57, v58, v59
    v_cvt_pk_bf16_f32 v58, v60, v61
    v_cvt_pk_bf16_f32 v59, v62, v63
    buffer_store_dwordx4 v[56:59], v30, s[16:19], s54 offen offset:512 sc1
    v_max_f32 v64, 0, v64
    v_max_f32 v65, 0, v65
    v_max_f32 v66, 0, v66
    v_max_f32 v67, 0, v67
    v_max_f32 v68, 0, v68
    v_max_f32 v69, 0, v69
    v_max_f32 v70, 0, v70
    s_add_u32 s62, s70, 34816
    buffer_load_dwordx4 a[68:71], v31, s[16:19], s62 offen offset:0 sc1
    v_max_f32 v71, 0, v71
    v_mul_f32 v64, v28, v64
    v_mul_f32 v65, v28, v65
    v_mul_f32 v66, v28, v66
    v_mul_f32 v67, v28, v67
    v_mul_f32 v68, v28, v68
    v_mul_f32 v69, v28, v69
    v_mul_f32 v70, v28, v70
    v_mul_f32 v71, v28, v71
    v_mul_f32 v64, v64, v64
    v_mul_f32 v65, v65, v65
    v_mul_f32 v66, v66, v66
    v_mul_f32 v67, v67, v67
    v_mul_f32 v68, v68, v68
    v_mul_f32 v69, v69, v69
    v_mul_f32 v70, v70, v70
    v_mul_f32 v71, v71, v71
    v_cvt_pk_bf16_f32 v64, v64, v65
    v_cvt_pk_bf16_f32 v65, v66, v67
    v_cvt_pk_bf16_f32 v66, v68, v69
    v_cvt_pk_bf16_f32 v67, v70, v71
    buffer_store_dwordx4 v[64:67], v30, s[16:19], s55 offen offset:0 sc1
    s_add_u32 s62, s70, 35840
    buffer_load_dwordx4 a[72:75], v31, s[16:19], s62 offen offset:0 sc1
    v_max_f32 v72, 0, v72
    v_max_f32 v73, 0, v73
    v_max_f32 v74, 0, v74
    v_max_f32 v75, 0, v75
    v_max_f32 v76, 0, v76
    v_max_f32 v77, 0, v77
    v_max_f32 v78, 0, v78
    v_max_f32 v79, 0, v79
    v_mul_f32 v72, v28, v72
    v_mul_f32 v73, v28, v73
    v_mul_f32 v74, v28, v74
    v_mul_f32 v75, v28, v75
    v_mul_f32 v76, v28, v76
    v_mul_f32 v77, v28, v77
    v_mul_f32 v78, v28, v78
    v_mul_f32 v79, v28, v79
    v_mul_f32 v72, v72, v72
    v_mul_f32 v73, v73, v73
    v_mul_f32 v74, v74, v74
    v_mul_f32 v75, v75, v75
    v_mul_f32 v76, v76, v76
    v_mul_f32 v77, v77, v77
    buffer_load_dwordx4 a[76:79], v31, s[16:19], s62 offen offset:1024 sc1
    v_mul_f32 v78, v78, v78
    v_mul_f32 v79, v79, v79
    v_cvt_pk_bf16_f32 v72, v72, v73
    v_cvt_pk_bf16_f32 v73, v74, v75
    v_cvt_pk_bf16_f32 v74, v76, v77
    v_cvt_pk_bf16_f32 v75, v78, v79
    buffer_store_dwordx4 v[72:75], v30, s[16:19], s55 offen offset:512 sc1
    v_max_f32 v80, 0, v80
    v_max_f32 v81, 0, v81
    v_max_f32 v82, 0, v82
    v_max_f32 v83, 0, v83
    v_max_f32 v84, 0, v84
    v_max_f32 v85, 0, v85
    v_max_f32 v86, 0, v86
    v_max_f32 v87, 0, v87
    v_mul_f32 v80, v28, v80
    v_mul_f32 v81, v28, v81
    v_mul_f32 v82, v28, v82
    v_mul_f32 v83, v28, v83
    v_mul_f32 v84, v28, v84
    v_mul_f32 v85, v28, v85
    buffer_load_dwordx4 a[80:83], v31, s[16:19], s62 offen offset:2048 sc1
    v_mul_f32 v86, v28, v86
    v_mul_f32 v87, v28, v87
    v_mul_f32 v80, v80, v80
    v_mul_f32 v81, v81, v81
    v_mul_f32 v82, v82, v82
    v_mul_f32 v83, v83, v83
    v_mul_f32 v84, v84, v84
    v_mul_f32 v85, v85, v85
    v_mul_f32 v86, v86, v86
    v_mul_f32 v87, v87, v87
    v_cvt_pk_bf16_f32 v80, v80, v81
    v_cvt_pk_bf16_f32 v81, v82, v83
    v_cvt_pk_bf16_f32 v82, v84, v85
    v_cvt_pk_bf16_f32 v83, v86, v87
    buffer_store_dwordx4 v[80:83], v30, s[16:19], s56 offen offset:0 sc1
    v_max_f32 v88, 0, v88
    v_max_f32 v89, 0, v89
    v_max_f32 v90, 0, v90
    v_max_f32 v91, 0, v91
    v_max_f32 v92, 0, v92
    v_max_f32 v93, 0, v93
    v_max_f32 v94, 0, v94
    buffer_load_dwordx4 a[84:87], v31, s[16:19], s62 offen offset:3072 sc1
    v_max_f32 v95, 0, v95
    v_mul_f32 v88, v28, v88
    v_mul_f32 v89, v28, v89
    v_mul_f32 v90, v28, v90
    v_mul_f32 v91, v28, v91
    v_mul_f32 v92, v28, v92
    v_mul_f32 v93, v28, v93
    v_mul_f32 v94, v28, v94
    v_mul_f32 v95, v28, v95
    v_mul_f32 v88, v88, v88
    v_mul_f32 v89, v89, v89
    v_mul_f32 v90, v90, v90
    v_mul_f32 v91, v91, v91
    v_mul_f32 v92, v92, v92
    v_mul_f32 v93, v93, v93
    v_mul_f32 v94, v94, v94
    v_mul_f32 v95, v95, v95
    v_cvt_pk_bf16_f32 v88, v88, v89
    v_cvt_pk_bf16_f32 v89, v90, v91
    v_cvt_pk_bf16_f32 v90, v92, v93
    v_cvt_pk_bf16_f32 v91, v94, v95
    buffer_store_dwordx4 v[88:91], v30, s[16:19], s56 offen offset:512 sc1
    v_and_b32 v144, 15, v1
    v_lshrrev_b32 v145, 4, v1
    s_lshl_b32 s45, s30, 2
    v_add_u32 v145, s45, v145
    v_sub_u32 v146, 32, v145
    v_cmp_eq_u32 vcc, 0, v145
    s_nop 1
    v_cndmask_b32 v146, v146, 16, vcc
    s_mov_b32 s46, 0x3a000000
    s_cmp_ge_u32 s42, 4
    s_cselect_b32 s46, s46, 0xba000000
    v_cvt_f32_u32 v145, v145
    v_cvt_f32_u32 v146, v146
    v_add_f32 v147, 0x42000000, v145
    v_add_f32 v148, 0x42000000, v146
    v_lshlrev_b32 v144, 6, v144
    s_add_u32 s62, s70, 39936
    buffer_load_dwordx4 a[88:91], v31, s[16:19], s62 offen offset:0 sc1
    v_add_u32 v149, s78, v144
    v_cvt_f32_u32 v149, v149
    v_mul_f32 v149, s46, v149
    v_mul_f32 v150, v149, v145
    v_mul_f32 v151, v149, v147
    v_mul_f32 v152, v149, v146
    v_mul_f32 v153, v149, v148
    v_cos_f32 v154, v150
    v_sin_f32 v150, v150
    v_cos_f32 v155, v151
    v_sin_f32 v151, v151
    v_cos_f32 v156, v152
    v_sin_f32 v152, v152
    v_cos_f32 v157, v153
    s_add_u32 s62, s70, 40960
    buffer_load_dwordx4 a[92:95], v31, s[16:19], s62 offen offset:0 sc1
    v_sin_f32 v153, v153
    v_cvt_pk_bf16_f32 v150, v154, v150
    v_cvt_pk_bf16_f32 v151, v155, v151
    v_cvt_pk_bf16_f32 v152, v156, v152
    v_cvt_pk_bf16_f32 v153, v157, v153
    v_accvgpr_write_b32 a160, v150
    v_accvgpr_write_b32 a161, v151
    v_accvgpr_write_b32 a162, v152
    v_accvgpr_write_b32 a163, v153
    v_add_u32 v149, s79, v144
    v_cvt_f32_u32 v149, v149
    v_mul_f32 v149, s46, v149
    v_mul_f32 v150, v149, v145
    v_mul_f32 v151, v149, v147
    buffer_load_dwordx4 a[96:99], v31, s[16:19], s62 offen offset:1024 sc1
    v_mul_f32 v152, v149, v146
    v_mul_f32 v153, v149, v148
    v_cos_f32 v154, v150
    v_sin_f32 v150, v150
    v_cos_f32 v155, v151
    v_sin_f32 v151, v151
    v_cos_f32 v156, v152
    v_sin_f32 v152, v152
    v_cos_f32 v157, v153
    v_sin_f32 v153, v153
    v_cvt_pk_bf16_f32 v150, v154, v150
    s_waitcnt vmcnt(3)
    s_add_u32 s68, s57, 294912
    v_mov_b32 v193, 0
    v_mov_b32 v194, s43
    s_mov_b64 exec, 1
    buffer_store_dword v194, v193, s[16:19], s68 offen sc1
    s_mov_b64 exec, -1
    v_cvt_pk_bf16_f32 v151, v155, v151
    v_cvt_pk_bf16_f32 v152, v156, v152
    buffer_load_dwordx4 a[100:103], v31, s[16:19], s62 offen offset:2048 sc1
    v_cvt_pk_bf16_f32 v153, v157, v153
    v_accvgpr_write_b32 a164, v150
    v_accvgpr_write_b32 a165, v151
    v_accvgpr_write_b32 a166, v152
    v_accvgpr_write_b32 a167, v153
    v_add_u32 v149, s80, v144
    v_cvt_f32_u32 v149, v149
    v_mul_f32 v149, s46, v149
    v_mul_f32 v150, v149, v145
    v_mul_f32 v151, v149, v147
    v_mul_f32 v152, v149, v146
    v_mul_f32 v153, v149, v148
    v_cos_f32 v154, v150
    v_sin_f32 v150, v150
    buffer_load_dwordx4 a[104:107], v31, s[16:19], s62 offen offset:3072 sc1
    v_cos_f32 v155, v151
    v_sin_f32 v151, v151
    v_cos_f32 v156, v152
    v_sin_f32 v152, v152
    v_cos_f32 v157, v153
    v_sin_f32 v153, v153
    v_cvt_pk_bf16_f32 v150, v154, v150
    v_cvt_pk_bf16_f32 v151, v155, v151
    v_cvt_pk_bf16_f32 v152, v156, v152
    v_cvt_pk_bf16_f32 v153, v157, v153
    v_accvgpr_write_b32 a168, v150
    v_accvgpr_write_b32 a169, v151
    v_accvgpr_write_b32 a170, v152
    v_accvgpr_write_b32 a171, v153
    s_add_u32 s62, s70, 45056
    buffer_load_dwordx4 a[108:111], v31, s[16:19], s62 offen offset:0 sc1
    v_add_u32 v149, s81, v144
    v_cvt_f32_u32 v149, v149
    v_mul_f32 v149, s46, v149
    v_mul_f32 v150, v149, v145
    v_mul_f32 v151, v149, v147
    v_mul_f32 v152, v149, v146
    v_mul_f32 v153, v149, v148
    v_cos_f32 v154, v150
    v_sin_f32 v150, v150
    v_cos_f32 v155, v151
    v_sin_f32 v151, v151
    v_cos_f32 v156, v152
    v_sin_f32 v152, v152
    s_add_u32 s62, s70, 46080
    buffer_load_dwordx4 a[112:115], v31, s[16:19], s62 offen offset:0 sc1
    v_cos_f32 v157, v153
    v_sin_f32 v153, v153
    v_cvt_pk_bf16_f32 v150, v154, v150
    v_cvt_pk_bf16_f32 v151, v155, v151
    v_cvt_pk_bf16_f32 v152, v156, v152
    v_cvt_pk_bf16_f32 v153, v157, v153
    v_accvgpr_write_b32 a172, v150
    v_accvgpr_write_b32 a173, v151
    v_accvgpr_write_b32 a174, v152
    v_accvgpr_write_b32 a175, v153
    s_mul_i32 s82, s81, 1280
    s_mul_i32 s71, s79, 1280
    s_and_b32 s45, s78, 1024
    s_and_b32 s78, s78, 63
    buffer_load_dwordx4 a[116:119], v31, s[16:19], s62 offen offset:1024 sc1
    s_mul_i32 s78, s78, 54
    s_add_u32 s78, s78, s61
    s_lshl_b32 s78, s78, 11
    s_add_u32 s78, s78, s45
    v_add_u32 v184, s78, v31
    v_add_u32 v188, s78, v192
    s_and_b32 s45, s79, 1024
    s_and_b32 s79, s79, 63
    s_mul_i32 s79, s79, 54
    s_add_u32 s79, s79, s61
    s_lshl_b32 s79, s79, 11
    s_add_u32 s79, s79, s45
    v_add_u32 v185, s79, v31
    v_add_u32 v189, s79, v192
    buffer_load_dwordx4 a[120:123], v31, s[16:19], s62 offen offset:2048 sc1
    s_and_b32 s45, s80, 1024
    s_and_b32 s80, s80, 63
    s_mul_i32 s80, s80, 54
    s_add_u32 s80, s80, s61
    s_lshl_b32 s80, s80, 11
    s_add_u32 s80, s80, s45
    v_add_u32 v186, s80, v31
    v_add_u32 v190, s80, v192
    s_and_b32 s45, s81, 1024
    s_and_b32 s81, s81, 63
    s_mul_i32 s81, s81, 54
    s_add_u32 s81, s81, s61
    s_lshl_b32 s81, s81, 11
    s_add_u32 s81, s81, s45
    buffer_load_dwordx4 a[124:127], v31, s[16:19], s62 offen offset:3072 sc1
    v_add_u32 v187, s81, v31
    v_add_u32 v191, s81, v192
    s_mov_b32 s36, 0
    s_movk_i32 s64, 26624
    s_movk_i32 s38, 4096
    s_movk_i32 s40, 8192
    s_movk_i32 s54, 12288
    s_movk_i32 s56, 16384
    s_movk_i32 s59, 20480
    s_movk_i32 s63, 24576
    s_mul_i32 s83, s42, 160
    s_add_u32 s82, s82, s83
    s_add_u32 s71, s71, s83
    s_mov_b32 s45, 81920
    s_add_u32 s62, s70, 50176
    buffer_load_dwordx4 a[128:131], v31, s[16:19], s62 offen offset:0 sc1
    v_and_b32 v144, 15, v1
    v_mul_lo_u32 v144, s45, v144
    v_lshrrev_b32 v145, 4, v1
    v_lshl_add_u32 v10, v145, 4, v144
    v_lshl_add_u32 v11, v145, 3, v144
    v_lshl_add_u32 v12, v145, 4, s83
    v_lshl_add_u32 v146, v145, 3, s83
    buffer_load_dwordx4 v[160:163], v10, s[4:7], s71 offen
    buffer_load_dwordx4 v[164:167], v10, s[4:7], s71 offen offset:64
    buffer_load_dwordx2 v[168:169], v11, s[4:7], s71 offen offset:128
    global_load_dwordx4 v[172:175], v12, s[26:27]
    global_load_dwordx4 v[176:179], v12, s[26:27] offset:64
    global_load_dwordx2 v[180:181], v146, s[26:27] offset:128
    s_and_b32 s46, s2, 15
    s_add_u32 s62, s70, 51200
    buffer_load_dwordx4 a[132:135], v31, s[16:19], s62 offen offset:0 sc1
    s_lshr_b32 s47, s30, 1
    s_lshl_b32 s47, s47, 4
    s_add_u32 s46, s46, s47
    s_and_b32 s47, s30, 1
    s_mul_i32 s47, s47, 96
    s_add_u32 s46, s46, s47
    s_lshl_b32 s46, s46, 2
    s_lshl_b32 s47, s31, 1
    s_add_u32 s46, s46, s47
    v_lshrrev_b32 v144, 1, v1
    v_lshlrev_b32 v144, 7, v144
    v_and_b32 v145, 1, v1
    v_add3_u32 v144, v144, v145, s46
    buffer_load_dwordx4 a[136:139], v31, s[16:19], s62 offen offset:1024 sc1
    v_lshlrev_b32 v2, 7, v144
    v_add_u32 v2, 12255232, v2
    s_sub_u32 s66, 32, s41
    s_and_b32 s66, s66, 31
    s_cmp_ge_u32 s42, 4
    s_cselect_b32 s66, s66, s41
    v_and_b32 v144, 7, v1
    v_min_u32 v144, 4, v144
    v_lshlrev_b32 v146, 5, v144
    v_add_u32 v147, 192, v146
    v_add_u32 v146, 112, v146
    v_cmp_gt_u32 vcc, 2, v144
    s_nop 1
    v_cndmask_b32 v144, v146, v147, vcc
    v_and_b32 v145, 8, v1
    v_bfe_u32 v147, v1, 4, 1
    v_add3_u32 v144, v144, v145, v147
    buffer_load_dwordx4 a[140:143], v31, s[16:19], s62 offen offset:2048 sc1
    s_lshl_b32 s45, s30, 3
    s_lshr_b32 s47, s66, 3
    s_add_u32 s45, s45, s47
    v_lshl_add_u32 v144, v144, 2, s45
    v_lshlrev_b32 v3, 7, v144
    v_add_u32 v3, 11960324, v3
    v_lshrrev_b32 v145, 4, v1
    v_and_b32 v144, 15, v1
    s_mul_i32 s45, s42, 80
    v_and_b32 v148, 12, v1
    v_add3_u32 v148, v148, v144, s45
    v_add_u32 v144, s45, v144
    s_movk_i32 s46, 5120
    v_mul_u32_u24 v145, s46, v145
    buffer_load_dwordx4 a[144:147], v31, s[16:19], s62 offen offset:3072 sc1
    s_cmp_ge_u32 s42, 4
    s_cselect_b32 s45, -1, 0
    s_cselect_b32 s46, 640, -1
    v_add_u32 v146, 0, v148
    v_xor_b32 v146, s45, v146
    v_add_u32 v146, s46, v146
    v_sub_u32 v149, 478, v146
    v_cmp_lt_i32 vcc, 159, v146
    s_nop 1
    v_cndmask_b32 v149, v146, v149, vcc
    v_cmp_eq_u32 vcc, 319, v146
    s_nop 1
    v_cndmask_b32 v149, v149, v146, vcc
    v_lshl_add_u32 v5, v149, 4, v145
    v_mov_b32 v147, 1073741824
    v_cmp_gt_i32 vcc, 0, v146
    s_nop 1
    v_cndmask_b32 v5, v5, v147, vcc
    v_add_u32 v146, 4, v148
    v_xor_b32 v146, s45, v146
    v_add_u32 v146, s46, v146
    v_sub_u32 v149, 478, v146
    s_add_u32 s62, s70, 55296
    buffer_load_dwordx4 a[148:151], v31, s[16:19], s62 offen offset:0 sc1
    v_cmp_lt_i32 vcc, 159, v146
    s_nop 1
    v_cndmask_b32 v149, v146, v149, vcc
    v_lshl_add_u32 v6, v149, 4, v145
    v_add_u32 v146, 32, v148
    v_xor_b32 v146, s45, v146
    v_add_u32 v146, s46, v146
    v_sub_u32 v149, 478, v146
    v_cmp_lt_i32 vcc, 159, v146
    s_nop 1
    v_cndmask_b32 v149, v146, v149, vcc
    v_lshl_add_u32 v7, v149, 4, v145
    v_add_u32 v146, 36, v148
    v_xor_b32 v146, s45, v146
    v_add_u32 v146, s46, v146
    v_sub_u32 v149, 478, v146
    v_cmp_lt_i32 vcc, 159, v146
    s_nop 1
    v_cndmask_b32 v149, v146, v149, vcc
    v_lshl_add_u32 v8, v149, 4, v145
    s_add_u32 s62, s70, 56320
    buffer_load_dwordx4 a[240:243], v31, s[16:19], s62 offen offset:0 sc1
    v_add_u32 v146, 64, v144
    v_xor_b32 v146, s45, v146
    v_add_u32 v146, s46, v146
    v_sub_u32 v149, 478, v146
    v_cmp_lt_i32 vcc, 159, v146
    s_nop 1
    v_cndmask_b32 v149, v146, v149, vcc
    v_lshl_add_u32 v9, v149, 4, v145
    s_lshl_b32 s65, s66, 4
    s_lshl_b32 s45, s30, 2
    s_add_u32 s65, s65, s45
    s_mul_i32 s65, s65, 5120
    s_add_u32 s65, s65, 7077888
    s_mul_i32 s45, s30, 15360
    s_add_u32 s45, s45, 0
    v_add_u32 v13, s45, v31
    buffer_load_dwordx4 a[244:247], v31, s[16:19], s62 offen offset:1024 sc1
    s_xor_b32 s45, s30, 2
    s_mul_i32 s45, s45, 15360
    s_add_u32 s45, s45, 0
    v_add_u32 v14, s45, v31
    s_add_u32 s45, s30, 1
    s_and_b32 s45, s45, 3
    s_mul_i32 s45, s45, 15360
    s_add_u32 s45, s45, 0
    v_add_u32 v15, s45, v31
    s_add_u32 s45, s30, 3
    s_and_b32 s45, s45, 3
    s_mul_i32 s45, s45, 15360
    s_add_u32 s45, s45, 0
    v_add_u32 v0, s45, v31
    buffer_load_dwordx4 a[248:251], v31, s[16:19], s62 offen offset:2048 sc1
    v_mov_b32 v1, v31
    s_mov_b64 exec, 0x3ff
    buffer_load_dword v4, v2, s[16:19], 0 offen sc1
    s_mov_b64 exec, -1
    s_waitcnt vmcnt(9)
    s_mov_b32 s45, 0x05040100
    s_mov_b32 s46, 0x07060302
    v_perm_b32 v36, v172, v160, s45
    buffer_load_dwordx4 a[252:255], v1, s[16:19], s62 offen offset:3072 sc1
    v_perm_b32 v37, v172, v160, s46
    v_perm_b32 v38, v173, v161, s45
    v_perm_b32 v39, v173, v161, s46
    v_perm_b32 v40, v174, v162, s45
    s_add_u32 s62, s70, 60416
    buffer_load_dwordx4 a[152:155], v1, s[16:19], s62 offen offset:0 sc1
    v_perm_b32 v41, v174, v162, s46
    v_perm_b32 v42, v175, v163, s45
    v_perm_b32 v43, v175, v163, s46
    s_add_u32 s62, s70, 61440
    buffer_load_dwordx4 a[0:3], v1, s[16:19], s62 offen offset:0 sc1
    v_perm_b32 v44, v176, v164, s45
    v_perm_b32 v45, v176, v164, s46
    v_perm_b32 v46, v177, v165, s45
    v_perm_b32 v47, v177, v165, s46
    buffer_load_dwordx4 a[4:7], v1, s[16:19], s62 offen offset:1024 sc1
    v_perm_b32 v48, v178, v166, s45
    v_perm_b32 v49, v178, v166, s46
    v_perm_b32 v50, v179, v167, s45
    buffer_load_dwordx4 a[8:11], v1, s[16:19], s62 offen offset:2048 sc1
    v_perm_b32 v51, v179, v167, s46
    v_perm_b32 v52, v180, v168, s45
    v_perm_b32 v53, v180, v168, s46
    v_perm_b32 v54, v181, v169, s45
    buffer_load_dwordx4 a[12:15], v1, s[16:19], s62 offen offset:3072 sc1
    v_perm_b32 v55, v181, v169, s46
    v_dot2_f32_bf16 v36, v36, s44, 0
    v_dot2_f32_bf16 v37, v37, s44, 0
    s_add_u32 s62, s70, 65536
    buffer_load_dwordx4 a[156:159], v1, s[16:19], s62 offen offset:0 sc1
    v_dot2_f32_bf16 v38, v38, s44, 0
    v_dot2_f32_bf16 v39, v39, s44, 0
    v_dot2_f32_bf16 v40, v40, s44, 0
    v_dot2_f32_bf16 v41, v41, s44, 0
    s_add_u32 s62, s70, 66560
    buffer_load_dwordx4 a[16:19], v192, s[16:19], s62 offen offset:0 sc1
    v_dot2_f32_bf16 v42, v42, s44, 0
    v_dot2_f32_bf16 v43, v43, s44, 0
    v_dot2_f32_bf16 v44, v44, s44, 0
    buffer_load_dwordx4 a[20:23], v192, s[16:19], s62 offen offset:1024 sc1
    v_dot2_f32_bf16 v45, v45, s44, 0
    v_dot2_f32_bf16 v46, v46, s44, 0
    v_dot2_f32_bf16 v47, v47, s44, 0
    v_dot2_f32_bf16 v48, v48, s44, 0
    buffer_load_dwordx4 a[24:27], v192, s[16:19], s62 offen offset:2048 sc1
    v_dot2_f32_bf16 v49, v49, s44, 0
    v_dot2_f32_bf16 v50, v50, s44, 0
    v_dot2_f32_bf16 v51, v51, s44, 0
    buffer_load_dwordx4 a[28:31], v192, s[16:19], s62 offen offset:3072 sc1
    v_dot2_f32_bf16 v52, v52, s44, 0
    v_dot2_f32_bf16 v53, v53, s44, 0
    v_dot2_f32_bf16 v54, v54, s44, 0
    v_dot2_f32_bf16 v55, v55, s44, 0
    s_add_u32 s62, s70, 70656
    buffer_load_dwordx4 a[196:199], v192, s[16:19], s62 offen offset:0 sc1
    s_waitcnt vmcnt(12)
    s_mov_b32 exec_lo, 0x3ff
    s_mov_b32 exec_hi, 0x0
    v_cmp_ne_u32 vcc, s43, v4
    s_mov_b32 s51, 0
    s_cbranch_vccz L_ok8
L_lp9:
    s_sleep 1
    buffer_load_dword v4, v2, s[16:19], 0 offen sc1
    s_waitcnt vmcnt(0)
    v_cmp_ne_u32 vcc, s43, v4
    s_add_u32 s51, s51, 1
    s_cmp_gt_u32 s51, 100000
    s_cbranch_scc1 L_ok8
    s_cbranch_vccnz L_lp9
L_ok8:
    s_mov_b64 exec, -1
    buffer_load_dwordx4 v[96:99], v184, s[16:19], s36 offen offset:0 sc1
    buffer_load_dwordx4 v[100:103], v184, s[16:19], s36 offen offset:2048 sc1
    buffer_load_dwordx4 v[104:107], v184, s[16:19], s38 offen offset:0 sc1
    buffer_load_dwordx4 v[108:111], v184, s[16:19], s38 offen offset:2048 sc1
    buffer_load_dwordx4 v[112:115], v184, s[16:19], s40 offen offset:0 sc1
    buffer_load_dwordx4 v[116:119], v184, s[16:19], s40 offen offset:2048 sc1
    buffer_load_dwordx4 v[120:123], v184, s[16:19], s54 offen offset:0 sc1
    buffer_load_dwordx4 v[124:127], v184, s[16:19], s54 offen offset:2048 sc1
    buffer_load_dwordx4 v[128:131], v184, s[16:19], s56 offen offset:0 sc1
    buffer_load_dwordx4 v[132:135], v184, s[16:19], s56 offen offset:2048 sc1
    s_waitcnt vmcnt(9)
    v_mfma_f32_16x16x32_bf16 v[16:19], v[196:199], v[96:99], 0
    v_mfma_f32_16x16x32_bf16 v[20:23], v[200:203], v[96:99], 0
    v_mfma_f32_16x16x32_bf16 v[24:27], v[204:207], v[96:99], 0
    v_mfma_f32_16x16x32_bf16 v[28:31], v[208:211], v[96:99], 0
    v_mfma_f32_16x16x32_bf16 v[32:35], v[212:215], v[96:99], 0
    buffer_load_dwordx4 v[96:99], v184, s[16:19], s59 offen offset:0 sc1
    s_waitcnt vmcnt(9)
    v_mfma_f32_16x16x32_bf16 v[16:19], v[216:219], v[100:103], v[16:19]
    v_mfma_f32_16x16x32_bf16 v[20:23], v[220:223], v[100:103], v[20:23]
    v_mfma_f32_16x16x32_bf16 v[24:27], v[224:227], v[100:103], v[24:27]
    v_mfma_f32_16x16x32_bf16 v[28:31], v[228:231], v[100:103], v[28:31]
    v_mfma_f32_16x16x32_bf16 v[32:35], v[232:235], v[100:103], v[32:35]
    buffer_load_dwordx4 v[100:103], v184, s[16:19], s59 offen offset:2048 sc1
    s_waitcnt vmcnt(9)
    v_mfma_f32_16x16x32_bf16 v[16:19], v[236:239], v[104:107], v[16:19]
    v_mfma_f32_16x16x32_bf16 v[20:23], v[240:243], v[104:107], v[20:23]
    v_mfma_f32_16x16x32_bf16 v[24:27], v[244:247], v[104:107], v[24:27]
    v_mfma_f32_16x16x32_bf16 v[28:31], v[248:251], v[104:107], v[28:31]
    v_mfma_f32_16x16x32_bf16 v[32:35], v[252:255], v[104:107], v[32:35]
    buffer_load_dwordx4 v[104:107], v184, s[16:19], s63 offen offset:0 sc1
    s_waitcnt vmcnt(9)
    v_mfma_f32_16x16x32_bf16 v[16:19], a[200:203], v[108:111], v[16:19]
    v_mfma_f32_16x16x32_bf16 v[20:23], a[204:207], v[108:111], v[20:23]
    v_mfma_f32_16x16x32_bf16 v[24:27], a[208:211], v[108:111], v[24:27]
    v_mfma_f32_16x16x32_bf16 v[28:31], a[212:215], v[108:111], v[28:31]
    v_mfma_f32_16x16x32_bf16 v[32:35], a[216:219], v[108:111], v[32:35]
    buffer_load_dwordx4 v[108:111], v188, s[16:19], s63 offen offset:2048 sc1
    s_waitcnt vmcnt(9)
    v_mfma_f32_16x16x32_bf16 v[16:19], a[220:223], v[112:115], v[16:19]
    v_mfma_f32_16x16x32_bf16 v[20:23], a[224:227], v[112:115], v[20:23]
    v_mfma_f32_16x16x32_bf16 v[24:27], a[228:231], v[112:115], v[24:27]
    v_mfma_f32_16x16x32_bf16 v[28:31], a[232:235], v[112:115], v[28:31]
    v_mfma_f32_16x16x32_bf16 v[32:35], a[236:239], v[112:115], v[32:35]
    buffer_load_dwordx4 v[112:115], v185, s[16:19], s36 offen offset:0 sc1
    s_waitcnt vmcnt(9)
    v_mfma_f32_16x16x32_bf16 v[16:19], a[32:35], v[116:119], v[16:19]
    v_mfma_f32_16x16x32_bf16 v[20:23], a[36:39], v[116:119], v[20:23]
    v_mfma_f32_16x16x32_bf16 v[24:27], a[40:43], v[116:119], v[24:27]
    v_mfma_f32_16x16x32_bf16 v[28:31], a[44:47], v[116:119], v[28:31]
    v_mfma_f32_16x16x32_bf16 v[32:35], a[48:51], v[116:119], v[32:35]
    buffer_load_dwordx4 v[116:119], v185, s[16:19], s36 offen offset:2048 sc1
    s_waitcnt vmcnt(9)
    v_mfma_f32_16x16x32_bf16 v[16:19], a[52:55], v[120:123], v[16:19]
    v_mfma_f32_16x16x32_bf16 v[20:23], a[56:59], v[120:123], v[20:23]
    v_mfma_f32_16x16x32_bf16 v[24:27], a[60:63], v[120:123], v[24:27]
    v_mfma_f32_16x16x32_bf16 v[28:31], a[64:67], v[120:123], v[28:31]
    v_mfma_f32_16x16x32_bf16 v[32:35], a[68:71], v[120:123], v[32:35]
    buffer_load_dwordx4 v[120:123], v185, s[16:19], s38 offen offset:0 sc1
    s_waitcnt vmcnt(9)
    v_mfma_f32_16x16x32_bf16 v[16:19], a[72:75], v[124:127], v[16:19]
    v_mfma_f32_16x16x32_bf16 v[20:23], a[76:79], v[124:127], v[20:23]
    v_mfma_f32_16x16x32_bf16 v[24:27], a[80:83], v[124:127], v[24:27]
    v_mfma_f32_16x16x32_bf16 v[28:31], a[84:87], v[124:127], v[28:31]
    v_mfma_f32_16x16x32_bf16 v[32:35], a[88:91], v[124:127], v[32:35]
    buffer_load_dwordx4 v[124:127], v185, s[16:19], s38 offen offset:2048 sc1
    s_waitcnt vmcnt(9)
    v_mfma_f32_16x16x32_bf16 v[16:19], a[92:95], v[128:131], v[16:19]
    v_mfma_f32_16x16x32_bf16 v[20:23], a[96:99], v[128:131], v[20:23]
    v_mfma_f32_16x16x32_bf16 v[24:27], a[100:103], v[128:131], v[24:27]
    v_mfma_f32_16x16x32_bf16 v[28:31], a[104:107], v[128:131], v[28:31]
    v_mfma_f32_16x16x32_bf16 v[32:35], a[108:111], v[128:131], v[32:35]
    buffer_load_dwordx4 v[128:131], v185, s[16:19], s40 offen offset:0 sc1
    s_waitcnt vmcnt(9)
    v_mfma_f32_16x16x32_bf16 v[16:19], a[112:115], v[132:135], v[16:19]
    v_mfma_f32_16x16x32_bf16 v[20:23], a[116:119], v[132:135], v[20:23]
    v_mfma_f32_16x16x32_bf16 v[24:27], a[120:123], v[132:135], v[24:27]
    v_mfma_f32_16x16x32_bf16 v[28:31], a[124:127], v[132:135], v[28:31]
    v_mfma_f32_16x16x32_bf16 v[32:35], a[128:131], v[132:135], v[32:35]
    buffer_load_dwordx4 v[132:135], v185, s[16:19], s40 offen offset:2048 sc1
    s_waitcnt vmcnt(9)
    v_mfma_f32_16x16x32_bf16 v[16:19], a[132:135], v[96:99], v[16:19]
    v_mfma_f32_16x16x32_bf16 v[20:23], a[136:139], v[96:99], v[20:23]
    s_mov_b32 exec_hi, 0
    buffer_load_dword v4, v3, s[16:19], 0 offen sc1
    s_mov_b32 exec_hi, -1
    v_mfma_f32_16x16x32_bf16 v[24:27], a[140:143], v[96:99], v[24:27]
    v_mfma_f32_16x16x32_bf16 v[28:31], a[144:147], v[96:99], v[28:31]
    v_mfma_f32_16x16x32_bf16 v[32:35], a[148:151], v[96:99], v[32:35]
    buffer_load_dwordx4 v[96:99], v185, s[16:19], s54 offen offset:0 sc1
    s_waitcnt vmcnt(10)
    v_mfma_f32_16x16x32_bf16 v[16:19], a[240:243], v[100:103], v[16:19]
    v_mfma_f32_16x16x32_bf16 v[20:23], a[244:247], v[100:103], v[20:23]
    v_mfma_f32_16x16x32_bf16 v[24:27], a[248:251], v[100:103], v[24:27]
    v_mfma_f32_16x16x32_bf16 v[28:31], a[252:255], v[100:103], v[28:31]
    v_mfma_f32_16x16x32_bf16 v[32:35], a[152:155], v[100:103], v[32:35]
    buffer_load_dwordx4 v[100:103], v185, s[16:19], s54 offen offset:2048 sc1
    s_waitcnt vmcnt(10)
    v_mfma_f32_16x16x32_bf16 v[16:19], a[0:3], v[104:107], v[16:19]
    v_mfma_f32_16x16x32_bf16 v[20:23], a[4:7], v[104:107], v[20:23]
    v_mfma_f32_16x16x32_bf16 v[24:27], a[8:11], v[104:107], v[24:27]
    v_mfma_f32_16x16x32_bf16 v[28:31], a[12:15], v[104:107], v[28:31]
    v_mfma_f32_16x16x32_bf16 v[32:35], a[156:159], v[104:107], v[32:35]
    buffer_load_dwordx4 v[104:107], v185, s[16:19], s56 offen offset:0 sc1
    s_waitcnt vmcnt(10)
    v_mfma_f32_16x16x32_bf16 v[16:19], a[16:19], v[108:111], v[16:19]
    v_mfma_f32_16x16x32_bf16 v[20:23], a[20:23], v[108:111], v[20:23]
    v_mfma_f32_16x16x32_bf16 v[24:27], a[24:27], v[108:111], v[24:27]
    v_mfma_f32_16x16x32_bf16 v[28:31], a[28:31], v[108:111], v[28:31]
    v_mfma_f32_16x16x32_bf16 v[32:35], a[196:199], v[108:111], v[32:35]
    buffer_load_dwordx4 v[108:111], v185, s[16:19], s56 offen offset:2048 sc1
    s_waitcnt vmcnt(10)
    v_mfma_f32_16x16x32_bf16 v[36:39], v[196:199], v[112:115], v[36:39]
    v_mfma_f32_16x16x32_bf16 v[40:43], v[200:203], v[112:115], v[40:43]
    v_mfma_f32_16x16x32_bf16 v[44:47], v[204:207], v[112:115], v[44:47]
    v_mfma_f32_16x16x32_bf16 v[48:51], v[208:211], v[112:115], v[48:51]
    v_mfma_f32_16x16x32_bf16 v[52:55], v[212:215], v[112:115], v[52:55]
    buffer_load_dwordx4 v[112:115], v185, s[16:19], s59 offen offset:0 sc1
    s_waitcnt vmcnt(10)
    v_mfma_f32_16x16x32_bf16 v[36:39], v[216:219], v[116:119], v[36:39]
    v_mfma_f32_16x16x32_bf16 v[40:43], v[220:223], v[116:119], v[40:43]
    v_mfma_f32_16x16x32_bf16 v[44:47], v[224:227], v[116:119], v[44:47]
    v_mfma_f32_16x16x32_bf16 v[48:51], v[228:231], v[116:119], v[48:51]
    v_mfma_f32_16x16x32_bf16 v[52:55], v[232:235], v[116:119], v[52:55]
    buffer_load_dwordx4 v[116:119], v185, s[16:19], s59 offen offset:2048 sc1
    s_waitcnt vmcnt(10)
    v_mfma_f32_16x16x32_bf16 v[36:39], v[236:239], v[120:123], v[36:39]
    v_mfma_f32_16x16x32_bf16 v[40:43], v[240:243], v[120:123], v[40:43]
    v_mfma_f32_16x16x32_bf16 v[44:47], v[244:247], v[120:123], v[44:47]
    v_mfma_f32_16x16x32_bf16 v[48:51], v[248:251], v[120:123], v[48:51]
    v_mfma_f32_16x16x32_bf16 v[52:55], v[252:255], v[120:123], v[52:55]
    buffer_load_dwordx4 v[120:123], v185, s[16:19], s63 offen offset:0 sc1
    s_waitcnt vmcnt(10)
    v_mfma_f32_16x16x32_bf16 v[36:39], a[200:203], v[124:127], v[36:39]
    v_mfma_f32_16x16x32_bf16 v[40:43], a[204:207], v[124:127], v[40:43]
    v_mfma_f32_16x16x32_bf16 v[44:47], a[208:211], v[124:127], v[44:47]
    v_mfma_f32_16x16x32_bf16 v[48:51], a[212:215], v[124:127], v[48:51]
    v_mfma_f32_16x16x32_bf16 v[52:55], a[216:219], v[124:127], v[52:55]
    buffer_load_dwordx4 v[124:127], v189, s[16:19], s63 offen offset:2048 sc1
    s_waitcnt vmcnt(10)
    v_mfma_f32_16x16x32_bf16 v[36:39], a[220:223], v[128:131], v[36:39]
    v_mfma_f32_16x16x32_bf16 v[40:43], a[224:227], v[128:131], v[40:43]
    v_mfma_f32_16x16x32_bf16 v[44:47], a[228:231], v[128:131], v[44:47]
    v_mfma_f32_16x16x32_bf16 v[48:51], a[232:235], v[128:131], v[48:51]
    v_mfma_f32_16x16x32_bf16 v[52:55], a[236:239], v[128:131], v[52:55]
    buffer_load_dwordx4 v[128:131], v186, s[16:19], s36 offen offset:0 sc1
    s_waitcnt vmcnt(10)
    v_mfma_f32_16x16x32_bf16 v[36:39], a[32:35], v[132:135], v[36:39]
    v_mfma_f32_16x16x32_bf16 v[40:43], a[36:39], v[132:135], v[40:43]
    v_mfma_f32_16x16x32_bf16 v[44:47], a[40:43], v[132:135], v[44:47]
    v_mfma_f32_16x16x32_bf16 v[48:51], a[44:47], v[132:135], v[48:51]
    v_mfma_f32_16x16x32_bf16 v[52:55], a[48:51], v[132:135], v[52:55]
    buffer_load_dwordx4 v[132:135], v186, s[16:19], s36 offen offset:2048 sc1
    s_waitcnt vmcnt(9)
    v_mfma_f32_16x16x32_bf16 v[36:39], a[52:55], v[96:99], v[36:39]
    v_mfma_f32_16x16x32_bf16 v[40:43], a[56:59], v[96:99], v[40:43]
    v_mfma_f32_16x16x32_bf16 v[44:47], a[60:63], v[96:99], v[44:47]
    v_mfma_f32_16x16x32_bf16 v[48:51], a[64:67], v[96:99], v[48:51]
    v_mfma_f32_16x16x32_bf16 v[52:55], a[68:71], v[96:99], v[52:55]
    buffer_load_dwordx4 v[96:99], v186, s[16:19], s38 offen offset:0 sc1
    s_waitcnt vmcnt(9)
    v_mfma_f32_16x16x32_bf16 v[36:39], a[72:75], v[100:103], v[36:39]
    v_mfma_f32_16x16x32_bf16 v[40:43], a[76:79], v[100:103], v[40:43]
    v_mfma_f32_16x16x32_bf16 v[44:47], a[80:83], v[100:103], v[44:47]
    v_mfma_f32_16x16x32_bf16 v[48:51], a[84:87], v[100:103], v[48:51]
    v_mfma_f32_16x16x32_bf16 v[52:55], a[88:91], v[100:103], v[52:55]
    buffer_load_dwordx4 v[100:103], v186, s[16:19], s38 offen offset:2048 sc1
    s_waitcnt vmcnt(9)
    v_mfma_f32_16x16x32_bf16 v[36:39], a[92:95], v[104:107], v[36:39]
    v_mfma_f32_16x16x32_bf16 v[40:43], a[96:99], v[104:107], v[40:43]
    s_mov_b32 exec_lo, 0xffffffff
    s_mov_b32 exec_hi, 0x0
    v_cmp_ne_u32 vcc, s43, v4
    s_mov_b32 s51, 0
    s_cbranch_vccz L_ok10
L_lp11:
    s_sleep 1
    buffer_load_dword v4, v3, s[16:19], 0 offen sc1
    s_waitcnt vmcnt(0)
    v_cmp_ne_u32 vcc, s43, v4
    s_add_u32 s51, s51, 1
    s_cmp_gt_u32 s51, 100000
    s_cbranch_scc1 L_ok10
    s_cbranch_vccnz L_lp11
L_ok10:
    s_mov_b64 exec, -1
    v_mfma_f32_16x16x32_bf16 v[44:47], a[100:103], v[104:107], v[44:47]
    v_mfma_f32_16x16x32_bf16 v[48:51], a[104:107], v[104:107], v[48:51]
    buffer_load_dwordx4 a[176:179], v5, s[16:19], s65 offen sc1
    v_mfma_f32_16x16x32_bf16 v[52:55], a[108:111], v[104:107], v[52:55]
    buffer_load_dwordx4 v[104:107], v186, s[16:19], s40 offen offset:0 sc1
    s_waitcnt vmcnt(10)
    v_mfma_f32_16x16x32_bf16 v[36:39], a[112:115], v[108:111], v[36:39]
    v_mfma_f32_16x16x32_bf16 v[40:43], a[116:119], v[108:111], v[40:43]
    v_mfma_f32_16x16x32_bf16 v[44:47], a[120:123], v[108:111], v[44:47]
    v_mfma_f32_16x16x32_bf16 v[48:51], a[124:127], v[108:111], v[48:51]
    buffer_load_dwordx4 a[180:183], v6, s[16:19], s65 offen sc1
    v_mfma_f32_16x16x32_bf16 v[52:55], a[128:131], v[108:111], v[52:55]
    buffer_load_dwordx4 v[108:111], v186, s[16:19], s40 offen offset:2048 sc1
    s_waitcnt vmcnt(11)
    v_mfma_f32_16x16x32_bf16 v[36:39], a[132:135], v[112:115], v[36:39]
    v_mfma_f32_16x16x32_bf16 v[40:43], a[136:139], v[112:115], v[40:43]
    v_mfma_f32_16x16x32_bf16 v[44:47], a[140:143], v[112:115], v[44:47]
    v_mfma_f32_16x16x32_bf16 v[48:51], a[144:147], v[112:115], v[48:51]
    buffer_load_dwordx4 a[184:187], v7, s[16:19], s65 offen sc1
    v_mfma_f32_16x16x32_bf16 v[52:55], a[148:151], v[112:115], v[52:55]
    buffer_load_dwordx4 v[112:115], v186, s[16:19], s54 offen offset:0 sc1
    s_waitcnt vmcnt(12)
    v_mfma_f32_16x16x32_bf16 v[36:39], a[240:243], v[116:119], v[36:39]
    v_mfma_f32_16x16x32_bf16 v[40:43], a[244:247], v[116:119], v[40:43]
    v_mfma_f32_16x16x32_bf16 v[44:47], a[248:251], v[116:119], v[44:47]
    v_mfma_f32_16x16x32_bf16 v[48:51], a[252:255], v[116:119], v[48:51]
    buffer_load_dwordx4 a[188:191], v8, s[16:19], s65 offen sc1
    v_mfma_f32_16x16x32_bf16 v[52:55], a[152:155], v[116:119], v[52:55]
    buffer_load_dwordx4 v[116:119], v186, s[16:19], s54 offen offset:2048 sc1
    s_waitcnt vmcnt(13)
    v_mfma_f32_16x16x32_bf16 v[36:39], a[0:3], v[120:123], v[36:39]
    v_mfma_f32_16x16x32_bf16 v[40:43], a[4:7], v[120:123], v[40:43]
    v_mfma_f32_16x16x32_bf16 v[44:47], a[8:11], v[120:123], v[44:47]
    v_mfma_f32_16x16x32_bf16 v[48:51], a[12:15], v[120:123], v[48:51]
    buffer_load_dwordx4 a[192:195], v9, s[16:19], s65 offen sc1
    v_mfma_f32_16x16x32_bf16 v[52:55], a[156:159], v[120:123], v[52:55]
    buffer_load_dwordx4 v[120:123], v186, s[16:19], s56 offen offset:0 sc1
    s_waitcnt vmcnt(14)
    v_mfma_f32_16x16x32_bf16 v[36:39], a[16:19], v[124:127], v[36:39]
    v_mfma_f32_16x16x32_bf16 v[40:43], a[20:23], v[124:127], v[40:43]
    v_mfma_f32_16x16x32_bf16 v[44:47], a[24:27], v[124:127], v[44:47]
    v_mfma_f32_16x16x32_bf16 v[48:51], a[28:31], v[124:127], v[48:51]
    v_mfma_f32_16x16x32_bf16 v[52:55], a[196:199], v[124:127], v[52:55]
    buffer_load_dwordx4 v[124:127], v186, s[16:19], s56 offen offset:2048 sc1
    s_waitcnt vmcnt(14)
    v_mfma_f32_16x16x32_bf16 v[56:59], v[196:199], v[128:131], 0
    v_mfma_f32_16x16x32_bf16 v[60:63], v[200:203], v[128:131], 0
    v_mfma_f32_16x16x32_bf16 v[64:67], v[204:207], v[128:131], 0
    v_mfma_f32_16x16x32_bf16 v[68:71], v[208:211], v[128:131], 0
    v_mfma_f32_16x16x32_bf16 v[72:75], v[212:215], v[128:131], 0
    buffer_load_dwordx4 v[128:131], v186, s[16:19], s59 offen offset:0 sc1
    s_waitcnt vmcnt(14)
    v_mfma_f32_16x16x32_bf16 v[56:59], v[216:219], v[132:135], v[56:59]
    v_mfma_f32_16x16x32_bf16 v[60:63], v[220:223], v[132:135], v[60:63]
    v_mfma_f32_16x16x32_bf16 v[64:67], v[224:227], v[132:135], v[64:67]
    v_mfma_f32_16x16x32_bf16 v[68:71], v[228:231], v[132:135], v[68:71]
    v_mfma_f32_16x16x32_bf16 v[72:75], v[232:235], v[132:135], v[72:75]
    buffer_load_dwordx4 v[132:135], v186, s[16:19], s59 offen offset:2048 sc1
    s_waitcnt vmcnt(14)
    v_mfma_f32_16x16x32_bf16 v[56:59], v[236:239], v[96:99], v[56:59]
    v_mfma_f32_16x16x32_bf16 v[60:63], v[240:243], v[96:99], v[60:63]
    v_mfma_f32_16x16x32_bf16 v[64:67], v[244:247], v[96:99], v[64:67]
    v_mfma_f32_16x16x32_bf16 v[68:71], v[248:251], v[96:99], v[68:71]
    v_mfma_f32_16x16x32_bf16 v[72:75], v[252:255], v[96:99], v[72:75]
    buffer_load_dwordx4 v[96:99], v186, s[16:19], s63 offen offset:0 sc1
    s_waitcnt vmcnt(14)
    v_mfma_f32_16x16x32_bf16 v[56:59], a[200:203], v[100:103], v[56:59]
    v_mfma_f32_16x16x32_bf16 v[60:63], a[204:207], v[100:103], v[60:63]
    v_mfma_f32_16x16x32_bf16 v[64:67], a[208:211], v[100:103], v[64:67]
    v_mfma_f32_16x16x32_bf16 v[68:71], a[212:215], v[100:103], v[68:71]
    v_mfma_f32_16x16x32_bf16 v[72:75], a[216:219], v[100:103], v[72:75]
    buffer_load_dwordx4 v[100:103], v190, s[16:19], s63 offen offset:2048 sc1
    s_waitcnt vmcnt(13)
    v_mfma_f32_16x16x32_bf16 v[56:59], a[220:223], v[104:107], v[56:59]
    v_mfma_f32_16x16x32_bf16 v[60:63], a[224:227], v[104:107], v[60:63]
    v_mfma_f32_16x16x32_bf16 v[64:67], a[228:231], v[104:107], v[64:67]
    v_mfma_f32_16x16x32_bf16 v[68:71], a[232:235], v[104:107], v[68:71]
    v_mfma_f32_16x16x32_bf16 v[72:75], a[236:239], v[104:107], v[72:75]
    buffer_load_dwordx4 v[104:107], v187, s[16:19], s36 offen offset:0 sc1
    s_waitcnt vmcnt(12)
    v_mfma_f32_16x16x32_bf16 v[56:59], a[32:35], v[108:111], v[56:59]
    v_mfma_f32_16x16x32_bf16 v[60:63], a[36:39], v[108:111], v[60:63]
    v_mfma_f32_16x16x32_bf16 v[64:67], a[40:43], v[108:111], v[64:67]
    v_mfma_f32_16x16x32_bf16 v[68:71], a[44:47], v[108:111], v[68:71]
    v_mfma_f32_16x16x32_bf16 v[72:75], a[48:51], v[108:111], v[72:75]
    buffer_load_dwordx4 v[108:111], v187, s[16:19], s36 offen offset:2048 sc1
    s_waitcnt vmcnt(8)
    v_mfma_f32_16x16x32_bf16 v[36:39], a[176:179], a[164:167], v[36:39]
    v_mfma_f32_16x16x32_bf16 v[40:43], a[180:183], a[164:167], v[40:43]
    v_mfma_f32_16x16x32_bf16 v[44:47], a[184:187], a[164:167], v[44:47]
    v_mfma_f32_16x16x32_bf16 v[48:51], a[188:191], a[164:167], v[48:51]
    v_mfma_f32_16x16x32_bf16 v[52:55], a[192:195], a[164:167], v[52:55]
    v_mfma_f32_16x16x32_bf16 v[16:19], a[176:179], a[160:163], v[16:19]
    v_mfma_f32_16x16x32_bf16 v[20:23], a[180:183], a[160:163], v[20:23]
    v_mfma_f32_16x16x32_bf16 v[24:27], a[184:187], a[160:163], v[24:27]
    v_mfma_f32_16x16x32_bf16 v[28:31], a[188:191], a[160:163], v[28:31]
    v_mfma_f32_16x16x32_bf16 v[32:35], a[192:195], a[160:163], v[32:35]
    v_mfma_f32_16x16x32_bf16 v[56:59], a[52:55], v[112:115], v[56:59]
    v_mfma_f32_16x16x32_bf16 v[60:63], a[56:59], v[112:115], v[60:63]
    ds_write_b128 v13, v[36:39] offset:5120
    v_mfma_f32_16x16x32_bf16 v[64:67], a[60:63], v[112:115], v[64:67]
    v_mfma_f32_16x16x32_bf16 v[68:71], a[64:67], v[112:115], v[68:71]
    v_mfma_f32_16x16x32_bf16 v[72:75], a[68:71], v[112:115], v[72:75]
    buffer_load_dwordx4 v[112:115], v187, s[16:19], s38 offen offset:0 sc1
    ds_write_b128 v13, v[40:43] offset:6144
    v_mfma_f32_16x16x32_bf16 v[56:59], a[72:75], v[116:119], v[56:59]
    v_mfma_f32_16x16x32_bf16 v[60:63], a[76:79], v[116:119], v[60:63]
    v_mfma_f32_16x16x32_bf16 v[64:67], a[80:83], v[116:119], v[64:67]
    ds_write_b128 v13, v[44:47] offset:7168
    v_mfma_f32_16x16x32_bf16 v[68:71], a[84:87], v[116:119], v[68:71]
    v_mfma_f32_16x16x32_bf16 v[72:75], a[88:91], v[116:119], v[72:75]
    buffer_load_dwordx4 v[116:119], v187, s[16:19], s38 offen offset:2048 sc1
    s_waitcnt vmcnt(9)
    v_mfma_f32_16x16x32_bf16 v[56:59], a[92:95], v[120:123], v[56:59]
    ds_write_b128 v13, v[48:51] offset:8192
    v_mfma_f32_16x16x32_bf16 v[60:63], a[96:99], v[120:123], v[60:63]
    v_mfma_f32_16x16x32_bf16 v[64:67], a[100:103], v[120:123], v[64:67]
    v_mfma_f32_16x16x32_bf16 v[68:71], a[104:107], v[120:123], v[68:71]
    ds_write_b128 v13, v[52:55] offset:9216
    v_mfma_f32_16x16x32_bf16 v[72:75], a[108:111], v[120:123], v[72:75]
    buffer_load_dwordx4 v[120:123], v187, s[16:19], s40 offen offset:0 sc1
    s_waitcnt vmcnt(9)
    v_mfma_f32_16x16x32_bf16 v[56:59], a[112:115], v[124:127], v[56:59]
    v_mfma_f32_16x16x32_bf16 v[60:63], a[116:119], v[124:127], v[60:63]
    v_mfma_f32_16x16x32_bf16 v[64:67], a[120:123], v[124:127], v[64:67]
    v_mfma_f32_16x16x32_bf16 v[68:71], a[124:127], v[124:127], v[68:71]
    v_mfma_f32_16x16x32_bf16 v[72:75], a[128:131], v[124:127], v[72:75]
    buffer_load_dwordx4 v[124:127], v187, s[16:19], s40 offen offset:2048 sc1
    s_waitcnt vmcnt(9)
    v_mfma_f32_16x16x32_bf16 v[56:59], a[132:135], v[128:131], v[56:59]
    v_mfma_f32_16x16x32_bf16 v[60:63], a[136:139], v[128:131], v[60:63]
    s_waitcnt lgkmcnt(0)
    s_barrier
    v_mfma_f32_16x16x32_bf16 v[64:67], a[140:143], v[128:131], v[64:67]
    v_mfma_f32_16x16x32_bf16 v[68:71], a[144:147], v[128:131], v[68:71]
    ds_read_b128 v[76:79], v14 offset:5120
    v_mfma_f32_16x16x32_bf16 v[72:75], a[148:151], v[128:131], v[72:75]
    buffer_load_dwordx4 v[128:131], v187, s[16:19], s54 offen offset:0 sc1
    s_waitcnt vmcnt(9)
    v_mfma_f32_16x16x32_bf16 v[56:59], a[240:243], v[132:135], v[56:59]
    v_mfma_f32_16x16x32_bf16 v[60:63], a[244:247], v[132:135], v[60:63]
    ds_write_b128 v13, v[16:19] offset:0
    v_mfma_f32_16x16x32_bf16 v[64:67], a[248:251], v[132:135], v[64:67]
    ds_read_b128 v[80:83], v14 offset:6144
    v_mfma_f32_16x16x32_bf16 v[68:71], a[252:255], v[132:135], v[68:71]
    v_mfma_f32_16x16x32_bf16 v[72:75], a[152:155], v[132:135], v[72:75]
    buffer_load_dwordx4 v[132:135], v187, s[16:19], s54 offen offset:2048 sc1
    s_waitcnt vmcnt(9)
    v_mfma_f32_16x16x32_bf16 v[56:59], a[0:3], v[96:99], v[56:59]
    ds_write_b128 v13, v[20:23] offset:1024
    v_mfma_f32_16x16x32_bf16 v[60:63], a[4:7], v[96:99], v[60:63]
    ds_read_b128 v[84:87], v14 offset:7168
    v_mfma_f32_16x16x32_bf16 v[64:67], a[8:11], v[96:99], v[64:67]
    v_mfma_f32_16x16x32_bf16 v[68:71], a[12:15], v[96:99], v[68:71]
    v_mfma_f32_16x16x32_bf16 v[72:75], a[156:159], v[96:99], v[72:75]
    buffer_load_dwordx4 v[96:99], v187, s[16:19], s56 offen offset:0 sc1
    ds_write_b128 v13, v[24:27] offset:2048
    s_waitcnt vmcnt(9)
    v_mfma_f32_16x16x32_bf16 v[56:59], a[16:19], v[100:103], v[56:59]
    ds_read_b128 v[88:91], v14 offset:8192
    v_mfma_f32_16x16x32_bf16 v[60:63], a[20:23], v[100:103], v[60:63]
    v_mfma_f32_16x16x32_bf16 v[64:67], a[24:27], v[100:103], v[64:67]
    v_mfma_f32_16x16x32_bf16 v[68:71], a[28:31], v[100:103], v[68:71]
    ds_write_b128 v13, v[28:31] offset:3072
    v_mfma_f32_16x16x32_bf16 v[72:75], a[196:199], v[100:103], v[72:75]
    buffer_load_dwordx4 v[100:103], v187, s[16:19], s56 offen offset:2048 sc1
    ds_read_b128 v[92:95], v14 offset:9216
    v_mfma_f32_16x16x32_bf16 v[56:59], a[176:179], a[168:171], v[56:59]
    v_mfma_f32_16x16x32_bf16 v[60:63], a[180:183], a[168:171], v[60:63]
    v_mfma_f32_16x16x32_bf16 v[64:67], a[184:187], a[168:171], v[64:67]
    ds_write_b128 v13, v[32:35] offset:4096
    v_mfma_f32_16x16x32_bf16 v[68:71], a[188:191], a[168:171], v[68:71]
    v_mfma_f32_16x16x32_bf16 v[72:75], a[192:195], a[168:171], v[72:75]
    s_waitcnt vmcnt(9)
    s_waitcnt lgkmcnt(1)
    v_mfma_f32_16x16x32_bf16 v[76:79], v[196:199], v[104:107], v[76:79]
    v_mfma_f32_16x16x32_bf16 v[80:83], v[200:203], v[104:107], v[80:83]
    v_mfma_f32_16x16x32_bf16 v[84:87], v[204:207], v[104:107], v[84:87]
    v_mfma_f32_16x16x32_bf16 v[88:91], v[208:211], v[104:107], v[88:91]
    v_mfma_f32_16x16x32_bf16 v[92:95], v[212:215], v[104:107], v[92:95]
    buffer_load_dwordx4 v[104:107], v187, s[16:19], s59 offen offset:0 sc1
    s_waitcnt vmcnt(9)
    v_mfma_f32_16x16x32_bf16 v[76:79], v[216:219], v[108:111], v[76:79]
    v_mfma_f32_16x16x32_bf16 v[80:83], v[220:223], v[108:111], v[80:83]
    ds_write_b128 v13, v[56:59] offset:10240
    v_mfma_f32_16x16x32_bf16 v[84:87], v[224:227], v[108:111], v[84:87]
    v_mfma_f32_16x16x32_bf16 v[88:91], v[228:231], v[108:111], v[88:91]
    v_mfma_f32_16x16x32_bf16 v[92:95], v[232:235], v[108:111], v[92:95]
    buffer_load_dwordx4 v[108:111], v187, s[16:19], s59 offen offset:2048 sc1
    ds_write_b128 v13, v[60:63] offset:11264
    s_waitcnt vmcnt(9)
    v_mfma_f32_16x16x32_bf16 v[76:79], v[236:239], v[112:115], v[76:79]
    v_mfma_f32_16x16x32_bf16 v[80:83], v[240:243], v[112:115], v[80:83]
    v_mfma_f32_16x16x32_bf16 v[84:87], v[244:247], v[112:115], v[84:87]
    ds_write_b128 v13, v[64:67] offset:12288
    v_mfma_f32_16x16x32_bf16 v[88:91], v[248:251], v[112:115], v[88:91]
    v_mfma_f32_16x16x32_bf16 v[92:95], v[252:255], v[112:115], v[92:95]
    buffer_load_dwordx4 v[112:115], v187, s[16:19], s63 offen offset:0 sc1
    s_waitcnt vmcnt(9)
    v_mfma_f32_16x16x32_bf16 v[76:79], a[200:203], v[116:119], v[76:79]
    ds_write_b128 v13, v[68:71] offset:13312
    v_mfma_f32_16x16x32_bf16 v[80:83], a[204:207], v[116:119], v[80:83]
    v_mfma_f32_16x16x32_bf16 v[84:87], a[208:211], v[116:119], v[84:87]
    v_mfma_f32_16x16x32_bf16 v[88:91], a[212:215], v[116:119], v[88:91]
    ds_write_b128 v13, v[72:75] offset:14336
    v_mfma_f32_16x16x32_bf16 v[92:95], a[216:219], v[116:119], v[92:95]
    buffer_load_dwordx4 v[116:119], v191, s[16:19], s63 offen offset:2048 sc1
    s_waitcnt vmcnt(9)
    v_mfma_f32_16x16x32_bf16 v[76:79], a[220:223], v[120:123], v[76:79]
    v_mfma_f32_16x16x32_bf16 v[80:83], a[224:227], v[120:123], v[80:83]
    v_mfma_f32_16x16x32_bf16 v[84:87], a[228:231], v[120:123], v[84:87]
    v_mfma_f32_16x16x32_bf16 v[88:91], a[232:235], v[120:123], v[88:91]
    v_mfma_f32_16x16x32_bf16 v[92:95], a[236:239], v[120:123], v[92:95]
    s_waitcnt vmcnt(8)
    v_mfma_f32_16x16x32_bf16 v[76:79], a[32:35], v[124:127], v[76:79]
    v_mfma_f32_16x16x32_bf16 v[80:83], a[36:39], v[124:127], v[80:83]
    s_waitcnt lgkmcnt(0)
    s_barrier
    v_mfma_f32_16x16x32_bf16 v[84:87], a[40:43], v[124:127], v[84:87]
    v_mfma_f32_16x16x32_bf16 v[88:91], a[44:47], v[124:127], v[88:91]
    ds_read_b128 v[144:147], v15 offset:10240
    v_mfma_f32_16x16x32_bf16 v[92:95], a[48:51], v[124:127], v[92:95]
    s_waitcnt vmcnt(7)
    v_mfma_f32_16x16x32_bf16 v[76:79], a[52:55], v[128:131], v[76:79]
    ds_read_b128 v[148:151], v15 offset:11264
    v_mfma_f32_16x16x32_bf16 v[80:83], a[56:59], v[128:131], v[80:83]
    v_mfma_f32_16x16x32_bf16 v[84:87], a[60:63], v[128:131], v[84:87]
    ds_read_b128 v[152:155], v15 offset:12288
    v_mfma_f32_16x16x32_bf16 v[88:91], a[64:67], v[128:131], v[88:91]
    v_mfma_f32_16x16x32_bf16 v[92:95], a[68:71], v[128:131], v[92:95]
    ds_read_b128 v[156:159], v15 offset:13312
    s_waitcnt vmcnt(6)
    v_mfma_f32_16x16x32_bf16 v[76:79], a[72:75], v[132:135], v[76:79]
    v_mfma_f32_16x16x32_bf16 v[80:83], a[76:79], v[132:135], v[80:83]
    ds_read_b128 v[160:163], v15 offset:14336
    v_mfma_f32_16x16x32_bf16 v[84:87], a[80:83], v[132:135], v[84:87]
    v_mfma_f32_16x16x32_bf16 v[88:91], a[84:87], v[132:135], v[88:91]
    ds_read_b128 v[164:167], v0 offset:0
    v_mfma_f32_16x16x32_bf16 v[92:95], a[88:91], v[132:135], v[92:95]
    s_waitcnt vmcnt(5)
    v_mfma_f32_16x16x32_bf16 v[76:79], a[92:95], v[96:99], v[76:79]
    ds_read_b128 v[168:171], v0 offset:1024
    v_mfma_f32_16x16x32_bf16 v[80:83], a[96:99], v[96:99], v[80:83]
    v_mfma_f32_16x16x32_bf16 v[84:87], a[100:103], v[96:99], v[84:87]
    ds_read_b128 v[172:175], v0 offset:2048
    v_mfma_f32_16x16x32_bf16 v[88:91], a[104:107], v[96:99], v[88:91]
    v_mfma_f32_16x16x32_bf16 v[92:95], a[108:111], v[96:99], v[92:95]
    ds_read_b128 v[176:179], v0 offset:3072
    s_waitcnt vmcnt(4)
    v_mfma_f32_16x16x32_bf16 v[76:79], a[112:115], v[100:103], v[76:79]
    v_mfma_f32_16x16x32_bf16 v[80:83], a[116:119], v[100:103], v[80:83]
    ds_read_b128 v[180:183], v0 offset:4096
    v_mfma_f32_16x16x32_bf16 v[84:87], a[120:123], v[100:103], v[84:87]
    v_mfma_f32_16x16x32_bf16 v[88:91], a[124:127], v[100:103], v[88:91]
    v_mfma_f32_16x16x32_bf16 v[92:95], a[128:131], v[100:103], v[92:95]
    s_waitcnt vmcnt(3)
    v_mfma_f32_16x16x32_bf16 v[76:79], a[132:135], v[104:107], v[76:79]
    s_waitcnt lgkmcnt(0)
    v_mfma_f32_16x16x32_bf16 v[80:83], a[136:139], v[104:107], v[80:83]
    v_add_f32 v144, v144, v164
    v_mfma_f32_16x16x32_bf16 v[84:87], a[140:143], v[104:107], v[84:87]
    v_add_f32 v145, v145, v165
    v_mfma_f32_16x16x32_bf16 v[88:91], a[144:147], v[104:107], v[88:91]
    v_add_f32 v146, v146, v166
    v_mfma_f32_16x16x32_bf16 v[92:95], a[148:151], v[104:107], v[92:95]
    v_add_f32 v147, v147, v167
    s_waitcnt vmcnt(2)
    v_mfma_f32_16x16x32_bf16 v[76:79], a[240:243], v[108:111], v[76:79]
    v_add_f32 v148, v148, v168
    v_mfma_f32_16x16x32_bf16 v[80:83], a[244:247], v[108:111], v[80:83]
    v_add_f32 v149, v149, v169
    v_mfma_f32_16x16x32_bf16 v[84:87], a[248:251], v[108:111], v[84:87]
    v_mfma_f32_16x16x32_bf16 v[88:91], a[252:255], v[108:111], v[88:91]
    v_add_f32 v150, v150, v170
    v_mfma_f32_16x16x32_bf16 v[92:95], a[152:155], v[108:111], v[92:95]
    v_add_f32 v151, v151, v171
    s_waitcnt vmcnt(1)
    v_mfma_f32_16x16x32_bf16 v[76:79], a[0:3], v[112:115], v[76:79]
    v_add_f32 v152, v152, v172
    v_mfma_f32_16x16x32_bf16 v[80:83], a[4:7], v[112:115], v[80:83]
    v_add_f32 v153, v153, v173
    v_mfma_f32_16x16x32_bf16 v[84:87], a[8:11], v[112:115], v[84:87]
    v_add_f32 v154, v154, v174
    v_mfma_f32_16x16x32_bf16 v[88:91], a[12:15], v[112:115], v[88:91]
    v_add_f32 v155, v155, v175
    v_mfma_f32_16x16x32_bf16 v[92:95], a[156:159], v[112:115], v[92:95]
    v_add_f32 v156, v156, v176
    s_waitcnt vmcnt(0)
    v_mfma_f32_16x16x32_bf16 v[76:79], a[16:19], v[116:119], v[76:79]
    v_mfma_f32_16x16x32_bf16 v[80:83], a[20:23], v[116:119], v[80:83]
    v_add_f32 v157, v157, v177
    v_mfma_f32_16x16x32_bf16 v[84:87], a[24:27], v[116:119], v[84:87]
    v_add_f32 v158, v158, v178
    v_mfma_f32_16x16x32_bf16 v[88:91], a[28:31], v[116:119], v[88:91]
    v_add_f32 v159, v159, v179
    v_mfma_f32_16x16x32_bf16 v[92:95], a[196:199], v[116:119], v[92:95]
    v_add_f32 v160, v160, v180
    v_mfma_f32_16x16x32_bf16 v[76:79], a[176:179], a[172:175], v[76:79]
    v_add_f32 v161, v161, v181
    v_mfma_f32_16x16x32_bf16 v[80:83], a[180:183], a[172:175], v[80:83]
    v_add_f32 v162, v162, v182
    v_mfma_f32_16x16x32_bf16 v[84:87], a[184:187], a[172:175], v[84:87]
    v_add_f32 v163, v163, v183
    v_mfma_f32_16x16x32_bf16 v[88:91], a[188:191], a[172:175], v[88:91]
    v_mfma_f32_16x16x32_bf16 v[92:95], a[192:195], a[172:175], v[92:95]
    s_nop 0
    v_add_f32 v76, v76, v144
    v_add_f32 v77, v77, v145
    v_add_f32 v78, v78, v146
    v_add_f32 v79, v79, v147
    v_cvt_pk_bf16_f32 v96, v76, v77
    v_cvt_pk_bf16_f32 v97, v78, v79
    v_add_f32 v80, v80, v148
    v_add_f32 v81, v81, v149
    v_add_f32 v82, v82, v150
    v_add_f32 v83, v83, v151
    v_cvt_pk_bf16_f32 v98, v80, v81
    v_cvt_pk_bf16_f32 v99, v82, v83
    buffer_store_dwordx4 v[96:99], v10, s[20:23], s82 offen
    v_add_f32 v84, v84, v152
    v_add_f32 v85, v85, v153
    v_add_f32 v86, v86, v154
    v_add_f32 v87, v87, v155
    v_cvt_pk_bf16_f32 v100, v84, v85
    v_cvt_pk_bf16_f32 v101, v86, v87
    v_add_f32 v88, v88, v156
    v_add_f32 v89, v89, v157
    v_add_f32 v90, v90, v158
    v_add_f32 v91, v91, v159
    v_cvt_pk_bf16_f32 v102, v88, v89
    v_cvt_pk_bf16_f32 v103, v90, v91
    buffer_store_dwordx4 v[100:103], v10, s[20:23], s82 offen offset:64
    v_add_f32 v92, v92, v160
    v_add_f32 v93, v93, v161
    v_add_f32 v94, v94, v162
    v_add_f32 v95, v95, v163
    v_cvt_pk_bf16_f32 v104, v92, v93
    v_cvt_pk_bf16_f32 v105, v94, v95
    buffer_store_dwordx2 v[104:105], v11, s[20:23], s82 offen offset:128
    s_endpgm
L_S:
    s_mul_i32 s35, s31, 26
    s_lshl_b32 s45, s33, 1
    s_add_u32 s35, s35, s45
    s_add_u32 s35, s35, 12
    s_mul_i32 s58, s31, 6
    s_add_u32 s58, s58, s45
    s_sub_u32 s58, s58, 12
    v_and_b32 v19, 1, v17
    v_lshlrev_b32 v19, 2, v19
    v_xor_b32 v18, v18, v19
    s_movk_i32 s51, 3456
    v_mul_u32_u24 v19, s51, v16
    v_lshl_add_u32 v4, v18, 4, v19
    v_add_u32 v5, 26624, v4
    s_lshl_b32 s38, s35, 6
    s_mul_i32 s45, s30, 55296
    s_add_u32 s38, s38, s45
    s_mul_i32 s40, s30, 2048
    s_add_u32 s40, s40, 65536
    s_lshl_b32 s46, s35, 6
    v_and_b32 v22, 31, v1
    v_lshl_add_u32 v22, v22, 2, s46
    s_waitcnt lgkmcnt(0)
    global_load_dword v23, v22, s[70:71]
    v_bfe_u32 v21, v1, 0, 3
    v_mul_u32_u24 v21, 0xa0, v21
    global_load_dword v29, v21, s[74:75]
    s_mov_b32 s8, s68
    s_and_b32 s9, s69, 0xffff
    s_mov_b32 s10, 2211840
    s_mov_b32 s11, 0x20000
    s_add_u32 m0, s40, 0
    s_add_u32 s36, s36, 128
    s_add_u32 s37, s37, 128
    buffer_load_dwordx4 v4, s[8:11], s38 offen offset:0  lds
    buffer_load_dwordx4 v5, s[8:11], s38 offen offset:1024  lds
    s_add_u32 s38, s38, 221184
    s_mov_b32 s12, s72
    s_and_b32 s13, s73, 0xffff
    s_mov_b32 s14, 2211840
    s_mov_b32 s15, 0x20000
    s_mov_b32 s16, s80
    s_and_b32 s17, s81, 0xffff
    s_mov_b32 s18, 12386304
    s_mov_b32 s19, 0x20000
    s_mov_b32 s20, s76
    s_and_b32 s21, s77, 0xffff
    s_mov_b32 s22, 2621440
    s_mov_b32 s23, 0x20000
    s_mov_b64 s[24:25], s[70:71]
    s_mov_b64 s[26:27], s[74:75]
    s_mov_b64 s[28:29], s[78:79]
    s_or_b32 s45, s2, s30
    s_cmp_lg_u32 s45, 0
    s_cbranch_scc1 L_non12
    s_memrealtime s[46:47]
    s_waitcnt lgkmcnt(0)
    s_or_b32 s45, s46, 1
    v_mov_b32 v16, 0
    v_mov_b32 v17, s45
    global_store_dword v16, v17, s[28:29] sc1
L_non12:
    v_lshl_add_u32 v16, v1, 2, s30
    v_lshlrev_b32 v16, 21, v16
    s_mov_b64 exec, 0x3
    buffer_load_dword v29, v16, s[16:19], 0 offen sc1
    s_mov_b64 exec, 3
    buffer_load_dword v29, v16, s[20:23], 0 offen sc1
    s_mov_b64 exec, -1
    s_mov_b32 s44, 0x3f803f80
    s_sub_u32 s47, 32, s32
    s_cmp_eq_u32 s32, 0
    s_cselect_b32 s47, 16, s47
    s_cmp_eq_u32 s31, 1
    s_cselect_b32 s41, s47, s32
    s_mov_b32 s42, s33
    s_mul_i32 s61, s30, 14
    s_cmp_eq_u32 s30, 3
    s_cselect_b32 s61, 41, s61
    v_and_b32 v16, 31, v1
    v_lshrrev_b32 v17, 5, v1
    v_bfe_u32 v18, v1, 1, 3
    v_xor_b32 v18, v18, v17
    v_lshlrev_b32 v19, 7, v16
    v_add_u32 v19, s39, v19
    v_lshl_add_u32 v8, v18, 4, v19
    v_xor_b32 v9, 32, v8
    v_xor_b32 v10, 64, v8
    v_xor_b32 v11, 96, v8
    v_bfe_u32 v20, v1, 2, 2
    v_lshl_add_u32 v18, v17, 3, v20
    v_mul_u32_u24 v18, 128, v18
    v_bfe_u32 v19, v1, 4, 1
    v_lshl_add_u32 v18, v19, 5, v18
    v_and_b32 v19, 3, v1
    v_lshl_add_u32 v18, v19, 3, v18
    v_add_u32 v18, 65536, v18
    v_lshrrev_b32 v20, 1, v20
    s_add_u32 s45, s30, 0
    s_and_b32 s45, s45, 1
    v_xor_b32 v19, s45, v20
    v_lshl_add_u32 v12, v19, 6, v18
    s_mul_i32 s53, s34, 54
    s_add_u32 s53, s53, s35
    s_add_u32 s53, s53, s45
    s_lshl_b32 s53, s53, 11
    s_add_u32 s45, s30, 1
    s_and_b32 s45, s45, 1
    v_xor_b32 v19, s45, v20
    v_lshl_add_u32 v13, v19, 6, v18
    s_mul_i32 s54, s34, 54
    s_add_u32 s54, s54, s35
    s_add_u32 s54, s54, s45
    s_lshl_b32 s54, s54, 11
    s_lshl_b32 s57, s2, 2
    s_add_u32 s57, s57, s30
    s_lshl_b32 s57, s57, 7
    s_add_u32 s57, s57, 11960320
    v_and_b32 v16, 15, v1
    v_bfe_u32 v17, v1, 4, 1
    v_mov_b32 v18, s44
    v_cmp_eq_u32 vcc, v16, v17
    s_nop 1
    v_cndmask_b32 v18, 0, v18, vcc
    v_accvgpr_write_b32 a192, v18
    v_accvgpr_write_b32 a193, v18
    v_accvgpr_write_b32 a194, v18
    v_accvgpr_write_b32 a195, v18
    v_lshlrev_b32 v31, 4, v1
    v_lshlrev_b32 v30, 10, v17
    v_lshrrev_b32 v17, 5, v1
    v_lshl_add_u32 v30, v17, 8, v30
    v_lshl_add_u32 v30, v16, 4, v30
    v_and_b32 v96, 31, v1
    v_lshrrev_b32 v97, 5, v1
    v_lshlrev_b32 v97, 3, v97
    v_and_b32 v99, 1, v1
    v_cmp_eq_u32 vcc, 0, v99
    s_nop 1
    v_cndmask_b32 v98, 0, 0.5, vcc
    v_cndmask_b32 v244, 1.0, -1.0, vcc
    s_mul_i32 s46, s30, 10240
    s_add_u32 s46, s46, 98304
    v_add_u32 v99, s46, v31
    s_lshl_b32 s45, s58, 4
    s_add_u32 s45, s45, 1
    v_add_u32 v100, s45, v96
    v_cvt_f32_u32 v100, v100
    v_mul_f32 v100, 0x3acccccd, v100
    s_mul_i32 s45, s30, 5
    s_add_u32 s45, s45, 0
    s_and_b32 s47, s45, 1
    s_lshr_b32 s45, s45, 1
    s_lshl_b32 s45, s45, 5
    s_add_u32 s45, s45, s47
    v_add_u32 v102, s45, v97
    v_cvt_f32_u32 v102, v102
    v_fma_f32 v104, v102, v100, v98
    v_fmamk_f32 v105, v100, 0x40000000, v104
    v_fmamk_f32 v106, v100, 0x40800000, v104
    v_fmamk_f32 v107, v100, 0x40c00000, v104
    v_fmamk_f32 v108, v100, 0x41800000, v104
    v_fmamk_f32 v109, v100, 0x41900000, v104
    v_fmamk_f32 v110, v100, 0x41a00000, v104
    v_fmamk_f32 v111, v100, 0x41b00000, v104
    v_cos_f32 v112, v104
    v_sin_f32 v104, v104
    v_cos_f32 v113, v105
    v_sin_f32 v105, v105
    v_cos_f32 v114, v106
    v_sin_f32 v106, v106
    v_cos_f32 v115, v107
    v_sin_f32 v107, v107
    v_cos_f32 v116, v108
    v_sin_f32 v108, v108
    v_cos_f32 v117, v109
    v_sin_f32 v109, v109
    v_cos_f32 v118, v110
    v_sin_f32 v110, v110
    v_cos_f32 v119, v111
    v_sin_f32 v111, v111
    v_cvt_pk_bf16_f32 v112, v112, v113
    v_cvt_pk_bf16_f32 v113, v114, v115
    v_cvt_pk_bf16_f32 v114, v116, v117
    v_cvt_pk_bf16_f32 v115, v118, v119
    ds_write_b128 v99, v[112:115] offset:0
    v_cvt_pk_bf16_f32 v120, v104, v105
    v_cvt_pk_bf16_f32 v121, v106, v107
    v_cvt_pk_bf16_f32 v122, v108, v109
    v_cvt_pk_bf16_f32 v123, v110, v111
    ds_write_b128 v99, v[120:123] offset:1024
    s_mul_i32 s45, s30, 5
    s_add_u32 s45, s45, 1
    s_and_b32 s47, s45, 1
    s_lshr_b32 s45, s45, 1
    s_lshl_b32 s45, s45, 5
    s_add_u32 s45, s45, s47
    v_add_u32 v102, s45, v97
    v_cvt_f32_u32 v102, v102
    v_fma_f32 v104, v102, v100, v98
    s_add_u32 m0, s39, 16384
    v_fmamk_f32 v105, v100, 0x40000000, v104
    v_fmamk_f32 v106, v100, 0x40800000, v104
    v_fmamk_f32 v107, v100, 0x40c00000, v104
    v_fmamk_f32 v108, v100, 0x41800000, v104
    v_fmamk_f32 v109, v100, 0x41900000, v104
    v_fmamk_f32 v110, v100, 0x41a00000, v104
    v_fmamk_f32 v111, v100, 0x41b00000, v104
    v_cos_f32 v112, v104
    v_sin_f32 v104, v104
    v_cos_f32 v113, v105
    v_sin_f32 v105, v105
    v_cos_f32 v114, v106
    v_sin_f32 v106, v106
    v_cos_f32 v115, v107
    v_sin_f32 v107, v107
    v_cos_f32 v116, v108
    v_sin_f32 v108, v108
    v_cos_f32 v117, v109
    v_sin_f32 v109, v109
    v_cos_f32 v118, v110
    v_sin_f32 v110, v110
    v_cos_f32 v119, v111
    v_sin_f32 v111, v111
    v_cvt_pk_bf16_f32 v112, v112, v113
    v_cvt_pk_bf16_f32 v113, v114, v115
    v_cvt_pk_bf16_f32 v114, v116, v117
    buffer_load_dwordx4 v2, s[4:7], s36 offen  lds
    v_cvt_pk_bf16_f32 v115, v118, v119
    ds_write_b128 v99, v[112:115] offset:2048
    v_cvt_pk_bf16_f32 v120, v104, v105
    v_cvt_pk_bf16_f32 v121, v106, v107
    v_cvt_pk_bf16_f32 v122, v108, v109
    v_cvt_pk_bf16_f32 v123, v110, v111
    ds_write_b128 v99, v[120:123] offset:3072
    s_mul_i32 s45, s30, 5
    s_add_u32 s45, s45, 2
    s_and_b32 s47, s45, 1
    s_lshr_b32 s45, s45, 1
    s_lshl_b32 s45, s45, 5
    s_add_u32 s45, s45, s47
    v_add_u32 v102, s45, v97
    v_cvt_f32_u32 v102, v102
    v_fma_f32 v104, v102, v100, v98
    v_fmamk_f32 v105, v100, 0x40000000, v104
    v_fmamk_f32 v106, v100, 0x40800000, v104
    v_fmamk_f32 v107, v100, 0x40c00000, v104
    v_fmamk_f32 v108, v100, 0x41800000, v104
    v_fmamk_f32 v109, v100, 0x41900000, v104
    v_fmamk_f32 v110, v100, 0x41a00000, v104
    v_fmamk_f32 v111, v100, 0x41b00000, v104
    v_cos_f32 v112, v104
    v_sin_f32 v104, v104
    buffer_load_dwordx4 v3, s[4:7], s36 offen offset:1024  lds
    v_cos_f32 v113, v105
    v_sin_f32 v105, v105
    v_cos_f32 v114, v106
    v_sin_f32 v106, v106
    v_cos_f32 v115, v107
    v_sin_f32 v107, v107
    v_cos_f32 v116, v108
    v_sin_f32 v108, v108
    v_cos_f32 v117, v109
    v_sin_f32 v109, v109
    v_cos_f32 v118, v110
    v_sin_f32 v110, v110
    v_cos_f32 v119, v111
    v_sin_f32 v111, v111
    v_cvt_pk_bf16_f32 v112, v112, v113
    v_cvt_pk_bf16_f32 v113, v114, v115
    v_cvt_pk_bf16_f32 v114, v116, v117
    v_cvt_pk_bf16_f32 v115, v118, v119
    ds_write_b128 v99, v[112:115] offset:4096
    v_cvt_pk_bf16_f32 v120, v104, v105
    v_cvt_pk_bf16_f32 v121, v106, v107
    v_cvt_pk_bf16_f32 v122, v108, v109
    v_cvt_pk_bf16_f32 v123, v110, v111
    ds_write_b128 v99, v[120:123] offset:5120
    s_mul_i32 s45, s30, 5
    s_add_u32 s45, s45, 3
    buffer_load_dwordx4 v2, s[4:7], s37 offen offset:2048  lds
    s_and_b32 s47, s45, 1
    s_lshr_b32 s45, s45, 1
    s_lshl_b32 s45, s45, 5
    s_add_u32 s45, s45, s47
    v_add_u32 v102, s45, v97
    v_cvt_f32_u32 v102, v102
    v_fma_f32 v104, v102, v100, v98
    v_fmamk_f32 v105, v100, 0x40000000, v104
    v_fmamk_f32 v106, v100, 0x40800000, v104
    v_fmamk_f32 v107, v100, 0x40c00000, v104
    v_fmamk_f32 v108, v100, 0x41800000, v104
    v_fmamk_f32 v109, v100, 0x41900000, v104
    v_fmamk_f32 v110, v100, 0x41a00000, v104
    v_fmamk_f32 v111, v100, 0x41b00000, v104
    v_cos_f32 v112, v104
    v_sin_f32 v104, v104
    v_cos_f32 v113, v105
    v_sin_f32 v105, v105
    v_cos_f32 v114, v106
    v_sin_f32 v106, v106
    v_cos_f32 v115, v107
    v_sin_f32 v107, v107
    v_cos_f32 v116, v108
    v_sin_f32 v108, v108
    v_cos_f32 v117, v109
    buffer_load_dwordx4 v3, s[4:7], s37 offen offset:3072  lds
    v_sin_f32 v109, v109
    v_cos_f32 v118, v110
    v_sin_f32 v110, v110
    v_cos_f32 v119, v111
    v_sin_f32 v111, v111
    v_cvt_pk_bf16_f32 v112, v112, v113
    v_cvt_pk_bf16_f32 v113, v114, v115
    v_cvt_pk_bf16_f32 v114, v116, v117
    v_cvt_pk_bf16_f32 v115, v118, v119
    ds_write_b128 v99, v[112:115] offset:6144
    v_cvt_pk_bf16_f32 v120, v104, v105
    v_cvt_pk_bf16_f32 v121, v106, v107
    v_cvt_pk_bf16_f32 v122, v108, v109
    v_cvt_pk_bf16_f32 v123, v110, v111
    ds_write_b128 v99, v[120:123] offset:7168
    s_mul_i32 s45, s30, 5
    s_add_u32 s45, s45, 4
    s_and_b32 s47, s45, 1
    s_lshr_b32 s45, s45, 1
    s_lshl_b32 s45, s45, 5
    s_add_u32 s45, s45, s47
    v_add_u32 v102, s45, v97
    v_cvt_f32_u32 v102, v102
    v_fma_f32 v104, v102, v100, v98
    v_fmamk_f32 v105, v100, 0x40000000, v104
    v_fmamk_f32 v106, v100, 0x40800000, v104
    s_add_u32 m0, s40, 8192
    s_add_u32 s36, s36, 128
    s_add_u32 s37, s37, 128
    v_fmamk_f32 v107, v100, 0x40c00000, v104
    v_fmamk_f32 v108, v100, 0x41800000, v104
    v_fmamk_f32 v109, v100, 0x41900000, v104
    v_fmamk_f32 v110, v100, 0x41a00000, v104
    v_fmamk_f32 v111, v100, 0x41b00000, v104
    v_cos_f32 v112, v104
    v_sin_f32 v104, v104
    v_cos_f32 v113, v105
    v_sin_f32 v105, v105
    v_cos_f32 v114, v106
    v_sin_f32 v106, v106
    v_cos_f32 v115, v107
    v_sin_f32 v107, v107
    v_cos_f32 v116, v108
    v_sin_f32 v108, v108
    v_cos_f32 v117, v109
    v_sin_f32 v109, v109
    v_cos_f32 v118, v110
    v_sin_f32 v110, v110
    v_cos_f32 v119, v111
    v_sin_f32 v111, v111
    v_cvt_pk_bf16_f32 v112, v112, v113
    v_cvt_pk_bf16_f32 v113, v114, v115
    v_cvt_pk_bf16_f32 v114, v116, v117
    v_cvt_pk_bf16_f32 v115, v118, v119
    buffer_load_dwordx4 v4, s[8:11], s38 offen offset:0  lds
    ds_write_b128 v99, v[112:115] offset:8192
    v_cvt_pk_bf16_f32 v120, v104, v105
    v_cvt_pk_bf16_f32 v121, v106, v107
    v_cvt_pk_bf16_f32 v122, v108, v109
    v_cvt_pk_bf16_f32 v123, v110, v111
    ds_write_b128 v99, v[120:123] offset:9216
    s_add_u32 s45, s30, 1
    s_and_b32 s46, s45, 1
    s_bfe_u32 s45, s45, 0x10001
    s_lshl_b32 s45, s45, 5
    s_add_u32 s45, s45, s41
    s_lshl_b32 s46, s46, 10
    s_add_u32 s78, s45, s46
    s_add_u32 s45, s30, 2
    s_and_b32 s46, s45, 1
    s_bfe_u32 s45, s45, 0x10001
    s_lshl_b32 s45, s45, 5
    s_add_u32 s45, s45, s41
    s_lshl_b32 s46, s46, 10
    s_add_u32 s79, s45, s46
    s_add_u32 s45, s30, 3
    s_and_b32 s46, s45, 1
    s_bfe_u32 s45, s45, 0x10001
    s_lshl_b32 s45, s45, 5
    s_add_u32 s45, s45, s41
    s_lshl_b32 s46, s46, 10
    buffer_load_dwordx4 v5, s[8:11], s38 offen offset:1024  lds
    s_add_u32 s80, s45, s46
    s_add_u32 s45, s30, 4
    s_and_b32 s46, s45, 1
    s_bfe_u32 s45, s45, 0x10001
    s_lshl_b32 s45, s45, 5
    s_add_u32 s45, s45, s41
    s_lshl_b32 s46, s46, 10
    s_add_u32 s81, s45, s46
    s_lshl_b32 s45, s32, 2
    s_add_u32 s45, s45, s30
    s_lshl_b32 s45, s45, 9
    s_add_u32 s45, s45, 11911168
    v_and_b32 v19, 31, v1
    v_lshl_add_u32 v19, v19, 4, s45
    v_add_u32 v20, s61, v1
    v_min_u32 v20, 53, v20
    s_lshl_b32 s45, s42, 7
    s_add_u32 s45, s45, 12189696
    v_lshlrev_b32 v20, 10, v20
    v_add_u32 v20, s45, v20
    s_mul_i32 s70, s42, 54
    s_add_u32 s70, s70, s61
    s_mul_i32 s70, s70, 5120
    s_add_u32 s70, s70, 9699328
    s_cmp_ge_u32 s30, 2
    s_cselect_b32 s45, 1073741824, 0
    v_add_u32 v192, s45, v31
    s_add_u32 s38, s38, 221184
    v_mov_b32 v28, 0
    global_load_dword v28, v28, s[28:29] sc1
    v_add_u32 v195, 98304, v31
    s_mov_b32 s73, 0x05040100
    s_mov_b32 s74, 0x07060302
    s_waitcnt vmcnt(9) lgkmcnt(0)
    s_barrier
    ds_read_b128 v[196:199], v8 offset:0
    ds_read_b64_tr_b16 v[96:97], v12 offset:0
    ds_read_b64_tr_b16 v[98:99], v12 offset:512
    ds_read_b64_tr_b16 v[100:101], v13 offset:0
    ds_read_b64_tr_b16 v[102:103], v13 offset:512
    ds_read_b128 v[200:203], v9 offset:0
    ds_read_b128 v[204:207], v10 offset:0
    ds_read_b128 v[208:211], v11 offset:0
    s_waitcnt lgkmcnt(3)
    v_mfma_f32_32x32x16_bf16 v[32:47], v[96:99], v[196:199], 0
    v_mfma_f32_16x16x32_bf16 a[196:199], a[192:195], v[96:99], 0
    ds_read_b64_tr_b16 v[112:113], v12 offset:2048
    ds_read_b64_tr_b16 v[114:115], v12 offset:2560
    ds_read_b64_tr_b16 v[116:117], v13 offset:2048
    s_add_u32 m0, s39, 32768
    s_nop 0
    buffer_load_dwordx4 v2, s[4:7], s36 offen  lds
    v_mfma_f32_32x32x16_bf16 v[48:63], v[100:103], v[196:199], 0
    ds_read_b64_tr_b16 v[118:119], v13 offset:2560
    buffer_load_dwordx4 v3, s[4:7], s36 offen offset:1024  lds
    buffer_load_dwordx4 v2, s[4:7], s37 offen offset:2048  lds
    s_waitcnt lgkmcnt(0)
    v_mfma_f32_32x32x16_bf16 v[32:47], v[112:115], v[200:203], v[32:47]
    v_mfma_f32_16x16x32_bf16 a[196:199], a[192:195], v[112:115], a[196:199]
    ds_read_b64_tr_b16 v[96:97], v12 offset:4096
    ds_read_b64_tr_b16 v[98:99], v12 offset:4608
    ds_read_b64_tr_b16 v[100:101], v13 offset:4096
    buffer_load_dwordx4 v3, s[4:7], s37 offen offset:3072  lds
    v_mfma_f32_32x32x16_bf16 v[48:63], v[116:119], v[200:203], v[48:63]
    ds_read_b64_tr_b16 v[102:103], v13 offset:4608
    ds_read_b128 v[104:107], v195 offset:0
    ds_read_b128 v[108:111], v195 offset:2048
    s_add_u32 m0, s40, 16384
    s_add_u32 s36, s36, 128
    s_add_u32 s37, s37, 128
    v_perm_b32 v228, v197, v196, s73
    v_perm_b32 v229, v199, v198, s73
    v_perm_b32 v230, v201, v200, s73
    v_perm_b32 v231, v203, v202, s73
    buffer_load_dwordx4 v4, s[8:11], s38 offen offset:0  lds
    v_perm_b32 v232, v197, v196, s74
    v_perm_b32 v233, v199, v198, s74
    v_perm_b32 v234, v201, v200, s74
    v_perm_b32 v235, v203, v202, s74
    buffer_load_dwordx4 v5, s[8:11], s38 offen offset:1024  lds
    s_add_u32 s38, s38, 221184
    s_add_u32 m0, s39, 49152
    s_waitcnt lgkmcnt(2)
    v_mfma_f32_32x32x16_bf16 v[32:47], v[96:99], v[204:207], v[32:47]
    v_mfma_f32_16x16x32_bf16 a[196:199], a[192:195], v[96:99], a[196:199]
    ds_read_b64_tr_b16 v[112:113], v12 offset:6144
    ds_read_b64_tr_b16 v[114:115], v12 offset:6656
    ds_read_b64_tr_b16 v[116:117], v13 offset:6144
    buffer_load_dwordx4 v2, s[4:7], s36 offen  lds
    v_mfma_f32_32x32x16_bf16 v[48:63], v[100:103], v[204:207], v[48:63]
    ds_read_b64_tr_b16 v[118:119], v13 offset:6656
    ds_read_b128 v[120:123], v195 offset:1024
    ds_read_b128 v[124:127], v195 offset:3072
    s_waitcnt lgkmcnt(6)
    v_mfma_f32_32x32x16_bf16 v[128:143], v[228:231], v[104:107], 0
    buffer_load_dwordx4 v3, s[4:7], s36 offen offset:1024  lds
    v_mfma_f32_32x32x16_bf16 v[144:159], v[232:235], v[108:111], 0
    buffer_load_dwordx4 v2, s[4:7], s37 offen offset:2048  lds
    s_mul_i32 s45, s32, 10
    s_add_u32 s45, s45, s58
    s_lshl_b32 s45, s45, 1
    s_add_u32 s45, s45, s30
    s_mul_i32 s45, s45, 6912
    v_lshlrev_b32 v64, 7, v1
    s_mov_b32 exec_hi, 0x3fffff
    buffer_load_dword v29, v64, s[12:15], s45 offen
    s_mov_b32 exec_hi, -1
    s_waitcnt vmcnt(11)
    s_barrier
    s_waitcnt lgkmcnt(2)
    v_mfma_f32_32x32x16_bf16 v[32:47], v[112:115], v[208:211], v[32:47]
    v_mfma_f32_16x16x32_bf16 a[196:199], a[192:195], v[112:115], a[196:199]
    ds_read_b128 v[212:215], v8 offset:16384
    ds_read_b64_tr_b16 v[96:97], v12 offset:8192
    ds_read_b64_tr_b16 v[98:99], v12 offset:8704
    ds_read_b64_tr_b16 v[100:101], v13 offset:8192
    buffer_load_dwordx4 v3, s[4:7], s37 offen offset:3072  lds
    v_lshlrev_b32 v16, 16, v23
    v_and_b32 v17, 0xffff0000, v23
    v_mfma_f32_32x32x16_bf16 v[48:63], v[116:119], v[208:211], v[48:63]
    ds_read_b64_tr_b16 v[102:103], v13 offset:8704
    ds_read_b128 v[104:107], v195 offset:4096
    ds_read_b128 v[108:111], v195 offset:6144
    s_add_u32 m0, s40, 24576
    s_add_u32 s36, s36, 128
    s_add_u32 s37, s37, 128
    v_lshlrev_b32 v18, 3, v1
    s_waitcnt lgkmcnt(7)
    v_mfma_f32_32x32x16_bf16 v[160:175], v[228:231], v[120:123], 0
    v_perm_b32 v236, v205, v204, s73
    v_perm_b32 v237, v207, v206, s73
    v_perm_b32 v238, v209, v208, s73
    v_perm_b32 v239, v211, v210, s73
    buffer_load_dwordx4 v4, s[8:11], s38 offen offset:0  lds
    v_add_u32 v18, 162304, v18
    v_mfma_f32_32x32x16_bf16 v[176:191], v[232:235], v[124:127], 0
    ds_read_b128 v[216:219], v9 offset:16384
    v_perm_b32 v240, v205, v204, s74
    v_perm_b32 v241, v207, v206, s74
    v_perm_b32 v242, v209, v208, s74
    v_perm_b32 v243, v211, v210, s74
    buffer_load_dwordx4 v5, s[8:11], s38 offen offset:1024  lds
    s_add_u32 s38, s38, 221184
    ds_write_b64 v18, v[16:17]
    s_waitcnt lgkmcnt(4)
    v_mfma_f32_32x32x16_bf16 v[32:47], v[96:99], v[212:215], v[32:47]
    v_mfma_f32_16x16x32_bf16 a[196:199], a[192:195], v[96:99], a[196:199]
    ds_read_b64_tr_b16 v[112:113], v12 offset:10240
    ds_read_b64_tr_b16 v[114:115], v12 offset:10752
    ds_read_b64_tr_b16 v[116:117], v13 offset:10240
    v_mfma_f32_32x32x16_bf16 v[48:63], v[100:103], v[212:215], v[48:63]
    ds_read_b64_tr_b16 v[118:119], v13 offset:10752
    ds_read_b128 v[120:123], v195 offset:5120
    ds_read_b128 v[124:127], v195 offset:7168
    s_waitcnt lgkmcnt(8)
    v_mfma_f32_32x32x16_bf16 v[128:143], v[236:239], v[104:107], v[128:143]
    v_mfma_f32_32x32x16_bf16 v[144:159], v[240:243], v[108:111], v[144:159]
    ds_read_b128 v[220:223], v10 offset:16384
    ds_read_b128 v[224:227], v11 offset:16384
    s_add_u32 m0, s39, 0
    s_waitcnt lgkmcnt(4)
    v_mfma_f32_32x32x16_bf16 v[32:47], v[112:115], v[216:219], v[32:47]
    v_mfma_f32_16x16x32_bf16 a[196:199], a[192:195], v[112:115], a[196:199]
    ds_read_b64_tr_b16 v[96:97], v12 offset:12288
    ds_read_b64_tr_b16 v[98:99], v12 offset:12800
    ds_read_b64_tr_b16 v[100:101], v13 offset:12288
    buffer_load_dwordx4 v2, s[4:7], s36 offen  lds
    v_mfma_f32_32x32x16_bf16 v[48:63], v[116:119], v[216:219], v[48:63]
    ds_read_b64_tr_b16 v[102:103], v13 offset:12800
    ds_read_b128 v[104:107], v195 offset:8192
    ds_read_b128 v[108:111], v195 offset:10240
    s_waitcnt lgkmcnt(8)
    v_mfma_f32_32x32x16_bf16 v[160:175], v[236:239], v[120:123], v[160:175]
    v_perm_b32 v228, v213, v212, s73
    v_perm_b32 v229, v215, v214, s73
    v_perm_b32 v230, v217, v216, s73
    v_perm_b32 v231, v219, v218, s73
    buffer_load_dwordx4 v3, s[4:7], s36 offen offset:1024  lds
    v_mfma_f32_32x32x16_bf16 v[176:191], v[240:243], v[124:127], v[176:191]
    v_perm_b32 v232, v213, v212, s74
    v_perm_b32 v233, v215, v214, s74
    v_perm_b32 v234, v217, v216, s74
    v_perm_b32 v235, v219, v218, s74
    buffer_load_dwordx4 v2, s[4:7], s37 offen offset:2048  lds
    s_waitcnt lgkmcnt(2)
    v_mfma_f32_32x32x16_bf16 v[32:47], v[96:99], v[220:223], v[32:47]
    v_mfma_f32_16x16x32_bf16 a[196:199], a[192:195], v[96:99], a[196:199]
    ds_read_b64_tr_b16 v[112:113], v12 offset:14336
    ds_read_b64_tr_b16 v[114:115], v12 offset:14848
    ds_read_b64_tr_b16 v[116:117], v13 offset:14336
    buffer_load_dwordx4 v3, s[4:7], s37 offen offset:3072  lds
    v_mfma_f32_32x32x16_bf16 v[48:63], v[100:103], v[220:223], v[48:63]
    ds_read_b64_tr_b16 v[118:119], v13 offset:14848
    ds_read_b128 v[120:123], v195 offset:9216
    ds_read_b128 v[124:127], v195 offset:11264
    s_waitcnt lgkmcnt(6)
    v_mfma_f32_32x32x16_bf16 v[128:143], v[228:231], v[104:107], v[128:143]
    v_mfma_f32_32x32x16_bf16 v[144:159], v[232:235], v[108:111], v[144:159]
    s_add_u32 m0, s40, 0
    s_add_u32 s36, s36, 128
    s_add_u32 s37, s37, 128
    s_waitcnt vmcnt(11)
    s_barrier
    s_waitcnt lgkmcnt(2)
    v_mfma_f32_32x32x16_bf16 v[32:47], v[112:115], v[224:227], v[32:47]
    v_mfma_f32_16x16x32_bf16 a[196:199], a[192:195], v[112:115], a[196:199]
    ds_read_b128 v[196:199], v8 offset:32768
    ds_read_b64_tr_b16 v[96:97], v12 offset:16384
    ds_read_b64_tr_b16 v[98:99], v12 offset:16896
    ds_read_b64_tr_b16 v[100:101], v13 offset:16384
    buffer_load_dwordx4 v4, s[8:11], s38 offen offset:0  lds
    v_mfma_f32_32x32x16_bf16 v[48:63], v[116:119], v[224:227], v[48:63]
    ds_read_b64_tr_b16 v[102:103], v13 offset:16896
    ds_read_b128 v[104:107], v195 offset:12288
    ds_read_b128 v[108:111], v195 offset:14336
    s_waitcnt lgkmcnt(7)
    v_mfma_f32_32x32x16_bf16 v[160:175], v[228:231], v[120:123], v[160:175]
    v_perm_b32 v236, v221, v220, s73
    v_perm_b32 v237, v223, v222, s73
    v_perm_b32 v238, v225, v224, s73
    v_perm_b32 v239, v227, v226, s73
    buffer_load_dwordx4 v5, s[8:11], s38 offen offset:1024  lds
    s_add_u32 s38, s38, 221184
    v_mfma_f32_32x32x16_bf16 v[176:191], v[232:235], v[124:127], v[176:191]
    ds_read_b128 v[200:203], v9 offset:32768
    v_perm_b32 v240, v221, v220, s74
    v_perm_b32 v241, v223, v222, s74
    v_perm_b32 v242, v225, v224, s74
    v_perm_b32 v243, v227, v226, s74
    s_waitcnt lgkmcnt(3)
    v_mfma_f32_32x32x16_bf16 v[32:47], v[96:99], v[196:199], v[32:47]
    v_mfma_f32_16x16x32_bf16 a[196:199], a[192:195], v[96:99], a[196:199]
    ds_read_b64_tr_b16 v[112:113], v12 offset:18432
    ds_read_b64_tr_b16 v[114:115], v12 offset:18944
    ds_read_b64_tr_b16 v[116:117], v13 offset:18432
    v_mfma_f32_32x32x16_bf16 v[48:63], v[100:103], v[196:199], v[48:63]
    ds_read_b64_tr_b16 v[118:119], v13 offset:18944
    ds_read_b128 v[120:123], v195 offset:13312
    ds_read_b128 v[124:127], v195 offset:15360
    s_waitcnt lgkmcnt(7)
    v_mfma_f32_32x32x16_bf16 v[128:143], v[236:239], v[104:107], v[128:143]
    v_mfma_f32_32x32x16_bf16 v[144:159], v[240:243], v[108:111], v[144:159]
    ds_read_b128 v[204:207], v10 offset:32768
    ds_read_b128 v[208:211], v11 offset:32768
    s_add_u32 m0, s39, 16384
    s_waitcnt lgkmcnt(4)
    v_mfma_f32_32x32x16_bf16 v[32:47], v[112:115], v[200:203], v[32:47]
    v_mfma_f32_16x16x32_bf16 a[196:199], a[192:195], v[112:115], a[196:199]
    ds_read_b64_tr_b16 v[96:97], v12 offset:20480
    ds_read_b64_tr_b16 v[98:99], v12 offset:20992
    ds_read_b64_tr_b16 v[100:101], v13 offset:20480
    buffer_load_dwordx4 v2, s[4:7], s36 offen  lds
    v_mfma_f32_32x32x16_bf16 v[48:63], v[116:119], v[200:203], v[48:63]
    ds_read_b64_tr_b16 v[102:103], v13 offset:20992
    ds_read_b128 v[104:107], v195 offset:16384
    ds_read_b128 v[108:111], v195 offset:18432
    s_waitcnt lgkmcnt(8)
    v_mfma_f32_32x32x16_bf16 v[160:175], v[236:239], v[120:123], v[160:175]
    v_perm_b32 v228, v197, v196, s73
    v_perm_b32 v229, v199, v198, s73
    v_perm_b32 v230, v201, v200, s73
    v_perm_b32 v231, v203, v202, s73
    buffer_load_dwordx4 v3, s[4:7], s36 offen offset:1024  lds
    v_mfma_f32_32x32x16_bf16 v[176:191], v[240:243], v[124:127], v[176:191]
    v_perm_b32 v232, v197, v196, s74
    v_perm_b32 v233, v199, v198, s74
    v_perm_b32 v234, v201, v200, s74
    v_perm_b32 v235, v203, v202, s74
    s_waitcnt lgkmcnt(2)
    v_mfma_f32_32x32x16_bf16 v[32:47], v[96:99], v[204:207], v[32:47]
    v_mfma_f32_16x16x32_bf16 a[196:199], a[192:195], v[96:99], a[196:199]
    ds_read_b64_tr_b16 v[112:113], v12 offset:22528
    ds_read_b64_tr_b16 v[114:115], v12 offset:23040
    ds_read_b64_tr_b16 v[116:117], v13 offset:22528
    buffer_load_dwordx4 v2, s[4:7], s37 offen offset:2048  lds
    v_mfma_f32_32x32x16_bf16 v[48:63], v[100:103], v[204:207], v[48:63]
    ds_read_b64_tr_b16 v[118:119], v13 offset:23040
    ds_read_b128 v[120:123], v195 offset:17408
    ds_read_b128 v[124:127], v195 offset:19456
    s_waitcnt lgkmcnt(6)
    v_mfma_f32_32x32x16_bf16 v[128:143], v[228:231], v[104:107], v[128:143]
    buffer_load_dwordx4 v3, s[4:7], s37 offen offset:3072  lds
    v_mfma_f32_32x32x16_bf16 v[144:159], v[232:235], v[108:111], v[144:159]
    s_add_u32 m0, s40, 8192
    s_add_u32 s36, s36, 128
    s_add_u32 s37, s37, 128
    v_readfirstlane_b32 s43, v28
    s_mov_b32 s51, 0
    s_cmp_lg_u32 s43, 0
    s_cbranch_scc1 L_nok13
L_nlp14:
    v_mov_b32 v28, 0
    global_load_dword v28, v28, s[28:29] sc1
    s_waitcnt vmcnt(0)
    v_readfirstlane_b32 s43, v28
    s_add_u32 s51, s51, 1
    s_cmp_gt_u32 s51, 100000
    s_cbranch_scc1 L_nok13
    s_cmp_eq_u32 s43, 0
    s_cbranch_scc1 L_nlp14
L_nok13:
    s_waitcnt vmcnt(10)
    s_barrier
    s_waitcnt lgkmcnt(2)
    v_mfma_f32_32x32x16_bf16 v[32:47], v[112:115], v[208:211], v[32:47]
    v_mfma_f32_16x16x32_bf16 a[196:199], a[192:195], v[112:115], a[196:199]
    ds_read_b128 v[212:215], v8 offset:49152
    ds_read_b64_tr_b16 v[96:97], v12 offset:24576
    ds_read_b64_tr_b16 v[98:99], v12 offset:25088
    ds_read_b64_tr_b16 v[100:101], v13 offset:24576
    buffer_load_dwordx4 v4, s[8:11], s38 offen offset:0  lds
    v_mfma_f32_32x32x16_bf16 v[48:63], v[116:119], v[208:211], v[48:63]
    ds_read_b64_tr_b16 v[102:103], v13 offset:25088
    ds_read_b128 v[104:107], v195 offset:20480
    ds_read_b128 v[108:111], v195 offset:22528
    s_waitcnt lgkmcnt(7)
    v_mfma_f32_32x32x16_bf16 v[160:175], v[228:231], v[120:123], v[160:175]
    v_perm_b32 v236, v205, v204, s73
    v_perm_b32 v237, v207, v206, s73
    v_perm_b32 v238, v209, v208, s73
    v_perm_b32 v239, v211, v210, s73
    buffer_load_dwordx4 v5, s[8:11], s38 offen offset:1024  lds
    s_add_u32 s38, s38, 221184
    v_mfma_f32_32x32x16_bf16 v[176:191], v[232:235], v[124:127], v[176:191]
    ds_read_b128 v[216:219], v9 offset:49152
    v_perm_b32 v240, v205, v204, s74
    v_perm_b32 v241, v207, v206, s74
    v_perm_b32 v242, v209, v208, s74
    v_perm_b32 v243, v211, v210, s74
    s_waitcnt lgkmcnt(3)
    v_mfma_f32_32x32x16_bf16 v[32:47], v[96:99], v[212:215], v[32:47]
    v_mfma_f32_16x16x32_bf16 a[196:199], a[192:195], v[96:99], a[196:199]
    ds_read_b64_tr_b16 v[112:113], v12 offset:26624
    ds_read_b64_tr_b16 v[114:115], v12 offset:27136
    ds_read_b64_tr_b16 v[116:117], v13 offset:26624
    v_mfma_f32_32x32x16_bf16 v[48:63], v[100:103], v[212:215], v[48:63]
    ds_read_b64_tr_b16 v[118:119], v13 offset:27136
    ds_read_b128 v[120:123], v195 offset:21504
    ds_read_b128 v[124:127], v195 offset:23552
    s_waitcnt lgkmcnt(7)
    v_mfma_f32_32x32x16_bf16 v[128:143], v[236:239], v[104:107], v[128:143]
    v_mfma_f32_32x32x16_bf16 v[144:159], v[240:243], v[108:111], v[144:159]
    ds_read_b128 v[220:223], v10 offset:49152
    ds_read_b128 v[224:227], v11 offset:49152
    s_add_u32 m0, s39, 32768
    s_waitcnt lgkmcnt(4)
    v_mfma_f32_32x32x16_bf16 v[32:47], v[112:115], v[216:219], v[32:47]
    v_mfma_f32_16x16x32_bf16 a[196:199], a[192:195], v[112:115], a[196:199]
    ds_read_b64_tr_b16 v[96:97], v12 offset:28672
    ds_read_b64_tr_b16 v[98:99], v12 offset:29184
    ds_read_b64_tr_b16 v[100:101], v13 offset:28672
    buffer_load_dwordx4 v2, s[4:7], s36 offen  lds
    v_mfma_f32_32x32x16_bf16 v[48:63], v[116:119], v[216:219], v[48:63]
    ds_read_b64_tr_b16 v[102:103], v13 offset:29184
    ds_read_b128 v[104:107], v195 offset:24576
    ds_read_b128 v[108:111], v195 offset:26624
    s_waitcnt lgkmcnt(8)
    v_mfma_f32_32x32x16_bf16 v[160:175], v[236:239], v[120:123], v[160:175]
    v_perm_b32 v228, v213, v212, s73
    v_perm_b32 v229, v215, v214, s73
    v_perm_b32 v230, v217, v216, s73
    v_perm_b32 v231, v219, v218, s73
    buffer_load_dwordx4 v3, s[4:7], s36 offen offset:1024  lds
    v_mfma_f32_32x32x16_bf16 v[176:191], v[240:243], v[124:127], v[176:191]
    v_perm_b32 v232, v213, v212, s74
    v_perm_b32 v233, v215, v214, s74
    v_perm_b32 v234, v217, v216, s74
    v_perm_b32 v235, v219, v218, s74
    global_load_dwordx4 a[176:179], v31, s[82:83] offset:0
    s_waitcnt lgkmcnt(2)
    v_mfma_f32_32x32x16_bf16 v[32:47], v[96:99], v[220:223], v[32:47]
    v_mfma_f32_16x16x32_bf16 a[196:199], a[192:195], v[96:99], a[196:199]
    ds_read_b64_tr_b16 v[112:113], v12 offset:30720
    ds_read_b64_tr_b16 v[114:115], v12 offset:31232
    ds_read_b64_tr_b16 v[116:117], v13 offset:30720
    buffer_load_dwordx4 v2, s[4:7], s37 offen offset:2048  lds
    global_load_dwordx4 a[180:183], v31, s[82:83] offset:1024
    v_mfma_f32_32x32x16_bf16 v[48:63], v[100:103], v[220:223], v[48:63]
    ds_read_b64_tr_b16 v[118:119], v13 offset:31232
    ds_read_b128 v[120:123], v195 offset:25600
    ds_read_b128 v[124:127], v195 offset:27648
    s_waitcnt lgkmcnt(6)
    v_mfma_f32_32x32x16_bf16 v[128:143], v[228:231], v[104:107], v[128:143]
    buffer_load_dwordx4 v3, s[4:7], s37 offen offset:3072  lds
    global_load_dwordx4 a[184:187], v31, s[82:83] offset:2048
    v_mfma_f32_32x32x16_bf16 v[144:159], v[232:235], v[108:111], v[144:159]
    s_add_u32 m0, s40, 16384
    s_add_u32 s36, s36, 128
    s_add_u32 s37, s37, 128
    s_waitcnt vmcnt(13)
    s_barrier
    s_waitcnt lgkmcnt(2)
    v_mfma_f32_32x32x16_bf16 v[32:47], v[112:115], v[224:227], v[32:47]
    v_mfma_f32_16x16x32_bf16 a[196:199], a[192:195], v[112:115], a[196:199]
    ds_read_b128 v[196:199], v8 offset:0
    ds_read_b64_tr_b16 v[96:97], v12 offset:0
    ds_read_b64_tr_b16 v[98:99], v12 offset:512
    ds_read_b64_tr_b16 v[100:101], v13 offset:0
    buffer_load_dwordx4 v4, s[8:11], s38 offen offset:0  lds
    global_load_dwordx4 a[188:191], v31, s[82:83] offset:3072
    v_mfma_f32_32x32x16_bf16 v[48:63], v[116:119], v[224:227], v[48:63]
    ds_read_b64_tr_b16 v[102:103], v13 offset:512
    ds_read_b128 v[104:107], v195 offset:28672
    ds_read_b128 v[108:111], v195 offset:30720
    s_waitcnt lgkmcnt(7)
    v_mfma_f32_32x32x16_bf16 v[160:175], v[228:231], v[120:123], v[160:175]
    v_perm_b32 v236, v221, v220, s73
    v_perm_b32 v237, v223, v222, s73
    v_perm_b32 v238, v225, v224, s73
    v_perm_b32 v239, v227, v226, s73
    buffer_load_dwordx4 v5, s[8:11], s38 offen offset:1024  lds
    s_add_u32 s38, s38, 221184
    s_add_u32 s82, s82, 4096
    s_addc_u32 s83, s83, 0
    v_mfma_f32_32x32x16_bf16 v[176:191], v[232:235], v[124:127], v[176:191]
    ds_read_b128 v[200:203], v9 offset:0
    v_perm_b32 v240, v221, v220, s74
    v_perm_b32 v241, v223, v222, s74
    v_perm_b32 v242, v225, v224, s74
    v_perm_b32 v243, v227, v226, s74
    s_waitcnt lgkmcnt(3)
    v_mfma_f32_32x32x16_bf16 v[32:47], v[96:99], v[196:199], v[32:47]
    v_mfma_f32_16x16x32_bf16 a[196:199], a[192:195], v[96:99], a[196:199]
    ds_read_b64_tr_b16 v[112:113], v12 offset:2048
    ds_read_b64_tr_b16 v[114:115], v12 offset:2560
    ds_read_b64_tr_b16 v[116:117], v13 offset:2048
    global_load_dwordx4 a[152:155], v31, s[82:83] offset:0
    v_mfma_f32_32x32x16_bf16 v[48:63], v[100:103], v[196:199], v[48:63]
    ds_read_b64_tr_b16 v[118:119], v13 offset:2560
    ds_read_b128 v[120:123], v195 offset:29696
    ds_read_b128 v[124:127], v195 offset:31744
    s_waitcnt lgkmcnt(7)
    v_mfma_f32_32x32x16_bf16 v[128:143], v[236:239], v[104:107], v[128:143]
    global_load_dwordx4 a[156:159], v31, s[82:83] offset:1024
    v_mfma_f32_32x32x16_bf16 v[144:159], v[240:243], v[108:111], v[144:159]
    ds_read_b128 v[204:207], v10 offset:0
    ds_read_b128 v[208:211], v11 offset:0
    s_add_u32 m0, s39, 49152
    s_waitcnt lgkmcnt(4)
    v_mfma_f32_32x32x16_bf16 v[32:47], v[112:115], v[200:203], v[32:47]
    v_mfma_f32_16x16x32_bf16 a[196:199], a[192:195], v[112:115], a[196:199]
    ds_read_b64_tr_b16 v[96:97], v12 offset:4096
    ds_read_b64_tr_b16 v[98:99], v12 offset:4608
    ds_read_b64_tr_b16 v[100:101], v13 offset:4096
    buffer_load_dwordx4 v2, s[4:7], s36 offen  lds
    v_mfma_f32_32x32x16_bf16 v[48:63], v[116:119], v[200:203], v[48:63]
    ds_read_b64_tr_b16 v[102:103], v13 offset:4608
    ds_read_b128 v[104:107], v195 offset:32768
    ds_read_b128 v[108:111], v195 offset:34816
    s_waitcnt lgkmcnt(8)
    v_mfma_f32_32x32x16_bf16 v[160:175], v[236:239], v[120:123], v[160:175]
    v_perm_b32 v228, v197, v196, s73
    v_perm_b32 v229, v199, v198, s73
    v_perm_b32 v230, v201, v200, s73
    v_perm_b32 v231, v203, v202, s73
    buffer_load_dwordx4 v3, s[4:7], s36 offen offset:1024  lds
    v_mfma_f32_32x32x16_bf16 v[176:191], v[240:243], v[124:127], v[176:191]
    v_perm_b32 v232, v197, v196, s74
    v_perm_b32 v233, v199, v198, s74
    v_perm_b32 v234, v201, v200, s74
    v_perm_b32 v235, v203, v202, s74
    s_waitcnt lgkmcnt(2)
    v_mfma_f32_32x32x16_bf16 v[32:47], v[96:99], v[204:207], v[32:47]
    v_mfma_f32_16x16x32_bf16 a[196:199], a[192:195], v[96:99], a[196:199]
    ds_read_b64_tr_b16 v[112:113], v12 offset:6144
    ds_read_b64_tr_b16 v[114:115], v12 offset:6656
    ds_read_b64_tr_b16 v[116:117], v13 offset:6144
    buffer_load_dwordx4 v2, s[4:7], s37 offen offset:2048  lds
    v_mfma_f32_32x32x16_bf16 v[48:63], v[100:103], v[204:207], v[48:63]
    ds_read_b64_tr_b16 v[118:119], v13 offset:6656
    ds_read_b128 v[120:123], v195 offset:33792
    ds_read_b128 v[124:127], v195 offset:35840
    s_waitcnt lgkmcnt(6)
    v_mfma_f32_32x32x16_bf16 v[128:143], v[228:231], v[104:107], v[128:143]
    buffer_load_dwordx4 v3, s[4:7], s37 offen offset:3072  lds
    v_mfma_f32_32x32x16_bf16 v[144:159], v[232:235], v[108:111], v[144:159]
    s_add_u32 m0, s40, 24576
    s_add_u32 s36, s36, 128
    s_add_u32 s37, s37, 128
    s_waitcnt vmcnt(16)
    s_barrier
    s_waitcnt lgkmcnt(2)
    v_mfma_f32_32x32x16_bf16 v[32:47], v[112:115], v[208:211], v[32:47]
    v_mfma_f32_16x16x32_bf16 a[196:199], a[192:195], v[112:115], a[196:199]
    ds_read_b128 v[212:215], v8 offset:16384
    ds_read_b64_tr_b16 v[96:97], v12 offset:8192
    ds_read_b64_tr_b16 v[98:99], v12 offset:8704
    ds_read_b64_tr_b16 v[100:101], v13 offset:8192
    buffer_load_dwordx4 v4, s[8:11], s38 offen offset:0  lds
    v_mfma_f32_32x32x16_bf16 v[48:63], v[116:119], v[208:211], v[48:63]
    ds_read_b64_tr_b16 v[102:103], v13 offset:8704
    ds_read_b128 v[104:107], v195 offset:36864
    ds_read_b128 v[108:111], v195 offset:38912
    s_waitcnt lgkmcnt(7)
    v_mfma_f32_32x32x16_bf16 v[160:175], v[228:231], v[120:123], v[160:175]
    v_perm_b32 v236, v205, v204, s73
    v_perm_b32 v237, v207, v206, s73
    v_perm_b32 v238, v209, v208, s73
    v_perm_b32 v239, v211, v210, s73
    buffer_load_dwordx4 v5, s[8:11], s38 offen offset:1024  lds
    s_add_u32 s38, s38, 221184
    v_mfma_f32_32x32x16_bf16 v[176:191], v[232:235], v[124:127], v[176:191]
    ds_read_b128 v[216:219], v9 offset:16384
    v_perm_b32 v240, v205, v204, s74
    v_perm_b32 v241, v207, v206, s74
    v_perm_b32 v242, v209, v208, s74
    v_perm_b32 v243, v211, v210, s74
    s_waitcnt lgkmcnt(3)
    v_mfma_f32_32x32x16_bf16 v[32:47], v[96:99], v[212:215], v[32:47]
    v_mfma_f32_16x16x32_bf16 a[196:199], a[192:195], v[96:99], a[196:199]
    ds_read_b64_tr_b16 v[112:113], v12 offset:10240
    ds_read_b64_tr_b16 v[114:115], v12 offset:10752
    ds_read_b64_tr_b16 v[116:117], v13 offset:10240
    v_mfma_f32_32x32x16_bf16 v[48:63], v[100:103], v[212:215], v[48:63]
    ds_read_b64_tr_b16 v[118:119], v13 offset:10752
    ds_read_b128 v[120:123], v195 offset:37888
    ds_read_b128 v[124:127], v195 offset:39936
    s_waitcnt lgkmcnt(7)
    v_mfma_f32_32x32x16_bf16 v[128:143], v[236:239], v[104:107], v[128:143]
    v_mfma_f32_32x32x16_bf16 v[144:159], v[240:243], v[108:111], v[144:159]
    ds_read_b128 v[220:223], v10 offset:16384
    ds_read_b128 v[224:227], v11 offset:16384
    s_add_u32 m0, s39, 0
    s_waitcnt lgkmcnt(4)
    v_mfma_f32_32x32x16_bf16 v[32:47], v[112:115], v[216:219], v[32:47]
    v_mfma_f32_16x16x32_bf16 a[196:199], a[192:195], v[112:115], a[196:199]
    ds_read_b64_tr_b16 v[96:97], v12 offset:12288
    ds_read_b64_tr_b16 v[98:99], v12 offset:12800
    ds_read_b64_tr_b16 v[100:101], v13 offset:12288
    buffer_load_dwordx4 v2, s[4:7], s36 offen  lds
    v_mfma_f32_32x32x16_bf16 v[48:63], v[116:119], v[216:219], v[48:63]
    ds_read_b64_tr_b16 v[102:103], v13 offset:12800
    ds_read_b128 v[104:107], v195 offset:0
    ds_read_b128 v[108:111], v195 offset:2048
    v_mul_f32 v128, v244, v128
    v_mul_f32 v129, v244, v129
    v_mul_f32 v130, v244, v130
    v_mul_f32 v131, v244, v131
    v_mul_f32 v132, v244, v132
    v_mul_f32 v133, v244, v133
    v_mul_f32 v134, v244, v134
    s_waitcnt lgkmcnt(8)
    v_mfma_f32_32x32x16_bf16 v[160:175], v[236:239], v[120:123], v[160:175]
    v_perm_b32 v228, v213, v212, s73
    v_perm_b32 v229, v215, v214, s73
    v_perm_b32 v230, v217, v216, s73
    v_perm_b32 v231, v219, v218, s73
    v_mul_f32 v135, v244, v135
    v_mul_f32 v136, v244, v136
    v_mul_f32 v137, v244, v137
    v_mul_f32 v138, v244, v138
    v_mul_f32 v139, v244, v139
    v_mul_f32 v140, v244, v140
    buffer_load_dwordx4 v3, s[4:7], s36 offen offset:1024  lds
    v_mfma_f32_32x32x16_bf16 v[176:191], v[240:243], v[124:127], v[176:191]
    v_perm_b32 v232, v213, v212, s74
    v_perm_b32 v233, v215, v214, s74
    v_perm_b32 v234, v217, v216, s74
    v_perm_b32 v235, v219, v218, s74
    v_mul_f32 v141, v244, v141
    v_mul_f32 v142, v244, v142
    v_mul_f32 v143, v244, v143
    v_mul_f32 v144, v244, v144
    v_mul_f32 v145, v244, v145
    v_mul_f32 v146, v244, v146
    v_mul_f32 v147, v244, v147
    s_waitcnt lgkmcnt(2)
    v_mfma_f32_32x32x16_bf16 v[32:47], v[96:99], v[220:223], v[32:47]
    v_mfma_f32_16x16x32_bf16 a[196:199], a[192:195], v[96:99], a[196:199]
    ds_read_b64_tr_b16 v[112:113], v12 offset:14336
    ds_read_b64_tr_b16 v[114:115], v12 offset:14848
    ds_read_b64_tr_b16 v[116:117], v13 offset:14336
    v_mul_f32 v148, v244, v148
    v_mul_f32 v149, v244, v149
    v_mul_f32 v150, v244, v150
    v_mul_f32 v151, v244, v151
    v_mul_f32 v152, v244, v152
    v_mul_f32 v153, v244, v153
    buffer_load_dwordx4 v2, s[4:7], s37 offen offset:2048  lds
    v_mfma_f32_32x32x16_bf16 v[48:63], v[100:103], v[220:223], v[48:63]
    ds_read_b64_tr_b16 v[118:119], v13 offset:14848
    ds_read_b128 v[120:123], v195 offset:1024
    ds_read_b128 v[124:127], v195 offset:3072
    v_mul_f32 v154, v244, v154
    v_mul_f32 v155, v244, v155
    v_mul_f32 v156, v244, v156
    v_mul_f32 v157, v244, v157
    v_mul_f32 v158, v244, v158
    v_mul_f32 v159, v244, v159
    v_mul_f32 v160, v244, v160
    v_mul_f32 v161, v244, v161
    v_mul_f32 v162, v244, v162
    v_mul_f32 v163, v244, v163
    v_mul_f32 v164, v244, v164
    v_mul_f32 v165, v244, v165
    v_mul_f32 v166, v244, v166
    s_waitcnt lgkmcnt(6)
    v_mfma_f32_32x32x16_bf16 v[128:143], v[228:231], v[104:107], v[128:143]
    v_mul_f32 v167, v244, v167
    v_mul_f32 v168, v244, v168
    v_mul_f32 v169, v244, v169
    v_mul_f32 v170, v244, v170
    v_mul_f32 v171, v244, v171
    v_mul_f32 v172, v244, v172
    buffer_load_dwordx4 v3, s[4:7], s37 offen offset:3072  lds
    v_mfma_f32_32x32x16_bf16 v[144:159], v[232:235], v[108:111], v[144:159]
    v_mul_f32 v173, v244, v173
    v_mul_f32 v174, v244, v174
    v_mul_f32 v175, v244, v175
    v_mul_f32 v176, v244, v176
    v_mul_f32 v177, v244, v177
    v_mul_f32 v178, v244, v178
    v_mul_f32 v179, v244, v179
    s_add_u32 m0, s40, 0
    s_add_u32 s36, s36, 128
    s_add_u32 s37, s37, 128
    s_waitcnt vmcnt(12)
    s_barrier
    s_waitcnt lgkmcnt(2)
    v_mfma_f32_32x32x16_bf16 v[32:47], v[112:115], v[224:227], v[32:47]
    v_mfma_f32_16x16x32_bf16 a[196:199], a[192:195], v[112:115], a[196:199]
    ds_read_b128 v[196:199], v8 offset:32768
    ds_read_b64_tr_b16 v[96:97], v12 offset:16384
    ds_read_b64_tr_b16 v[98:99], v12 offset:16896
    ds_read_b64_tr_b16 v[100:101], v13 offset:16384
    v_mul_f32 v180, v244, v180
    v_mul_f32 v181, v244, v181
    v_mul_f32 v182, v244, v182
    v_mul_f32 v183, v244, v183
    v_mul_f32 v184, v244, v184
    v_mul_f32 v185, v244, v185
    buffer_load_dwordx4 v4, s[8:11], s38 offen offset:0  lds
    v_mfma_f32_32x32x16_bf16 v[48:63], v[116:119], v[224:227], v[48:63]
    ds_read_b64_tr_b16 v[102:103], v13 offset:16896
    ds_read_b128 v[104:107], v195 offset:4096
    ds_read_b128 v[108:111], v195 offset:6144
    v_mul_f32 v186, v244, v186
    v_mul_f32 v187, v244, v187
    v_mul_f32 v188, v244, v188
    v_mul_f32 v189, v244, v189
    v_mul_f32 v190, v244, v190
    v_mul_f32 v191, v244, v191
    s_waitcnt lgkmcnt(7)
    v_mfma_f32_32x32x16_bf16 v[160:175], v[228:231], v[120:123], v[160:175]
    v_perm_b32 v236, v221, v220, s73
    v_perm_b32 v237, v223, v222, s73
    v_perm_b32 v238, v225, v224, s73
    v_perm_b32 v239, v227, v226, s73
    buffer_load_dwordx4 v5, s[8:11], s38 offen offset:1024  lds
    s_add_u32 s38, s38, 221184
    v_mfma_f32_32x32x16_bf16 v[176:191], v[232:235], v[124:127], v[176:191]
    ds_read_b128 v[200:203], v9 offset:32768
    v_perm_b32 v240, v221, v220, s74
    v_perm_b32 v241, v223, v222, s74
    v_perm_b32 v242, v225, v224, s74
    v_perm_b32 v243, v227, v226, s74
    s_waitcnt lgkmcnt(3)
    v_mfma_f32_32x32x16_bf16 v[32:47], v[96:99], v[196:199], v[32:47]
    v_mfma_f32_16x16x32_bf16 a[196:199], a[192:195], v[96:99], a[196:199]
    ds_read_b64_tr_b16 v[112:113], v12 offset:18432
    ds_read_b64_tr_b16 v[114:115], v12 offset:18944
    ds_read_b64_tr_b16 v[116:117], v13 offset:18432
    v_mfma_f32_32x32x16_bf16 v[48:63], v[100:103], v[196:199], v[48:63]
    ds_read_b64_tr_b16 v[118:119], v13 offset:18944
    ds_read_b128 v[120:123], v195 offset:5120
    ds_read_b128 v[124:127], v195 offset:7168
    s_waitcnt lgkmcnt(7)
    v_mfma_f32_32x32x16_bf16 v[128:143], v[236:239], v[104:107], v[128:143]
    v_mfma_f32_32x32x16_bf16 v[144:159], v[240:243], v[108:111], v[144:159]
    ds_read_b128 v[204:207], v10 offset:32768
    ds_read_b128 v[208:211], v11 offset:32768
    s_add_u32 m0, s39, 16384
    s_waitcnt lgkmcnt(4)
    v_mfma_f32_32x32x16_bf16 v[32:47], v[112:115], v[200:203], v[32:47]
    v_mfma_f32_16x16x32_bf16 a[196:199], a[192:195], v[112:115], a[196:199]
    ds_read_b64_tr_b16 v[96:97], v12 offset:20480
    ds_read_b64_tr_b16 v[98:99], v12 offset:20992
    ds_read_b64_tr_b16 v[100:101], v13 offset:20480
    buffer_load_dwordx4 v2, s[4:7], s36 offen  lds
    v_mfma_f32_32x32x16_bf16 v[48:63], v[116:119], v[200:203], v[48:63]
    ds_read_b64_tr_b16 v[102:103], v13 offset:20992
    ds_read_b128 v[104:107], v195 offset:8192
    ds_read_b128 v[108:111], v195 offset:10240
    s_waitcnt lgkmcnt(8)
    v_mfma_f32_32x32x16_bf16 v[160:175], v[236:239], v[120:123], v[160:175]
    v_perm_b32 v228, v197, v196, s73
    v_perm_b32 v229, v199, v198, s73
    v_perm_b32 v230, v201, v200, s73
    v_perm_b32 v231, v203, v202, s73
    buffer_load_dwordx4 v3, s[4:7], s36 offen offset:1024  lds
    v_mfma_f32_32x32x16_bf16 v[176:191], v[240:243], v[124:127], v[176:191]
    v_perm_b32 v232, v197, v196, s74
    v_perm_b32 v233, v199, v198, s74
    v_perm_b32 v234, v201, v200, s74
    v_perm_b32 v235, v203, v202, s74
    s_waitcnt lgkmcnt(2)
    v_mfma_f32_32x32x16_bf16 v[32:47], v[96:99], v[204:207], v[32:47]
    v_mfma_f32_16x16x32_bf16 a[196:199], a[192:195], v[96:99], a[196:199]
    ds_read_b64_tr_b16 v[112:113], v12 offset:22528
    ds_read_b64_tr_b16 v[114:115], v12 offset:23040
    ds_read_b64_tr_b16 v[116:117], v13 offset:22528
    buffer_load_dwordx4 v2, s[4:7], s37 offen offset:2048  lds
    v_mfma_f32_32x32x16_bf16 v[48:63], v[100:103], v[204:207], v[48:63]
    ds_read_b64_tr_b16 v[118:119], v13 offset:23040
    ds_read_b128 v[120:123], v195 offset:9216
    ds_read_b128 v[124:127], v195 offset:11264
    s_waitcnt lgkmcnt(6)
    v_mfma_f32_32x32x16_bf16 v[128:143], v[228:231], v[104:107], v[128:143]
    buffer_load_dwordx4 v3, s[4:7], s37 offen offset:3072  lds
    v_mfma_f32_32x32x16_bf16 v[144:159], v[232:235], v[108:111], v[144:159]
    s_add_u32 m0, s40, 8192
    s_add_u32 s36, s36, 128
    s_add_u32 s37, s37, 128
    s_waitcnt vmcnt(10)
    s_barrier
    s_waitcnt lgkmcnt(2)
    v_mfma_f32_32x32x16_bf16 v[32:47], v[112:115], v[208:211], v[32:47]
    v_mfma_f32_16x16x32_bf16 a[196:199], a[192:195], v[112:115], a[196:199]
    ds_read_b128 v[212:215], v8 offset:49152
    ds_read_b64_tr_b16 v[96:97], v12 offset:24576
    ds_read_b64_tr_b16 v[98:99], v12 offset:25088
    ds_read_b64_tr_b16 v[100:101], v13 offset:24576
    buffer_load_dwordx4 v4, s[8:11], s38 offen offset:0  lds
    v_mfma_f32_32x32x16_bf16 v[48:63], v[116:119], v[208:211], v[48:63]
    ds_read_b64_tr_b16 v[102:103], v13 offset:25088
    ds_read_b128 v[104:107], v195 offset:12288
    ds_read_b128 v[108:111], v195 offset:14336
    s_waitcnt lgkmcnt(7)
    v_mfma_f32_32x32x16_bf16 v[160:175], v[228:231], v[120:123], v[160:175]
    v_perm_b32 v236, v205, v204, s73
    v_perm_b32 v237, v207, v206, s73
    v_perm_b32 v238, v209, v208, s73
    v_perm_b32 v239, v211, v210, s73
    buffer_load_dwordx4 v5, s[8:11], s38 offen offset:1024  lds
    s_add_u32 s38, s38, 221184
    v_mfma_f32_32x32x16_bf16 v[176:191], v[232:235], v[124:127], v[176:191]
    ds_read_b128 v[216:219], v9 offset:49152
    v_perm_b32 v240, v205, v204, s74
    v_perm_b32 v241, v207, v206, s74
    v_perm_b32 v242, v209, v208, s74
    v_perm_b32 v243, v211, v210, s74
    buffer_load_dword v21, v20, s[16:19], 0 offen sc1
    s_waitcnt lgkmcnt(3)
    v_mfma_f32_32x32x16_bf16 v[32:47], v[96:99], v[212:215], v[32:47]
    v_mfma_f32_16x16x32_bf16 a[196:199], a[192:195], v[96:99], a[196:199]
    ds_read_b64_tr_b16 v[112:113], v12 offset:26624
    ds_read_b64_tr_b16 v[114:115], v12 offset:27136
    ds_read_b64_tr_b16 v[116:117], v13 offset:26624
    v_mfma_f32_32x32x16_bf16 v[48:63], v[100:103], v[212:215], v[48:63]
    ds_read_b64_tr_b16 v[118:119], v13 offset:27136
    ds_read_b128 v[120:123], v195 offset:13312
    ds_read_b128 v[124:127], v195 offset:15360
    s_waitcnt lgkmcnt(7)
    v_mfma_f32_32x32x16_bf16 v[128:143], v[236:239], v[104:107], v[128:143]
    v_mfma_f32_32x32x16_bf16 v[144:159], v[240:243], v[108:111], v[144:159]
    ds_read_b128 v[220:223], v10 offset:49152
    ds_read_b128 v[224:227], v11 offset:49152
    s_waitcnt lgkmcnt(4)
    v_mfma_f32_32x32x16_bf16 v[32:47], v[112:115], v[216:219], v[32:47]
    v_mfma_f32_16x16x32_bf16 a[196:199], a[192:195], v[112:115], a[196:199]
    ds_read_b64_tr_b16 v[96:97], v12 offset:28672
    ds_read_b64_tr_b16 v[98:99], v12 offset:29184
    ds_read_b64_tr_b16 v[100:101], v13 offset:28672
    v_mfma_f32_32x32x16_bf16 v[48:63], v[116:119], v[216:219], v[48:63]
    ds_read_b64_tr_b16 v[102:103], v13 offset:29184
    ds_read_b128 v[104:107], v195 offset:16384
    ds_read_b128 v[108:111], v195 offset:18432
    s_waitcnt lgkmcnt(8)
    v_mfma_f32_32x32x16_bf16 v[160:175], v[236:239], v[120:123], v[160:175]
    v_perm_b32 v228, v213, v212, s73
    v_perm_b32 v229, v215, v214, s73
    v_perm_b32 v230, v217, v216, s73
    v_perm_b32 v231, v219, v218, s73
    v_mfma_f32_32x32x16_bf16 v[176:191], v[240:243], v[124:127], v[176:191]
    v_perm_b32 v232, v213, v212, s74
    v_perm_b32 v233, v215, v214, s74
    v_perm_b32 v234, v217, v216, s74
    v_perm_b32 v235, v219, v218, s74
    s_waitcnt lgkmcnt(2)
    v_mfma_f32_32x32x16_bf16 v[32:47], v[96:99], v[220:223], v[32:47]
    v_mfma_f32_16x16x32_bf16 a[196:199], a[192:195], v[96:99], a[196:199]
    ds_read_b64_tr_b16 v[112:113], v12 offset:30720
    ds_read_b64_tr_b16 v[114:115], v12 offset:31232
    ds_read_b64_tr_b16 v[116:117], v13 offset:30720
    v_mfma_f32_32x32x16_bf16 v[48:63], v[100:103], v[220:223], v[48:63]
    ds_read_b64_tr_b16 v[118:119], v13 offset:31232
    ds_read_b128 v[120:123], v195 offset:17408
    ds_read_b128 v[124:127], v195 offset:19456
    s_waitcnt lgkmcnt(6)
    v_mfma_f32_32x32x16_bf16 v[128:143], v[228:231], v[104:107], v[128:143]
    v_mfma_f32_32x32x16_bf16 v[144:159], v[232:235], v[108:111], v[144:159]
    s_waitcnt vmcnt(0)
    s_mov_b32 exec_lo, 0x3fff
    s_mov_b32 exec_hi, 0x0
    v_cmp_ne_u32 vcc, s43, v21
    s_mov_b32 s51, 0
    s_cbranch_vccz L_ok15
L_lp16:
    s_sleep 1
    buffer_load_dword v21, v20, s[16:19], 0 offen sc1
    s_waitcnt vmcnt(0)
    v_cmp_ne_u32 vcc, s43, v21
    s_add_u32 s51, s51, 1
    s_cmp_gt_u32 s51, 100000
    s_cbranch_scc1 L_ok15
    s_cbranch_vccnz L_lp16
L_ok15:
    s_mov_b64 exec, -1
    s_barrier
    s_waitcnt lgkmcnt(2)
    v_mfma_f32_32x32x16_bf16 v[32:47], v[112:115], v[224:227], v[32:47]
    v_mfma_f32_16x16x32_bf16 a[196:199], a[192:195], v[112:115], a[196:199]
    ds_read_b128 v[196:199], v8 offset:0
    ds_read_b64_tr_b16 v[96:97], v12 offset:0
    ds_read_b64_tr_b16 v[98:99], v12 offset:512
    ds_read_b64_tr_b16 v[100:101], v13 offset:0
    s_add_u32 s62, s70, 15360
    buffer_load_dwordx4 a[200:203], v31, s[16:19], s62 offen offset:0 sc1
    s_lshl_b32 s72, s30, 7
    s_add_u32 s72, s72, 162816
    v_mfma_f32_32x32x16_bf16 v[48:63], v[116:119], v[224:227], v[48:63]
    ds_read_b64_tr_b16 v[102:103], v13 offset:512
    ds_read_b128 v[104:107], v195 offset:20480
    ds_read_b128 v[108:111], v195 offset:22528
    buffer_load_dwordx4 a[204:207], v31, s[16:19], s62 offen offset:1024 sc1
    v_and_b32 v22, 31, v1
    s_waitcnt lgkmcnt(7)
    v_mfma_f32_32x32x16_bf16 v[160:175], v[228:231], v[120:123], v[160:175]
    v_perm_b32 v236, v221, v220, s73
    v_perm_b32 v237, v223, v222, s73
    v_perm_b32 v238, v225, v224, s73
    v_perm_b32 v239, v227, v226, s73
    buffer_load_dwordx4 a[208:211], v31, s[16:19], s62 offen offset:2048 sc1
    v_lshl_add_u32 v3, v22, 2, s72
    v_mfma_f32_32x32x16_bf16 v[176:191], v[232:235], v[124:127], v[176:191]
    ds_read_b128 v[200:203], v9 offset:0
    v_perm_b32 v240, v221, v220, s74
    v_perm_b32 v241, v223, v222, s74
    v_perm_b32 v242, v225, v224, s74
    v_perm_b32 v243, v227, v226, s74
    buffer_load_dwordx4 v[24:27], v19, s[16:19], 0 offen sc1
    s_add_u32 s71, s30, 0
    s_waitcnt lgkmcnt(3)
    v_mfma_f32_32x32x16_bf16 v[32:47], v[96:99], v[196:199], v[32:47]
    v_mfma_f32_16x16x32_bf16 a[196:199], a[192:195], v[96:99], a[196:199]
    ds_read_b64_tr_b16 v[112:113], v12 offset:2048
    ds_read_b64_tr_b16 v[114:115], v12 offset:2560
    ds_read_b64_tr_b16 v[116:117], v13 offset:2048
    buffer_load_dwordx4 a[212:215], v31, s[16:19], s62 offen offset:3072 sc1
    s_and_b32 s71, s71, 1
    s_lshl_b32 s71, s71, 7
    v_mfma_f32_32x32x16_bf16 v[48:63], v[100:103], v[196:199], v[48:63]
    ds_read_b64_tr_b16 v[118:119], v13 offset:2560
    ds_read_b128 v[120:123], v195 offset:21504
    ds_read_b128 v[124:127], v195 offset:23552
    s_add_u32 s62, s70, 19456
    buffer_load_dwordx4 a[216:219], v31, s[16:19], s62 offen offset:0 sc1
    s_add_u32 s71, s71, 161792
    s_waitcnt lgkmcnt(7)
    v_mfma_f32_32x32x16_bf16 v[128:143], v[236:239], v[104:107], v[128:143]
    s_add_u32 s62, s70, 20480
    buffer_load_dwordx4 a[220:223], v31, s[16:19], s62 offen offset:0 sc1
    v_lshl_add_u32 v14, v22, 2, s71
    v_mfma_f32_32x32x16_bf16 v[144:159], v[240:243], v[108:111], v[144:159]
    ds_read_b128 v[204:207], v10 offset:0
    ds_read_b128 v[208:211], v11 offset:0
    s_add_u32 s71, s30, 1
    s_waitcnt lgkmcnt(4)
    v_mfma_f32_32x32x16_bf16 v[32:47], v[112:115], v[200:203], v[32:47]
    v_mfma_f32_16x16x32_bf16 a[196:199], a[192:195], v[112:115], a[196:199]
    ds_read_b64_tr_b16 v[96:97], v12 offset:4096
    ds_read_b64_tr_b16 v[98:99], v12 offset:4608
    ds_read_b64_tr_b16 v[100:101], v13 offset:4096
    buffer_load_dwordx4 a[224:227], v31, s[16:19], s62 offen offset:1024 sc1
    s_and_b32 s71, s71, 1
    s_lshl_b32 s71, s71, 7
    v_mfma_f32_32x32x16_bf16 v[48:63], v[116:119], v[200:203], v[48:63]
    ds_read_b64_tr_b16 v[102:103], v13 offset:4608
    ds_read_b128 v[104:107], v195 offset:24576
    ds_read_b128 v[108:111], v195 offset:26624
    buffer_load_dwordx4 a[228:231], v31, s[16:19], s62 offen offset:2048 sc1
    s_add_u32 s71, s71, 161792
    s_waitcnt lgkmcnt(8)
    v_mfma_f32_32x32x16_bf16 v[160:175], v[236:239], v[120:123], v[160:175]
    v_perm_b32 v228, v197, v196, s73
    v_perm_b32 v229, v199, v198, s73
    v_perm_b32 v230, v201, v200, s73
    v_perm_b32 v231, v203, v202, s73
    buffer_load_dwordx4 a[232:235], v31, s[16:19], s62 offen offset:3072 sc1
    v_lshl_add_u32 v15, v22, 2, s71
    v_mfma_f32_32x32x16_bf16 v[176:191], v[240:243], v[124:127], v[176:191]
    v_perm_b32 v232, v197, v196, s74
    v_perm_b32 v233, v199, v198, s74
    v_perm_b32 v234, v201, v200, s74
    v_perm_b32 v235, v203, v202, s74
    v_lshrrev_b32 v22, 5, v1
    s_waitcnt lgkmcnt(2)
    v_mfma_f32_32x32x16_bf16 v[32:47], v[96:99], v[204:207], v[32:47]
    v_mfma_f32_16x16x32_bf16 a[196:199], a[192:195], v[96:99], a[196:199]
    ds_read_b64_tr_b16 v[112:113], v12 offset:6144
    ds_read_b64_tr_b16 v[114:115], v12 offset:6656
    ds_read_b64_tr_b16 v[116:117], v13 offset:6144
    s_add_u32 s62, s70, 24576
    buffer_load_dwordx4 a[236:239], v31, s[16:19], s62 offen offset:0 sc1
    s_waitcnt vmcnt(7)
    v_cmp_ne_u32 vcc, s43, v27
    s_mov_b32 s51, 0
    s_cbranch_vccz L_ok17
L_lp18:
    s_sleep 1
    buffer_load_dwordx4 v[24:27], v19, s[16:19], 0 offen sc1
    s_waitcnt vmcnt(0)
    v_cmp_ne_u32 vcc, s43, v27
    s_add_u32 s51, s51, 1
    s_cmp_gt_u32 s51, 100000
    s_cbranch_scc1 L_ok17
    s_cbranch_vccnz L_lp18
L_ok17:
    v_rcp_f32 v28, v25
    v_mfma_f32_32x32x16_bf16 v[48:63], v[100:103], v[204:207], v[48:63]
    ds_read_b64_tr_b16 v[118:119], v13 offset:6656
    ds_read_b128 v[120:123], v195 offset:25600
    ds_read_b128 v[124:127], v195 offset:27648
    s_add_u32 s62, s70, 25600
    buffer_load_dwordx4 a[32:35], v31, s[16:19], s62 offen offset:0 sc1
    s_nop 0
    ds_write2st64_b32 v3, v28, v26 offset0:0 offset1:2
    s_waitcnt lgkmcnt(7)
    v_mfma_f32_32x32x16_bf16 v[128:143], v[228:231], v[104:107], v[128:143]
    buffer_load_dwordx4 a[36:39], v31, s[16:19], s62 offen offset:1024 sc1
    v_cvt_pk_bf16_f32 v68, v24, v25
    v_mfma_f32_32x32x16_bf16 v[144:159], v[232:235], v[108:111], v[144:159]
    v_lshlrev_b32 v70, 16, v68
    s_barrier
    s_waitcnt lgkmcnt(3)
    v_mfma_f32_32x32x16_bf16 v[32:47], v[112:115], v[208:211], v[32:47]
    v_mfma_f32_16x16x32_bf16 a[196:199], a[192:195], v[112:115], a[196:199]
    ds_read_b128 v[212:215], v8 offset:16384
    ds_read_b64_tr_b16 v[96:97], v12 offset:8192
    ds_read_b64_tr_b16 v[98:99], v12 offset:8704
    ds_read_b64_tr_b16 v[100:101], v13 offset:8192
    buffer_load_dwordx4 a[40:43], v31, s[16:19], s62 offen offset:2048 sc1
    v_and_b32 v71, 0xffff0000, v68
    v_mfma_f32_32x32x16_bf16 v[48:63], v[116:119], v[208:211], v[48:63]
    ds_read_b64_tr_b16 v[102:103], v13 offset:8704
    ds_read_b128 v[104:107], v195 offset:28672
    ds_read_b128 v[108:111], v195 offset:30720
    buffer_load_dwordx4 a[44:47], v31, s[16:19], s62 offen offset:3072 sc1
    v_sub_f32 v70, v24, v70
    s_waitcnt lgkmcnt(8)
    v_mfma_f32_32x32x16_bf16 v[160:175], v[228:231], v[120:123], v[160:175]
    v_perm_b32 v236, v205, v204, s73
    v_perm_b32 v237, v207, v206, s73
    v_perm_b32 v238, v209, v208, s73
    v_perm_b32 v239, v211, v210, s73
    s_add_u32 s62, s70, 29696
    buffer_load_dwordx4 a[48:51], v31, s[16:19], s62 offen offset:0 sc1
    v_sub_f32 v71, v25, v71
    v_cvt_pk_bf16_f32 v69, v70, v71
    v_mfma_f32_32x32x16_bf16 v[176:191], v[232:235], v[124:127], v[176:191]
    ds_read_b128 v[216:219], v9 offset:16384
    v_perm_b32 v240, v205, v204, s74
    v_perm_b32 v241, v207, v206, s74
    v_perm_b32 v242, v209, v208, s74
    v_perm_b32 v243, v211, v210, s74
    ds_read_b64_tr_b16 v[84:85], v12 offset:10240
    ds_read_b64_tr_b16 v[86:87], v12 offset:10752
    ds_read_b64_tr_b16 v[88:89], v12 offset:12288
    v_mov_b32 v64, 0
    s_waitcnt lgkmcnt(6)
    v_mfma_f32_32x32x16_bf16 v[32:47], v[96:99], v[212:215], v[32:47]
    v_mfma_f32_16x16x32_bf16 a[196:199], a[192:195], v[96:99], a[196:199]
    ds_read_b64_tr_b16 v[112:113], v12 offset:10240
    ds_read_b64_tr_b16 v[114:115], v12 offset:10752
    ds_read_b64_tr_b16 v[116:117], v13 offset:10240
    s_add_u32 s62, s70, 30720
    buffer_load_dwordx4 a[52:55], v31, s[16:19], s62 offen offset:0 sc1
    v_mov_b32 v65, 0
    v_mfma_f32_32x32x16_bf16 v[48:63], v[100:103], v[212:215], v[48:63]
    ds_read_b64_tr_b16 v[118:119], v13 offset:10752
    ds_read_b128 v[120:123], v195 offset:29696
    ds_read_b128 v[124:127], v195 offset:31744
    buffer_load_dwordx4 a[56:59], v31, s[16:19], s62 offen offset:1024 sc1
    v_mov_b32 v66, 0
    s_waitcnt lgkmcnt(10)
    v_mfma_f32_32x32x16_bf16 v[128:143], v[236:239], v[104:107], v[128:143]
    buffer_load_dwordx4 a[60:63], v31, s[16:19], s62 offen offset:2048 sc1
    v_mov_b32 v67, 0
    v_mfma_f32_32x32x16_bf16 v[144:159], v[240:243], v[108:111], v[144:159]
    ds_read_b128 v[220:223], v10 offset:16384
    ds_read_b128 v[224:227], v11 offset:16384
    ds_read_b64_tr_b16 v[90:91], v12 offset:12800
    ds_read_b64_tr_b16 v[92:93], v12 offset:14336
    ds_read_b64_tr_b16 v[94:95], v12 offset:14848
    s_mov_b32 s48, 0x05040100
    s_mov_b32 exec_hi, 0
    v_perm_b32 v64, v69, v68, s48
    v_mov_b32 v65, v68
    v_lshrrev_b32 v66, 16, v69
    s_mov_b32 exec_hi, -1
    s_waitcnt lgkmcnt(7)
    v_mfma_f32_32x32x16_bf16 v[32:47], v[112:115], v[216:219], v[32:47]
    ds_read_b64_tr_b16 v[96:97], v12 offset:12288
    ds_read_b64_tr_b16 v[98:99], v12 offset:12800
    ds_read_b64_tr_b16 v[100:101], v13 offset:12288
    s_waitcnt lgkmcnt(3)
    v_mfma_f32_16x16x32_bf16 a[196:199], a[192:195], v[84:87], a[196:199]
    v_mfma_f32_16x16x32_bf16 a[196:199], a[192:195], v[88:91], a[196:199]
    v_mfma_f32_16x16x32_bf16 a[196:199], a[192:195], v[92:95], a[196:199]
    buffer_load_dwordx4 a[64:67], v31, s[16:19], s62 offen offset:3072 sc1
    v_mfma_f32_32x32x16_bf16 v[48:63], v[116:119], v[216:219], v[48:63]
    ds_read_b64_tr_b16 v[102:103], v13 offset:12800
    ds_read_b128 v[104:107], v195 offset:32768
    ds_read_b128 v[108:111], v195 offset:34816
    s_add_u32 s62, s70, 34816
    buffer_load_dwordx4 a[68:71], v31, s[16:19], s62 offen offset:0 sc1
    v_mfma_f32_32x32x16_bf16 v[160:175], v[236:239], v[120:123], v[160:175]
    v_perm_b32 v228, v213, v212, s73
    v_perm_b32 v229, v215, v214, s73
    v_perm_b32 v230, v217, v216, s73
    v_perm_b32 v231, v219, v218, s73
    s_add_u32 s62, s70, 35840
    buffer_load_dwordx4 a[72:75], v31, s[16:19], s62 offen offset:0 sc1
    v_mfma_f32_32x32x16_bf16 v[176:191], v[240:243], v[124:127], v[176:191]
    v_perm_b32 v232, v213, v212, s74
    v_perm_b32 v233, v215, v214, s74
    v_perm_b32 v234, v217, v216, s74
    v_perm_b32 v235, v219, v218, s74
    v_accvgpr_read_b32 v16, a196
    v_accvgpr_read_b32 v17, a197
    s_mov_b64 exec, 0xffff
    ds_write2_b32 v14, v16, v17 offset0:0 offset1:16
    s_mov_b64 exec, -1
    s_waitcnt lgkmcnt(3)
    v_mfma_f32_32x32x16_bf16 v[32:47], v[96:99], v[220:223], v[32:47]
    ds_read_b64_tr_b16 v[112:113], v12 offset:14336
    ds_read_b64_tr_b16 v[114:115], v12 offset:14848
    ds_read_b64_tr_b16 v[116:117], v13 offset:14336
    buffer_load_dwordx4 a[76:79], v31, s[16:19], s62 offen offset:1024 sc1
    v_mfma_f32_32x32x16_bf16 v[48:63], v[100:103], v[220:223], v[48:63]
    ds_read_b64_tr_b16 v[118:119], v13 offset:14848
    ds_read_b128 v[120:123], v195 offset:33792
    ds_read_b128 v[124:127], v195 offset:35840
    buffer_load_dwordx4 a[80:83], v31, s[16:19], s62 offen offset:2048 sc1
    s_waitcnt lgkmcnt(7)
    s_waitcnt lgkmcnt(6)
    s_barrier
    v_mfma_f32_32x32x16_bf16 v[128:143], v[228:231], v[104:107], v[128:143]
    buffer_load_dwordx4 a[84:87], v31, s[16:19], s62 offen offset:3072 sc1
    ds_read2_b32 v[76:77], v14 offset0:0 offset1:128
    ds_read2_b32 v[82:83], v15 offset0:0 offset1:128
    v_mfma_f32_32x32x16_bf16 v[144:159], v[232:235], v[108:111], v[144:159]
    s_waitcnt lgkmcnt(4)
    v_mfma_f32_32x32x16_bf16 v[32:47], v[112:115], v[224:227], v[32:47]
    ds_read_b128 v[104:107], v195 offset:36864
    ds_read_b128 v[108:111], v195 offset:38912
    s_add_u32 s62, s70, 39936
    buffer_load_dwordx4 a[88:91], v31, s[16:19], s62 offen offset:0 sc1
    s_waitcnt lgkmcnt(3)
    v_cvt_pk_bf16_f32 v72, v76, v76
    v_cvt_pk_bf16_f32 v74, v77, v77
    v_and_b32 v73, 0xffff0000, v72
    v_mfma_f32_32x32x16_bf16 v[48:63], v[116:119], v[224:227], v[48:63]
    s_add_u32 s62, s70, 40960
    buffer_load_dwordx4 a[92:95], v31, s[16:19], s62 offen offset:0 sc1
    v_mov_b32 v75, 0
    v_sub_f32 v73, v76, v73
    v_cvt_pk_bf16_f32 v73, v73, v77
    v_mfma_f32_32x32x16_bf16 v[160:175], v[228:231], v[120:123], v[160:175]
    v_perm_b32 v236, v221, v220, s73
    v_perm_b32 v237, v223, v222, s73
    v_perm_b32 v238, v225, v224, s73
    v_perm_b32 v239, v227, v226, s73
    buffer_load_dwordx4 a[96:99], v31, s[16:19], s62 offen offset:1024 sc1
    s_waitcnt lgkmcnt(2)
    v_cvt_pk_bf16_f32 v78, v82, v82
    v_cvt_pk_bf16_f32 v80, v83, v83
    v_and_b32 v79, 0xffff0000, v78
    v_mfma_f32_32x32x16_bf16 v[176:191], v[232:235], v[124:127], v[176:191]
    v_perm_b32 v240, v221, v220, s74
    v_perm_b32 v241, v223, v222, s74
    v_perm_b32 v242, v225, v224, s74
    v_perm_b32 v243, v227, v226, s74
    v_mov_b32 v81, 0
    v_sub_f32 v79, v82, v79
    v_cvt_pk_bf16_f32 v79, v79, v83
    ds_read_b128 v[120:123], v195 offset:37888
    ds_read_b128 v[124:127], v195 offset:39936
    v_mfma_f32_32x32x16_bf16 v[32:47], v[72:75], v[64:67], v[32:47]
    v_mfma_f32_32x32x16_bf16 v[48:63], v[78:81], v[64:67], v[48:63]
    s_waitcnt lgkmcnt(2)
    v_mfma_f32_32x32x16_bf16 v[128:143], v[236:239], v[104:107], v[128:143]
    v_mfma_f32_32x32x16_bf16 v[144:159], v[240:243], v[108:111], v[144:159]
    s_waitcnt lgkmcnt(0)
    v_mfma_f32_32x32x16_bf16 v[160:175], v[236:239], v[120:123], v[160:175]
    v_mfma_f32_32x32x16_bf16 v[176:191], v[240:243], v[124:127], v[176:191]
    s_nop 4
    v_max_f32 v32, 0, v32
    v_max_f32 v33, 0, v33
    v_max_f32 v34, 0, v34
    v_max_f32 v35, 0, v35
    v_max_f32 v36, 0, v36
    v_max_f32 v37, 0, v37
    v_max_f32 v38, 0, v38
    buffer_load_dwordx4 a[100:103], v31, s[16:19], s62 offen offset:2048 sc1
    v_max_f32 v39, 0, v39
    v_mul_f32 v32, v28, v32
    v_mul_f32 v33, v28, v33
    v_mul_f32 v34, v28, v34
    v_mul_f32 v35, v28, v35
    v_mul_f32 v36, v28, v36
    v_mul_f32 v37, v28, v37
    v_mul_f32 v38, v28, v38
    v_mul_f32 v39, v28, v39
    v_mul_f32 v32, v32, v32
    v_mul_f32 v33, v33, v33
    v_mul_f32 v34, v34, v34
    v_mul_f32 v35, v35, v35
    v_mul_f32 v36, v36, v36
    v_mul_f32 v37, v37, v37
    buffer_load_dwordx4 a[104:107], v31, s[16:19], s62 offen offset:3072 sc1
    v_mul_f32 v38, v38, v38
    v_mul_f32 v39, v39, v39
    v_cvt_pk_bf16_f32 v32, v32, v33
    v_cvt_pk_bf16_f32 v33, v34, v35
    v_cvt_pk_bf16_f32 v34, v36, v37
    v_cvt_pk_bf16_f32 v35, v38, v39
    buffer_store_dwordx4 v[32:35], v30, s[16:19], s53 offen offset:0 sc1
    v_max_f32 v40, 0, v40
    v_max_f32 v41, 0, v41
    v_max_f32 v42, 0, v42
    v_max_f32 v43, 0, v43
    v_max_f32 v44, 0, v44
    v_max_f32 v45, 0, v45
    v_max_f32 v46, 0, v46
    v_max_f32 v47, 0, v47
    v_mul_f32 v40, v28, v40
    v_mul_f32 v41, v28, v41
    v_mul_f32 v42, v28, v42
    v_mul_f32 v43, v28, v43
    v_mul_f32 v44, v28, v44
    v_mul_f32 v45, v28, v45
    v_mul_f32 v46, v28, v46
    s_add_u32 s62, s70, 45056
    buffer_load_dwordx4 a[108:111], v31, s[16:19], s62 offen offset:0 sc1
    v_mul_f32 v47, v28, v47
    v_mul_f32 v40, v40, v40
    v_mul_f32 v41, v41, v41
    v_mul_f32 v42, v42, v42
    v_mul_f32 v43, v43, v43
    v_mul_f32 v44, v44, v44
    v_mul_f32 v45, v45, v45
    v_mul_f32 v46, v46, v46
    v_mul_f32 v47, v47, v47
    v_cvt_pk_bf16_f32 v40, v40, v41
    v_cvt_pk_bf16_f32 v41, v42, v43
    v_cvt_pk_bf16_f32 v42, v44, v45
    v_cvt_pk_bf16_f32 v43, v46, v47
    buffer_store_dwordx4 v[40:43], v30, s[16:19], s53 offen offset:512 sc1
    v_max_f32 v48, 0, v48
    v_max_f32 v49, 0, v49
    v_max_f32 v50, 0, v50
    v_max_f32 v51, 0, v51
    v_max_f32 v52, 0, v52
    v_max_f32 v53, 0, v53
    v_max_f32 v54, 0, v54
    s_add_u32 s62, s70, 46080
    buffer_load_dwordx4 a[112:115], v31, s[16:19], s62 offen offset:0 sc1
    v_max_f32 v55, 0, v55
    v_mul_f32 v48, v28, v48
    v_mul_f32 v49, v28, v49
    v_mul_f32 v50, v28, v50
    v_mul_f32 v51, v28, v51
    v_mul_f32 v52, v28, v52
    v_mul_f32 v53, v28, v53
    v_mul_f32 v54, v28, v54
    v_mul_f32 v55, v28, v55
    v_mul_f32 v48, v48, v48
    v_mul_f32 v49, v49, v49
    v_mul_f32 v50, v50, v50
    v_mul_f32 v51, v51, v51
    v_mul_f32 v52, v52, v52
    v_mul_f32 v53, v53, v53
    buffer_load_dwordx4 a[116:119], v31, s[16:19], s62 offen offset:1024 sc1
    v_mul_f32 v54, v54, v54
    v_mul_f32 v55, v55, v55
    v_cvt_pk_bf16_f32 v48, v48, v49
    v_cvt_pk_bf16_f32 v49, v50, v51
    v_cvt_pk_bf16_f32 v50, v52, v53
    v_cvt_pk_bf16_f32 v51, v54, v55
    buffer_store_dwordx4 v[48:51], v30, s[16:19], s54 offen offset:0 sc1
    v_max_f32 v56, 0, v56
    v_max_f32 v57, 0, v57
    v_max_f32 v58, 0, v58
    v_max_f32 v59, 0, v59
    v_max_f32 v60, 0, v60
    v_max_f32 v61, 0, v61
    v_max_f32 v62, 0, v62
    v_max_f32 v63, 0, v63
    v_mul_f32 v56, v28, v56
    v_mul_f32 v57, v28, v57
    v_mul_f32 v58, v28, v58
    v_mul_f32 v59, v28, v59
    v_mul_f32 v60, v28, v60
    v_mul_f32 v61, v28, v61
    v_mul_f32 v62, v28, v62
    buffer_load_dwordx4 a[120:123], v31, s[16:19], s62 offen offset:2048 sc1
    v_mul_f32 v63, v28, v63
    v_mul_f32 v56, v56, v56
    v_mul_f32 v57, v57, v57
    v_mul_f32 v58, v58, v58
    v_mul_f32 v59, v59, v59
    v_mul_f32 v60, v60, v60
    v_mul_f32 v61, v61, v61
    v_mul_f32 v62, v62, v62
    v_mul_f32 v63, v63, v63
    v_cvt_pk_bf16_f32 v56, v56, v57
    v_cvt_pk_bf16_f32 v57, v58, v59
    v_cvt_pk_bf16_f32 v58, v60, v61
    v_cvt_pk_bf16_f32 v59, v62, v63
    buffer_store_dwordx4 v[56:59], v30, s[16:19], s54 offen offset:512 sc1
    v_lshl_add_u32 v16, v22, 4, s72
    ds_read_b128 v[96:99], v16 offset:0
    ds_read_b128 v[100:103], v16 offset:32
    ds_read_b128 v[104:107], v16 offset:64
    ds_read_b128 v[108:111], v16 offset:96
    v_and_b32 v17, 31, v1
    v_lshlrev_b32 v21, 2, v17
    v_lshl_add_u32 v18, v22, 9, v21
    s_lshl_b32 s71, s30, 12
    v_add_u32 v18, s71, v18
    s_lshl_b32 s71, s30, 10
    v_lshl_add_u32 v19, v1, 2, s71
    s_mov_b32 s71, 81920
    v_mul_lo_u32 v21, s71, v22
    v_lshl_add_u32 v20, v17, 4, v21
    s_waitcnt lgkmcnt(0)
    v_add_f32 v228, v128, v144
    v_sub_f32 v144, v128, v144
    v_mul_f32 v128, v96, v228
    v_mul_f32 v144, v96, v144
    v_add_f32 v229, v129, v145
    v_sub_f32 v145, v129, v145
    v_mul_f32 v129, v97, v229
    v_mul_f32 v145, v97, v145
    v_add_f32 v230, v130, v146
    v_sub_f32 v146, v130, v146
    v_mul_f32 v130, v98, v230
    v_mul_f32 v146, v98, v146
    v_add_f32 v231, v131, v147
    v_sub_f32 v147, v131, v147
    v_mul_f32 v131, v99, v231
    v_mul_f32 v147, v99, v147
    v_add_f32 v228, v132, v148
    v_sub_f32 v148, v132, v148
    v_mul_f32 v132, v100, v228
    v_mul_f32 v148, v100, v148
    v_add_f32 v229, v133, v149
    v_sub_f32 v149, v133, v149
    v_mul_f32 v133, v101, v229
    v_mul_f32 v149, v101, v149
    v_add_f32 v230, v134, v150
    v_sub_f32 v150, v134, v150
    v_mul_f32 v134, v102, v230
    v_mul_f32 v150, v102, v150
    v_add_f32 v231, v135, v151
    v_sub_f32 v151, v135, v151
    v_mul_f32 v135, v103, v231
    v_mul_f32 v151, v103, v151
    v_add_f32 v228, v136, v152
    v_sub_f32 v152, v136, v152
    v_mul_f32 v136, v104, v228
    v_mul_f32 v152, v104, v152
    v_add_f32 v229, v137, v153
    v_sub_f32 v153, v137, v153
    v_mul_f32 v137, v105, v229
    v_mul_f32 v153, v105, v153
    v_add_f32 v230, v138, v154
    v_sub_f32 v154, v138, v154
    v_mul_f32 v138, v106, v230
    v_mul_f32 v154, v106, v154
    v_add_f32 v231, v139, v155
    v_sub_f32 v155, v139, v155
    v_mul_f32 v139, v107, v231
    v_mul_f32 v155, v107, v155
    v_add_f32 v228, v140, v156
    v_sub_f32 v156, v140, v156
    v_mul_f32 v140, v108, v228
    v_mul_f32 v156, v108, v156
    v_add_f32 v229, v141, v157
    v_sub_f32 v157, v141, v157
    v_mul_f32 v141, v109, v229
    v_mul_f32 v157, v109, v157
    v_add_f32 v230, v142, v158
    v_sub_f32 v158, v142, v158
    v_mul_f32 v142, v110, v230
    v_mul_f32 v158, v110, v158
    v_add_f32 v231, v143, v159
    v_sub_f32 v159, v143, v159
    v_mul_f32 v143, v111, v231
    v_mul_f32 v159, v111, v159
    v_cvt_pk_bf16_f32 v128, v128, v129
    v_cvt_pk_bf16_f32 v129, v130, v131
    v_cvt_pk_bf16_f32 v130, v132, v133
    v_cvt_pk_bf16_f32 v131, v134, v135
    v_cvt_pk_bf16_f32 v132, v136, v137
    v_cvt_pk_bf16_f32 v133, v138, v139
    v_cvt_pk_bf16_f32 v134, v140, v141
    v_cvt_pk_bf16_f32 v135, v142, v143
    v_add_f32 v228, v160, v176
    v_sub_f32 v176, v176, v160
    v_mul_f32 v160, v96, v228
    v_mul_f32 v176, v96, v176
    v_add_f32 v229, v161, v177
    v_sub_f32 v177, v177, v161
    v_mul_f32 v161, v97, v229
    v_mul_f32 v177, v97, v177
    v_add_f32 v230, v162, v178
    v_sub_f32 v178, v178, v162
    v_mul_f32 v162, v98, v230
    v_mul_f32 v178, v98, v178
    v_add_f32 v231, v163, v179
    v_sub_f32 v179, v179, v163
    v_mul_f32 v163, v99, v231
    v_mul_f32 v179, v99, v179
    v_add_f32 v228, v164, v180
    v_sub_f32 v180, v180, v164
    v_mul_f32 v164, v100, v228
    v_mul_f32 v180, v100, v180
    v_add_f32 v229, v165, v181
    v_sub_f32 v181, v181, v165
    v_mul_f32 v165, v101, v229
    v_mul_f32 v181, v101, v181
    v_add_f32 v230, v166, v182
    v_sub_f32 v182, v182, v166
    v_mul_f32 v166, v102, v230
    v_mul_f32 v182, v102, v182
    v_add_f32 v231, v167, v183
    v_sub_f32 v183, v183, v167
    v_mul_f32 v167, v103, v231
    v_mul_f32 v183, v103, v183
    v_add_f32 v228, v168, v184
    v_sub_f32 v184, v184, v168
    v_mul_f32 v168, v104, v228
    v_mul_f32 v184, v104, v184
    v_add_f32 v229, v169, v185
    v_sub_f32 v185, v185, v169
    v_mul_f32 v169, v105, v229
    v_mul_f32 v185, v105, v185
    v_add_f32 v230, v170, v186
    v_sub_f32 v186, v186, v170
    v_mul_f32 v170, v106, v230
    v_mul_f32 v186, v106, v186
    v_add_f32 v231, v171, v187
    v_sub_f32 v187, v187, v171
    v_mul_f32 v171, v107, v231
    v_mul_f32 v187, v107, v187
    v_add_f32 v228, v172, v188
    v_sub_f32 v188, v188, v172
    v_mul_f32 v172, v108, v228
    v_mul_f32 v188, v108, v188
    v_add_f32 v229, v173, v189
    v_sub_f32 v189, v189, v173
    v_mul_f32 v173, v109, v229
    v_mul_f32 v189, v109, v189
    v_add_f32 v230, v174, v190
    v_sub_f32 v190, v190, v174
    v_mul_f32 v174, v110, v230
    v_mul_f32 v190, v110, v190
    v_add_f32 v231, v175, v191
    v_sub_f32 v191, v191, v175
    v_mul_f32 v175, v111, v231
    v_mul_f32 v191, v111, v191
    v_cvt_pk_bf16_f32 v160, v160, v161
    v_cvt_pk_bf16_f32 v161, v162, v163
    v_cvt_pk_bf16_f32 v162, v164, v165
    v_cvt_pk_bf16_f32 v163, v166, v167
    v_cvt_pk_bf16_f32 v164, v168, v169
    v_cvt_pk_bf16_f32 v165, v170, v171
    v_cvt_pk_bf16_f32 v166, v172, v173
    v_cvt_pk_bf16_f32 v167, v174, v175
    v_mfma_f32_32x32x16_bf16 v[64:79], a[176:179], v[128:131], 0
    v_mfma_f32_32x32x16_bf16 v[80:95], a[184:187], v[128:131], 0
    v_mfma_f32_32x32x16_bf16 v[64:79], a[180:183], v[132:135], v[64:79]
    v_mfma_f32_32x32x16_bf16 v[80:95], a[188:191], v[132:135], v[80:95]
    v_mfma_f32_32x32x16_bf16 v[64:79], a[152:155], v[160:163], v[64:79]
    v_mfma_f32_32x32x16_bf16 v[80:95], a[176:179], v[160:163], v[80:95]
    v_mfma_f32_32x32x16_bf16 v[64:79], a[156:159], v[164:167], v[64:79]
    v_mfma_f32_32x32x16_bf16 v[80:95], a[180:183], v[164:167], v[80:95]
    s_cmp_lg_u32 s58, 8
    s_cbranch_scc1 L_spec19
    ds_read_b128 v[232:235], v16 offset:512
    ds_read_b128 v[236:239], v16 offset:544
    ds_read_b128 v[240:243], v16 offset:576
    ds_read_b128 v[244:247], v16 offset:608
    s_waitcnt lgkmcnt(0)
    s_mov_b32 exec_lo, 0x80000000
    s_mov_b32 exec_hi, 0x80000000
    v_mov_b32 v144, v232
    v_mov_b32 v176, 0
    v_mov_b32 v145, v233
    v_mov_b32 v177, 0
    v_mov_b32 v146, v234
    v_mov_b32 v178, 0
    v_mov_b32 v147, v235
    v_mov_b32 v179, 0
    v_mov_b32 v148, v236
    v_mov_b32 v180, 0
    v_mov_b32 v149, v237
    v_mov_b32 v181, 0
    v_mov_b32 v150, v238
    v_mov_b32 v182, 0
    v_mov_b32 v151, v239
    v_mov_b32 v183, 0
    v_mov_b32 v152, v240
    v_mov_b32 v184, 0
    v_mov_b32 v153, v241
    v_mov_b32 v185, 0
    v_mov_b32 v154, v242
    v_mov_b32 v186, 0
    v_mov_b32 v155, v243
    v_mov_b32 v187, 0
    v_mov_b32 v156, v244
    v_mov_b32 v188, 0
    v_mov_b32 v157, v245
    v_mov_b32 v189, 0
    v_mov_b32 v158, v246
    v_mov_b32 v190, 0
    v_mov_b32 v159, v247
    v_mov_b32 v191, 0
    s_mov_b64 exec, -1
L_spec19:
    v_cvt_pk_bf16_f32 v144, v144, v145
    v_cvt_pk_bf16_f32 v145, v146, v147
    v_cvt_pk_bf16_f32 v146, v148, v149
    v_cvt_pk_bf16_f32 v147, v150, v151
    v_cvt_pk_bf16_f32 v148, v152, v153
    v_cvt_pk_bf16_f32 v149, v154, v155
    v_cvt_pk_bf16_f32 v150, v156, v157
    v_cvt_pk_bf16_f32 v151, v158, v159
    v_cvt_pk_bf16_f32 v176, v176, v177
    v_cvt_pk_bf16_f32 v177, v178, v179
    v_cvt_pk_bf16_f32 v178, v180, v181
    v_cvt_pk_bf16_f32 v179, v182, v183
    v_cvt_pk_bf16_f32 v180, v184, v185
    v_cvt_pk_bf16_f32 v181, v186, v187
    v_cvt_pk_bf16_f32 v182, v188, v189
    v_cvt_pk_bf16_f32 v183, v190, v191
    s_waitcnt vmcnt(0)
    s_add_u32 s68, s57, 294912
    v_mov_b32 v193, 0
    v_mov_b32 v194, s43
    s_mov_b64 exec, 1
    buffer_store_dword v194, v193, s[16:19], s68 offen sc1
    s_mov_b64 exec, -1
    v_mfma_f32_32x32x16_bf16 v[196:211], a[176:179], v[144:147], 0
    v_mfma_f32_32x32x16_bf16 v[212:227], a[184:187], v[144:147], 0
    v_mfma_f32_32x32x16_bf16 v[196:211], a[180:183], v[148:151], v[196:211]
    v_mfma_f32_32x32x16_bf16 v[212:227], a[188:191], v[148:151], v[212:227]
    v_mfma_f32_32x32x16_bf16 v[196:211], a[152:155], v[176:179], v[196:211]
    v_mfma_f32_32x32x16_bf16 v[212:227], a[176:179], v[176:179], v[212:227]
    v_mfma_f32_32x32x16_bf16 v[196:211], a[156:159], v[180:183], v[196:211]
    v_mfma_f32_32x32x16_bf16 v[212:227], a[180:183], v[180:183], v[212:227]
    v_cvt_pk_bf16_f32 v64, v64, v80
    ds_write_b32 v18, v64 offset:0
    v_cvt_pk_bf16_f32 v65, v65, v81
    ds_write_b32 v18, v65 offset:128
    v_cvt_pk_bf16_f32 v66, v66, v82
    ds_write_b32 v18, v66 offset:256
    v_cvt_pk_bf16_f32 v67, v67, v83
    ds_write_b32 v18, v67 offset:384
    v_cvt_pk_bf16_f32 v68, v68, v84
    ds_write_b32 v18, v68 offset:1024
    v_cvt_pk_bf16_f32 v69, v69, v85
    ds_write_b32 v18, v69 offset:1152
    v_cvt_pk_bf16_f32 v70, v70, v86
    ds_write_b32 v18, v70 offset:1280
    v_cvt_pk_bf16_f32 v71, v71, v87
    ds_write_b32 v18, v71 offset:1408
    v_cvt_pk_bf16_f32 v72, v72, v88
    ds_write_b32 v18, v72 offset:2048
    v_cvt_pk_bf16_f32 v73, v73, v89
    ds_write_b32 v18, v73 offset:2176
    v_cvt_pk_bf16_f32 v74, v74, v90
    ds_write_b32 v18, v74 offset:2304
    v_cvt_pk_bf16_f32 v75, v75, v91
    ds_write_b32 v18, v75 offset:2432
    v_cvt_pk_bf16_f32 v76, v76, v92
    ds_write_b32 v18, v76 offset:3072
    v_cvt_pk_bf16_f32 v77, v77, v93
    ds_write_b32 v18, v77 offset:3200
    v_cvt_pk_bf16_f32 v78, v78, v94
    ds_write_b32 v18, v78 offset:3328
    v_cvt_pk_bf16_f32 v79, v79, v95
    ds_write_b32 v18, v79 offset:3456
    v_cvt_pk_bf16_f32 v196, v196, v212
    ds_write_b32 v18, v196 offset:16384
    v_cvt_pk_bf16_f32 v197, v197, v213
    ds_write_b32 v18, v197 offset:16512
    v_cvt_pk_bf16_f32 v198, v198, v214
    ds_write_b32 v18, v198 offset:16640
    v_cvt_pk_bf16_f32 v199, v199, v215
    ds_write_b32 v18, v199 offset:16768
    v_cvt_pk_bf16_f32 v200, v200, v216
    ds_write_b32 v18, v200 offset:17408
    v_cvt_pk_bf16_f32 v201, v201, v217
    ds_write_b32 v18, v201 offset:17536
    v_cvt_pk_bf16_f32 v202, v202, v218
    ds_write_b32 v18, v202 offset:17664
    v_cvt_pk_bf16_f32 v203, v203, v219
    ds_write_b32 v18, v203 offset:17792
    v_cvt_pk_bf16_f32 v204, v204, v220
    ds_write_b32 v18, v204 offset:18432
    v_cvt_pk_bf16_f32 v205, v205, v221
    ds_write_b32 v18, v205 offset:18560
    v_cvt_pk_bf16_f32 v206, v206, v222
    ds_write_b32 v18, v206 offset:18688
    v_cvt_pk_bf16_f32 v207, v207, v223
    ds_write_b32 v18, v207 offset:18816
    v_cvt_pk_bf16_f32 v208, v208, v224
    ds_write_b32 v18, v208 offset:19456
    v_cvt_pk_bf16_f32 v209, v209, v225
    ds_write_b32 v18, v209 offset:19584
    v_cvt_pk_bf16_f32 v210, v210, v226
    ds_write_b32 v18, v210 offset:19712
    v_cvt_pk_bf16_f32 v211, v211, v227
    ds_write_b32 v18, v211 offset:19840
    s_waitcnt lgkmcnt(0)
    s_barrier
    ds_read2st64_b32 v[128:129], v19 offset0:0 offset1:16
    ds_read2st64_b32 v[130:131], v19 offset0:32 offset1:48
    ds_read2st64_b32 v[132:133], v19 offset0:1 offset1:17
    ds_read2st64_b32 v[134:135], v19 offset0:33 offset1:49
    ds_read2st64_b32 v[136:137], v19 offset0:2 offset1:18
    ds_read2st64_b32 v[138:139], v19 offset0:34 offset1:50
    ds_read2st64_b32 v[140:141], v19 offset0:3 offset1:19
    ds_read2st64_b32 v[142:143], v19 offset0:35 offset1:51
    ds_read2st64_b32 v[144:145], v19 offset0:64 offset1:80
    ds_read2st64_b32 v[146:147], v19 offset0:96 offset1:112
    ds_read2st64_b32 v[148:149], v19 offset0:65 offset1:81
    ds_read2st64_b32 v[150:151], v19 offset0:97 offset1:113
    ds_read2st64_b32 v[152:153], v19 offset0:66 offset1:82
    ds_read2st64_b32 v[154:155], v19 offset0:98 offset1:114
    ds_read2st64_b32 v[156:157], v19 offset0:67 offset1:83
    ds_read2st64_b32 v[158:159], v19 offset0:99 offset1:115
    s_lshl_b32 s71, s30, 7
    s_add_u32 s71, s71, s32
    s_mul_i32 s71, s71, 5120
    s_lshl_b32 s72, s58, 8
    s_add_u32 s71, s71, s72
    s_add_u32 s71, s71, 7077888
    s_add_u32 s72, s71, 163840
    s_add_u32 s73, s71, 327680
    s_add_u32 s74, s71, 491520
    s_waitcnt lgkmcnt(14)
    buffer_store_dwordx4 v[128:131], v20, s[16:19], s71 offen offset:0 sc1
    s_waitcnt lgkmcnt(12)
    buffer_store_dwordx4 v[132:135], v20, s[16:19], s72 offen offset:0 sc1
    s_waitcnt lgkmcnt(10)
    buffer_store_dwordx4 v[136:139], v20, s[16:19], s73 offen offset:0 sc1
    s_waitcnt lgkmcnt(8)
    buffer_store_dwordx4 v[140:143], v20, s[16:19], s74 offen offset:0 sc1
    s_waitcnt lgkmcnt(6)
    buffer_store_dwordx4 v[144:147], v20, s[16:19], s71 offen offset:2560 sc1
    s_waitcnt lgkmcnt(4)
    buffer_store_dwordx4 v[148:151], v20, s[16:19], s72 offen offset:2560 sc1
    s_waitcnt lgkmcnt(2)
    buffer_store_dwordx4 v[152:155], v20, s[16:19], s73 offen offset:2560 sc1
    s_waitcnt lgkmcnt(0)
    buffer_store_dwordx4 v[156:159], v20, s[16:19], s74 offen offset:2560 sc1
    v_and_b32 v144, 15, v1
    v_lshrrev_b32 v145, 4, v1
    s_lshl_b32 s45, s30, 2
    v_add_u32 v145, s45, v145
    v_sub_u32 v146, 32, v145
    v_cmp_eq_u32 vcc, 0, v145
    s_nop 1
    v_cndmask_b32 v146, v146, 16, vcc
    s_mov_b32 s46, 0x3a000000
    s_cmp_ge_u32 s42, 4
    s_cselect_b32 s46, s46, 0xba000000
    v_cvt_f32_u32 v145, v145
    v_cvt_f32_u32 v146, v146
    s_add_u32 s62, s70, 0
    buffer_load_dwordx4 v[196:199], v31, s[16:19], s62 offen offset:0 sc1
    v_add_f32 v147, 0x42000000, v145
    v_add_f32 v148, 0x42000000, v146
    v_lshlrev_b32 v144, 6, v144
    v_add_u32 v149, s78, v144
    v_cvt_f32_u32 v149, v149
    v_mul_f32 v149, s46, v149
    v_mul_f32 v150, v149, v145
    v_mul_f32 v151, v149, v147
    v_mul_f32 v152, v149, v146
    v_mul_f32 v153, v149, v148
    v_cos_f32 v154, v150
    buffer_load_dwordx4 v[200:203], v31, s[16:19], s62 offen offset:1024 sc1
    v_sin_f32 v150, v150
    v_cos_f32 v155, v151
    v_sin_f32 v151, v151
    v_cos_f32 v156, v152
    v_sin_f32 v152, v152
    v_cos_f32 v157, v153
    v_sin_f32 v153, v153
    v_cvt_pk_bf16_f32 v150, v154, v150
    v_cvt_pk_bf16_f32 v151, v155, v151
    v_cvt_pk_bf16_f32 v152, v156, v152
    buffer_load_dwordx4 v[204:207], v31, s[16:19], s62 offen offset:2048 sc1
    v_cvt_pk_bf16_f32 v153, v157, v153
    v_accvgpr_write_b32 a160, v150
    v_accvgpr_write_b32 a161, v151
    v_accvgpr_write_b32 a162, v152
    v_accvgpr_write_b32 a163, v153
    v_add_u32 v149, s79, v144
    v_cvt_f32_u32 v149, v149
    v_mul_f32 v149, s46, v149
    v_mul_f32 v150, v149, v145
    v_mul_f32 v151, v149, v147
    v_mul_f32 v152, v149, v146
    buffer_load_dwordx4 v[208:211], v31, s[16:19], s62 offen offset:3072 sc1
    v_mul_f32 v153, v149, v148
    v_cos_f32 v154, v150
    v_sin_f32 v150, v150
    v_cos_f32 v155, v151
    v_sin_f32 v151, v151
    v_cos_f32 v156, v152
    v_sin_f32 v152, v152
    v_cos_f32 v157, v153
    v_sin_f32 v153, v153
    v_cvt_pk_bf16_f32 v150, v154, v150
    s_add_u32 s62, s70, 4096
    buffer_load_dwordx4 v[212:215], v31, s[16:19], s62 offen offset:0 sc1
    v_cvt_pk_bf16_f32 v151, v155, v151
    v_cvt_pk_bf16_f32 v152, v156, v152
    v_cvt_pk_bf16_f32 v153, v157, v153
    v_accvgpr_write_b32 a164, v150
    v_accvgpr_write_b32 a165, v151
    v_accvgpr_write_b32 a166, v152
    v_accvgpr_write_b32 a167, v153
    v_add_u32 v149, s80, v144
    v_cvt_f32_u32 v149, v149
    v_mul_f32 v149, s46, v149
    v_mul_f32 v150, v149, v145
    s_add_u32 s62, s70, 5120
    buffer_load_dwordx4 v[216:219], v31, s[16:19], s62 offen offset:0 sc1
    v_mul_f32 v151, v149, v147
    v_mul_f32 v152, v149, v146
    s_waitcnt vmcnt(6)
    v_mov_b32 v193, 4
    v_mov_b32 v194, s43
    s_mov_b64 exec, 1
    buffer_store_dword v194, v193, s[16:19], s57 offen sc1
    s_mov_b64 exec, -1
    v_mul_f32 v153, v149, v148
    v_cos_f32 v154, v150
    v_sin_f32 v150, v150
    v_cos_f32 v155, v151
    v_sin_f32 v151, v151
    v_cos_f32 v156, v152
    v_sin_f32 v152, v152
    buffer_load_dwordx4 v[220:223], v31, s[16:19], s62 offen offset:1024 sc1
    v_cos_f32 v157, v153
    v_sin_f32 v153, v153
    v_cvt_pk_bf16_f32 v150, v154, v150
    v_cvt_pk_bf16_f32 v151, v155, v151
    v_cvt_pk_bf16_f32 v152, v156, v152
    v_cvt_pk_bf16_f32 v153, v157, v153
    v_accvgpr_write_b32 a168, v150
    v_accvgpr_write_b32 a169, v151
    v_accvgpr_write_b32 a170, v152
    v_accvgpr_write_b32 a171, v153
    v_add_u32 v149, s81, v144
    buffer_load_dwordx4 v[224:227], v31, s[16:19], s62 offen offset:2048 sc1
    v_cvt_f32_u32 v149, v149
    v_mul_f32 v149, s46, v149
    v_mul_f32 v150, v149, v145
    v_mul_f32 v151, v149, v147
    v_mul_f32 v152, v149, v146
    v_mul_f32 v153, v149, v148
    v_cos_f32 v154, v150
    v_sin_f32 v150, v150
    v_cos_f32 v155, v151
    v_sin_f32 v151, v151
    buffer_load_dwordx4 v[228:231], v31, s[16:19], s62 offen offset:3072 sc1
    v_cos_f32 v156, v152
    v_sin_f32 v152, v152
    v_cos_f32 v157, v153
    v_sin_f32 v153, v153
    v_cvt_pk_bf16_f32 v150, v154, v150
    v_cvt_pk_bf16_f32 v151, v155, v151
    v_cvt_pk_bf16_f32 v152, v156, v152
    v_cvt_pk_bf16_f32 v153, v157, v153
    v_accvgpr_write_b32 a172, v150
    v_accvgpr_write_b32 a173, v151
    v_accvgpr_write_b32 a174, v152
    s_add_u32 s62, s70, 9216
    buffer_load_dwordx4 v[232:235], v31, s[16:19], s62 offen offset:0 sc1
    v_accvgpr_write_b32 a175, v153
    s_mul_i32 s82, s81, 1280
    s_mul_i32 s71, s79, 1280
    s_and_b32 s45, s78, 1024
    s_and_b32 s78, s78, 63
    s_mul_i32 s78, s78, 54
    s_add_u32 s78, s78, s61
    s_lshl_b32 s78, s78, 11
    s_add_u32 s78, s78, s45
    v_add_u32 v184, s78, v31
    s_add_u32 s62, s70, 10240
    buffer_load_dwordx4 v[236:239], v31, s[16:19], s62 offen offset:0 sc1
    v_add_u32 v188, s78, v192
    s_and_b32 s45, s79, 1024
    s_and_b32 s79, s79, 63
    s_mul_i32 s79, s79, 54
    s_add_u32 s79, s79, s61
    s_lshl_b32 s79, s79, 11
    s_add_u32 s79, s79, s45
    v_add_u32 v185, s79, v31
    v_add_u32 v189, s79, v192
    s_and_b32 s45, s80, 1024
    s_and_b32 s80, s80, 63
    buffer_load_dwordx4 v[240:243], v31, s[16:19], s62 offen offset:1024 sc1
    s_mul_i32 s80, s80, 54
    s_add_u32 s80, s80, s61
    s_lshl_b32 s80, s80, 11
    s_add_u32 s80, s80, s45
    v_add_u32 v186, s80, v31
    v_add_u32 v190, s80, v192
    s_and_b32 s45, s81, 1024
    s_and_b32 s81, s81, 63
    s_mul_i32 s81, s81, 54
    s_add_u32 s81, s81, s61
    buffer_load_dwordx4 v[244:247], v31, s[16:19], s62 offen offset:2048 sc1
    s_lshl_b32 s81, s81, 11
    s_add_u32 s81, s81, s45
    v_add_u32 v187, s81, v31
    v_add_u32 v191, s81, v192
    s_mov_b32 s36, 0
    s_movk_i32 s64, 26624
    s_movk_i32 s38, 4096
    s_movk_i32 s40, 8192
    s_movk_i32 s54, 12288
    s_movk_i32 s56, 16384
    s_movk_i32 s59, 20480
    buffer_load_dwordx4 v[248:251], v31, s[16:19], s62 offen offset:3072 sc1
    s_movk_i32 s63, 24576
    s_mul_i32 s83, s42, 160
    s_add_u32 s82, s82, s83
    s_add_u32 s71, s71, s83
    s_mov_b32 s45, 81920
    v_and_b32 v144, 15, v1
    v_mul_lo_u32 v144, s45, v144
    v_lshrrev_b32 v145, 4, v1
    v_lshl_add_u32 v10, v145, 4, v144
    v_lshl_add_u32 v11, v145, 3, v144
    s_add_u32 s62, s70, 14336
    buffer_load_dwordx4 v[252:255], v31, s[16:19], s62 offen offset:0 sc1
    v_lshl_add_u32 v12, v145, 4, s83
    v_lshl_add_u32 v146, v145, 3, s83
    buffer_load_dwordx4 v[160:163], v10, s[4:7], s71 offen
    buffer_load_dwordx4 v[164:167], v10, s[4:7], s71 offen offset:64
    buffer_load_dwordx2 v[168:169], v11, s[4:7], s71 offen offset:128
    global_load_dwordx4 v[172:175], v12, s[26:27]
    global_load_dwordx4 v[176:179], v12, s[26:27] offset:64
    global_load_dwordx2 v[180:181], v146, s[26:27] offset:128
    s_and_b32 s46, s2, 15
    s_lshr_b32 s47, s30, 1
    s_lshl_b32 s47, s47, 4
    s_add_u32 s62, s70, 46080
    buffer_load_dwordx4 a[124:127], v31, s[16:19], s62 offen offset:3072 sc1
    s_add_u32 s46, s46, s47
    s_and_b32 s47, s30, 1
    s_mul_i32 s47, s47, 96
    s_add_u32 s46, s46, s47
    s_lshl_b32 s46, s46, 2
    s_lshl_b32 s47, s31, 1
    s_add_u32 s46, s46, s47
    v_lshrrev_b32 v144, 1, v1
    v_lshlrev_b32 v144, 7, v144
    v_and_b32 v145, 1, v1
    s_add_u32 s62, s70, 50176
    buffer_load_dwordx4 a[128:131], v31, s[16:19], s62 offen offset:0 sc1
    v_add3_u32 v144, v144, v145, s46
    v_lshlrev_b32 v2, 7, v144
    v_add_u32 v2, 12255232, v2
    s_sub_u32 s66, 32, s41
    s_and_b32 s66, s66, 31
    s_cmp_ge_u32 s42, 4
    s_cselect_b32 s66, s66, s41
    v_and_b32 v144, 7, v1
    v_min_u32 v144, 4, v144
    v_lshlrev_b32 v146, 5, v144
    v_add_u32 v147, 192, v146
    v_add_u32 v146, 112, v146
    s_add_u32 s62, s70, 51200
    buffer_load_dwordx4 a[132:135], v31, s[16:19], s62 offen offset:0 sc1
    v_cmp_gt_u32 vcc, 2, v144
    s_nop 1
    v_cndmask_b32 v144, v146, v147, vcc
    v_and_b32 v145, 8, v1
    v_bfe_u32 v147, v1, 4, 1
    v_add3_u32 v144, v144, v145, v147
    s_lshl_b32 s45, s30, 3
    s_lshr_b32 s47, s66, 3
    s_add_u32 s45, s45, s47
    v_lshl_add_u32 v144, v144, 2, s45
    v_lshlrev_b32 v3, 7, v144
    v_add_u32 v3, 11960324, v3
    buffer_load_dwordx4 a[136:139], v31, s[16:19], s62 offen offset:1024 sc1
    v_lshrrev_b32 v145, 4, v1
    v_and_b32 v144, 15, v1
    s_mul_i32 s45, s42, 80
    v_and_b32 v148, 12, v1
    v_add3_u32 v148, v148, v144, s45
    v_add_u32 v144, s45, v144
    s_movk_i32 s46, 5120
    v_mul_u32_u24 v145, s46, v145
    s_cmp_ge_u32 s42, 4
    s_cselect_b32 s45, -1, 0
    s_cselect_b32 s46, 640, -1
    v_add_u32 v146, 0, v148
    v_xor_b32 v146, s45, v146
    buffer_load_dwordx4 a[140:143], v31, s[16:19], s62 offen offset:2048 sc1
    v_add_u32 v146, s46, v146
    v_sub_u32 v149, 478, v146
    v_cmp_lt_i32 vcc, 159, v146
    s_nop 1
    v_cndmask_b32 v149, v146, v149, vcc
    v_cmp_eq_u32 vcc, 319, v146
    s_nop 1
    v_cndmask_b32 v149, v149, v146, vcc
    v_lshl_add_u32 v5, v149, 4, v145
    v_mov_b32 v147, 1073741824
    v_cmp_gt_i32 vcc, 0, v146
    s_nop 1
    v_cndmask_b32 v5, v5, v147, vcc
    v_add_u32 v146, 4, v148
    v_xor_b32 v146, s45, v146
    v_add_u32 v146, s46, v146
    buffer_load_dwordx4 a[144:147], v31, s[16:19], s62 offen offset:3072 sc1
    v_sub_u32 v149, 478, v146
    v_cmp_lt_i32 vcc, 159, v146
    s_nop 1
    v_cndmask_b32 v149, v146, v149, vcc
    v_lshl_add_u32 v6, v149, 4, v145
    v_add_u32 v146, 32, v148
    v_xor_b32 v146, s45, v146
    v_add_u32 v146, s46, v146
    v_sub_u32 v149, 478, v146
    v_cmp_lt_i32 vcc, 159, v146
    s_nop 1
    v_cndmask_b32 v149, v146, v149, vcc
    v_lshl_add_u32 v7, v149, 4, v145
    v_add_u32 v146, 36, v148
    v_xor_b32 v146, s45, v146
    s_add_u32 s62, s70, 55296
    buffer_load_dwordx4 a[148:151], v31, s[16:19], s62 offen offset:0 sc1
    v_add_u32 v146, s46, v146
    v_sub_u32 v149, 478, v146
    v_cmp_lt_i32 vcc, 159, v146
    s_nop 1
    v_cndmask_b32 v149, v146, v149, vcc
    v_lshl_add_u32 v8, v149, 4, v145
    v_add_u32 v146, 64, v144
    v_xor_b32 v146, s45, v146
    v_add_u32 v146, s46, v146
    v_sub_u32 v149, 478, v146
    v_cmp_lt_i32 vcc, 159, v146
    s_nop 1
    v_cndmask_b32 v149, v146, v149, vcc
    v_lshl_add_u32 v9, v149, 4, v145
    s_add_u32 s62, s70, 56320
    buffer_load_dwordx4 a[240:243], v31, s[16:19], s62 offen offset:0 sc1
    s_lshl_b32 s65, s66, 4
    s_lshl_b32 s45, s30, 2
    s_add_u32 s65, s65, s45
    s_mul_i32 s65, s65, 5120
    s_add_u32 s65, s65, 7077888
    s_mul_i32 s45, s30, 15360
    s_add_u32 s45, s45, 65536
    v_add_u32 v13, s45, v31
    s_xor_b32 s45, s30, 2
    s_mul_i32 s45, s45, 15360
    s_add_u32 s45, s45, 65536
    buffer_load_dwordx4 a[244:247], v31, s[16:19], s62 offen offset:1024 sc1
    v_add_u32 v14, s45, v31
    s_add_u32 s45, s30, 1
    s_and_b32 s45, s45, 3
    s_mul_i32 s45, s45, 15360
    s_add_u32 s45, s45, 65536
    v_add_u32 v15, s45, v31
    s_add_u32 s45, s30, 3
    s_and_b32 s45, s45, 3
    s_mul_i32 s45, s45, 15360
    s_add_u32 s45, s45, 65536
    v_add_u32 v0, s45, v31
    buffer_load_dwordx4 a[248:251], v31, s[16:19], s62 offen offset:2048 sc1
    v_mov_b32 v1, v31
    s_mov_b64 exec, 0x3ff
    buffer_load_dword v4, v2, s[16:19], 0 offen sc1
    s_mov_b64 exec, -1
    s_waitcnt vmcnt(11)
    s_mov_b32 s45, 0x05040100
    s_mov_b32 s46, 0x07060302
    v_perm_b32 v36, v172, v160, s45
    buffer_load_dwordx4 a[252:255], v1, s[16:19], s62 offen offset:3072 sc1
    v_perm_b32 v37, v172, v160, s46
    v_perm_b32 v38, v173, v161, s45
    v_perm_b32 v39, v173, v161, s46
    v_perm_b32 v40, v174, v162, s45
    s_add_u32 s62, s70, 60416
    buffer_load_dwordx4 a[152:155], v1, s[16:19], s62 offen offset:0 sc1
    v_perm_b32 v41, v174, v162, s46
    v_perm_b32 v42, v175, v163, s45
    v_perm_b32 v43, v175, v163, s46
    s_add_u32 s62, s70, 61440
    buffer_load_dwordx4 a[0:3], v1, s[16:19], s62 offen offset:0 sc1
    v_perm_b32 v44, v176, v164, s45
    v_perm_b32 v45, v176, v164, s46
    v_perm_b32 v46, v177, v165, s45
    v_perm_b32 v47, v177, v165, s46
    buffer_load_dwordx4 a[4:7], v1, s[16:19], s62 offen offset:1024 sc1
    v_perm_b32 v48, v178, v166, s45
    v_perm_b32 v49, v178, v166, s46
    v_perm_b32 v50, v179, v167, s45
    buffer_load_dwordx4 a[8:11], v1, s[16:19], s62 offen offset:2048 sc1
    v_perm_b32 v51, v179, v167, s46
    v_perm_b32 v52, v180, v168, s45
    v_perm_b32 v53, v180, v168, s46
    v_perm_b32 v54, v181, v169, s45
    buffer_load_dwordx4 a[12:15], v1, s[16:19], s62 offen offset:3072 sc1
    v_perm_b32 v55, v181, v169, s46
    v_dot2_f32_bf16 v36, v36, s44, 0
    v_dot2_f32_bf16 v37, v37, s44, 0
    s_add_u32 s62, s70, 65536
    buffer_load_dwordx4 a[156:159], v1, s[16:19], s62 offen offset:0 sc1
    v_dot2_f32_bf16 v38, v38, s44, 0
    v_dot2_f32_bf16 v39, v39, s44, 0
    v_dot2_f32_bf16 v40, v40, s44, 0
    v_dot2_f32_bf16 v41, v41, s44, 0
    s_add_u32 s62, s70, 66560
    buffer_load_dwordx4 a[16:19], v192, s[16:19], s62 offen offset:0 sc1
    v_dot2_f32_bf16 v42, v42, s44, 0
    v_dot2_f32_bf16 v43, v43, s44, 0
    v_dot2_f32_bf16 v44, v44, s44, 0
    buffer_load_dwordx4 a[20:23], v192, s[16:19], s62 offen offset:1024 sc1
    v_dot2_f32_bf16 v45, v45, s44, 0
    v_dot2_f32_bf16 v46, v46, s44, 0
    v_dot2_f32_bf16 v47, v47, s44, 0
    v_dot2_f32_bf16 v48, v48, s44, 0
    buffer_load_dwordx4 a[24:27], v192, s[16:19], s62 offen offset:2048 sc1
    v_dot2_f32_bf16 v49, v49, s44, 0
    v_dot2_f32_bf16 v50, v50, s44, 0
    v_dot2_f32_bf16 v51, v51, s44, 0
    buffer_load_dwordx4 a[28:31], v192, s[16:19], s62 offen offset:3072 sc1
    v_dot2_f32_bf16 v52, v52, s44, 0
    v_dot2_f32_bf16 v53, v53, s44, 0
    v_dot2_f32_bf16 v54, v54, s44, 0
    v_dot2_f32_bf16 v55, v55, s44, 0
    s_add_u32 s62, s70, 70656
    buffer_load_dwordx4 a[196:199], v192, s[16:19], s62 offen offset:0 sc1
    s_waitcnt vmcnt(12)
    s_mov_b32 exec_lo, 0x3ff
    s_mov_b32 exec_hi, 0x0
    v_cmp_ne_u32 vcc, s43, v4
    s_mov_b32 s51, 0
    s_cbranch_vccz L_ok20
L_lp21:
    s_sleep 1
    buffer_load_dword v4, v2, s[16:19], 0 offen sc1
    s_waitcnt vmcnt(0)
    v_cmp_ne_u32 vcc, s43, v4
    s_add_u32 s51, s51, 1
    s_cmp_gt_u32 s51, 100000
    s_cbranch_scc1 L_ok20
    s_cbranch_vccnz L_lp21
L_ok20:
    s_mov_b64 exec, -1
    buffer_load_dwordx4 v[96:99], v184, s[16:19], s36 offen offset:0 sc1
    buffer_load_dwordx4 v[100:103], v184, s[16:19], s36 offen offset:2048 sc1
    buffer_load_dwordx4 v[104:107], v184, s[16:19], s38 offen offset:0 sc1
    buffer_load_dwordx4 v[108:111], v184, s[16:19], s38 offen offset:2048 sc1
    buffer_load_dwordx4 v[112:115], v184, s[16:19], s40 offen offset:0 sc1
    buffer_load_dwordx4 v[116:119], v184, s[16:19], s40 offen offset:2048 sc1
    buffer_load_dwordx4 v[120:123], v184, s[16:19], s54 offen offset:0 sc1
    buffer_load_dwordx4 v[124:127], v184, s[16:19], s54 offen offset:2048 sc1
    buffer_load_dwordx4 v[128:131], v184, s[16:19], s56 offen offset:0 sc1
    buffer_load_dwordx4 v[132:135], v184, s[16:19], s56 offen offset:2048 sc1
    s_waitcnt vmcnt(9)
    v_mfma_f32_16x16x32_bf16 v[16:19], v[196:199], v[96:99], 0
    v_mfma_f32_16x16x32_bf16 v[20:23], v[200:203], v[96:99], 0
    v_mfma_f32_16x16x32_bf16 v[24:27], v[204:207], v[96:99], 0
    v_mfma_f32_16x16x32_bf16 v[28:31], v[208:211], v[96:99], 0
    v_mfma_f32_16x16x32_bf16 v[32:35], v[212:215], v[96:99], 0
    buffer_load_dwordx4 v[96:99], v184, s[16:19], s59 offen offset:0 sc1
    s_waitcnt vmcnt(9)
    v_mfma_f32_16x16x32_bf16 v[16:19], v[216:219], v[100:103], v[16:19]
    v_mfma_f32_16x16x32_bf16 v[20:23], v[220:223], v[100:103], v[20:23]
    v_mfma_f32_16x16x32_bf16 v[24:27], v[224:227], v[100:103], v[24:27]
    v_mfma_f32_16x16x32_bf16 v[28:31], v[228:231], v[100:103], v[28:31]
    v_mfma_f32_16x16x32_bf16 v[32:35], v[232:235], v[100:103], v[32:35]
    buffer_load_dwordx4 v[100:103], v184, s[16:19], s59 offen offset:2048 sc1
    s_waitcnt vmcnt(9)
    v_mfma_f32_16x16x32_bf16 v[16:19], v[236:239], v[104:107], v[16:19]
    v_mfma_f32_16x16x32_bf16 v[20:23], v[240:243], v[104:107], v[20:23]
    v_mfma_f32_16x16x32_bf16 v[24:27], v[244:247], v[104:107], v[24:27]
    v_mfma_f32_16x16x32_bf16 v[28:31], v[248:251], v[104:107], v[28:31]
    v_mfma_f32_16x16x32_bf16 v[32:35], v[252:255], v[104:107], v[32:35]
    buffer_load_dwordx4 v[104:107], v184, s[16:19], s63 offen offset:0 sc1
    s_waitcnt vmcnt(9)
    v_mfma_f32_16x16x32_bf16 v[16:19], a[200:203], v[108:111], v[16:19]
    v_mfma_f32_16x16x32_bf16 v[20:23], a[204:207], v[108:111], v[20:23]
    v_mfma_f32_16x16x32_bf16 v[24:27], a[208:211], v[108:111], v[24:27]
    v_mfma_f32_16x16x32_bf16 v[28:31], a[212:215], v[108:111], v[28:31]
    v_mfma_f32_16x16x32_bf16 v[32:35], a[216:219], v[108:111], v[32:35]
    buffer_load_dwordx4 v[108:111], v188, s[16:19], s63 offen offset:2048 sc1
    s_waitcnt vmcnt(9)
    v_mfma_f32_16x16x32_bf16 v[16:19], a[220:223], v[112:115], v[16:19]
    v_mfma_f32_16x16x32_bf16 v[20:23], a[224:227], v[112:115], v[20:23]
    v_mfma_f32_16x16x32_bf16 v[24:27], a[228:231], v[112:115], v[24:27]
    v_mfma_f32_16x16x32_bf16 v[28:31], a[232:235], v[112:115], v[28:31]
    v_mfma_f32_16x16x32_bf16 v[32:35], a[236:239], v[112:115], v[32:35]
    buffer_load_dwordx4 v[112:115], v185, s[16:19], s36 offen offset:0 sc1
    s_waitcnt vmcnt(9)
    v_mfma_f32_16x16x32_bf16 v[16:19], a[32:35], v[116:119], v[16:19]
    v_mfma_f32_16x16x32_bf16 v[20:23], a[36:39], v[116:119], v[20:23]
    v_mfma_f32_16x16x32_bf16 v[24:27], a[40:43], v[116:119], v[24:27]
    v_mfma_f32_16x16x32_bf16 v[28:31], a[44:47], v[116:119], v[28:31]
    v_mfma_f32_16x16x32_bf16 v[32:35], a[48:51], v[116:119], v[32:35]
    buffer_load_dwordx4 v[116:119], v185, s[16:19], s36 offen offset:2048 sc1
    s_waitcnt vmcnt(9)
    v_mfma_f32_16x16x32_bf16 v[16:19], a[52:55], v[120:123], v[16:19]
    v_mfma_f32_16x16x32_bf16 v[20:23], a[56:59], v[120:123], v[20:23]
    v_mfma_f32_16x16x32_bf16 v[24:27], a[60:63], v[120:123], v[24:27]
    v_mfma_f32_16x16x32_bf16 v[28:31], a[64:67], v[120:123], v[28:31]
    v_mfma_f32_16x16x32_bf16 v[32:35], a[68:71], v[120:123], v[32:35]
    buffer_load_dwordx4 v[120:123], v185, s[16:19], s38 offen offset:0 sc1
    s_waitcnt vmcnt(9)
    v_mfma_f32_16x16x32_bf16 v[16:19], a[72:75], v[124:127], v[16:19]
    v_mfma_f32_16x16x32_bf16 v[20:23], a[76:79], v[124:127], v[20:23]
    v_mfma_f32_16x16x32_bf16 v[24:27], a[80:83], v[124:127], v[24:27]
    v_mfma_f32_16x16x32_bf16 v[28:31], a[84:87], v[124:127], v[28:31]
    v_mfma_f32_16x16x32_bf16 v[32:35], a[88:91], v[124:127], v[32:35]
    buffer_load_dwordx4 v[124:127], v185, s[16:19], s38 offen offset:2048 sc1
    s_waitcnt vmcnt(9)
    v_mfma_f32_16x16x32_bf16 v[16:19], a[92:95], v[128:131], v[16:19]
    v_mfma_f32_16x16x32_bf16 v[20:23], a[96:99], v[128:131], v[20:23]
    v_mfma_f32_16x16x32_bf16 v[24:27], a[100:103], v[128:131], v[24:27]
    v_mfma_f32_16x16x32_bf16 v[28:31], a[104:107], v[128:131], v[28:31]
    v_mfma_f32_16x16x32_bf16 v[32:35], a[108:111], v[128:131], v[32:35]
    buffer_load_dwordx4 v[128:131], v185, s[16:19], s40 offen offset:0 sc1
    s_waitcnt vmcnt(9)
    v_mfma_f32_16x16x32_bf16 v[16:19], a[112:115], v[132:135], v[16:19]
    v_mfma_f32_16x16x32_bf16 v[20:23], a[116:119], v[132:135], v[20:23]
    v_mfma_f32_16x16x32_bf16 v[24:27], a[120:123], v[132:135], v[24:27]
    v_mfma_f32_16x16x32_bf16 v[28:31], a[124:127], v[132:135], v[28:31]
    v_mfma_f32_16x16x32_bf16 v[32:35], a[128:131], v[132:135], v[32:35]
    buffer_load_dwordx4 v[132:135], v185, s[16:19], s40 offen offset:2048 sc1
    s_waitcnt vmcnt(9)
    v_mfma_f32_16x16x32_bf16 v[16:19], a[132:135], v[96:99], v[16:19]
    v_mfma_f32_16x16x32_bf16 v[20:23], a[136:139], v[96:99], v[20:23]
    s_mov_b32 exec_hi, 0
    buffer_load_dword v4, v3, s[16:19], 0 offen sc1
    s_mov_b32 exec_hi, -1
    v_mfma_f32_16x16x32_bf16 v[24:27], a[140:143], v[96:99], v[24:27]
    v_mfma_f32_16x16x32_bf16 v[28:31], a[144:147], v[96:99], v[28:31]
    v_mfma_f32_16x16x32_bf16 v[32:35], a[148:151], v[96:99], v[32:35]
    buffer_load_dwordx4 v[96:99], v185, s[16:19], s54 offen offset:0 sc1
    s_waitcnt vmcnt(10)
    v_mfma_f32_16x16x32_bf16 v[16:19], a[240:243], v[100:103], v[16:19]
    v_mfma_f32_16x16x32_bf16 v[20:23], a[244:247], v[100:103], v[20:23]
    v_mfma_f32_16x16x32_bf16 v[24:27], a[248:251], v[100:103], v[24:27]
    v_mfma_f32_16x16x32_bf16 v[28:31], a[252:255], v[100:103], v[28:31]
    v_mfma_f32_16x16x32_bf16 v[32:35], a[152:155], v[100:103], v[32:35]
    buffer_load_dwordx4 v[100:103], v185, s[16:19], s54 offen offset:2048 sc1
    s_waitcnt vmcnt(10)
    v_mfma_f32_16x16x32_bf16 v[16:19], a[0:3], v[104:107], v[16:19]
    v_mfma_f32_16x16x32_bf16 v[20:23], a[4:7], v[104:107], v[20:23]
    v_mfma_f32_16x16x32_bf16 v[24:27], a[8:11], v[104:107], v[24:27]
    v_mfma_f32_16x16x32_bf16 v[28:31], a[12:15], v[104:107], v[28:31]
    v_mfma_f32_16x16x32_bf16 v[32:35], a[156:159], v[104:107], v[32:35]
    buffer_load_dwordx4 v[104:107], v185, s[16:19], s56 offen offset:0 sc1
    s_waitcnt vmcnt(10)
    v_mfma_f32_16x16x32_bf16 v[16:19], a[16:19], v[108:111], v[16:19]
    v_mfma_f32_16x16x32_bf16 v[20:23], a[20:23], v[108:111], v[20:23]
    v_mfma_f32_16x16x32_bf16 v[24:27], a[24:27], v[108:111], v[24:27]
    v_mfma_f32_16x16x32_bf16 v[28:31], a[28:31], v[108:111], v[28:31]
    v_mfma_f32_16x16x32_bf16 v[32:35], a[196:199], v[108:111], v[32:35]
    buffer_load_dwordx4 v[108:111], v185, s[16:19], s56 offen offset:2048 sc1
    s_waitcnt vmcnt(10)
    v_mfma_f32_16x16x32_bf16 v[36:39], v[196:199], v[112:115], v[36:39]
    v_mfma_f32_16x16x32_bf16 v[40:43], v[200:203], v[112:115], v[40:43]
    v_mfma_f32_16x16x32_bf16 v[44:47], v[204:207], v[112:115], v[44:47]
    v_mfma_f32_16x16x32_bf16 v[48:51], v[208:211], v[112:115], v[48:51]
    v_mfma_f32_16x16x32_bf16 v[52:55], v[212:215], v[112:115], v[52:55]
    buffer_load_dwordx4 v[112:115], v185, s[16:19], s59 offen offset:0 sc1
    s_waitcnt vmcnt(10)
    v_mfma_f32_16x16x32_bf16 v[36:39], v[216:219], v[116:119], v[36:39]
    v_mfma_f32_16x16x32_bf16 v[40:43], v[220:223], v[116:119], v[40:43]
    v_mfma_f32_16x16x32_bf16 v[44:47], v[224:227], v[116:119], v[44:47]
    v_mfma_f32_16x16x32_bf16 v[48:51], v[228:231], v[116:119], v[48:51]
    v_mfma_f32_16x16x32_bf16 v[52:55], v[232:235], v[116:119], v[52:55]
    buffer_load_dwordx4 v[116:119], v185, s[16:19], s59 offen offset:2048 sc1
    s_waitcnt vmcnt(10)
    v_mfma_f32_16x16x32_bf16 v[36:39], v[236:239], v[120:123], v[36:39]
    v_mfma_f32_16x16x32_bf16 v[40:43], v[240:243], v[120:123], v[40:43]
    v_mfma_f32_16x16x32_bf16 v[44:47], v[244:247], v[120:123], v[44:47]
    v_mfma_f32_16x16x32_bf16 v[48:51], v[248:251], v[120:123], v[48:51]
    v_mfma_f32_16x16x32_bf16 v[52:55], v[252:255], v[120:123], v[52:55]
    buffer_load_dwordx4 v[120:123], v185, s[16:19], s63 offen offset:0 sc1
    s_waitcnt vmcnt(10)
    v_mfma_f32_16x16x32_bf16 v[36:39], a[200:203], v[124:127], v[36:39]
    v_mfma_f32_16x16x32_bf16 v[40:43], a[204:207], v[124:127], v[40:43]
    v_mfma_f32_16x16x32_bf16 v[44:47], a[208:211], v[124:127], v[44:47]
    v_mfma_f32_16x16x32_bf16 v[48:51], a[212:215], v[124:127], v[48:51]
    v_mfma_f32_16x16x32_bf16 v[52:55], a[216:219], v[124:127], v[52:55]
    buffer_load_dwordx4 v[124:127], v189, s[16:19], s63 offen offset:2048 sc1
    s_waitcnt vmcnt(10)
    v_mfma_f32_16x16x32_bf16 v[36:39], a[220:223], v[128:131], v[36:39]
    v_mfma_f32_16x16x32_bf16 v[40:43], a[224:227], v[128:131], v[40:43]
    v_mfma_f32_16x16x32_bf16 v[44:47], a[228:231], v[128:131], v[44:47]
    v_mfma_f32_16x16x32_bf16 v[48:51], a[232:235], v[128:131], v[48:51]
    v_mfma_f32_16x16x32_bf16 v[52:55], a[236:239], v[128:131], v[52:55]
    buffer_load_dwordx4 v[128:131], v186, s[16:19], s36 offen offset:0 sc1
    s_waitcnt vmcnt(10)
    v_mfma_f32_16x16x32_bf16 v[36:39], a[32:35], v[132:135], v[36:39]
    v_mfma_f32_16x16x32_bf16 v[40:43], a[36:39], v[132:135], v[40:43]
    v_mfma_f32_16x16x32_bf16 v[44:47], a[40:43], v[132:135], v[44:47]
    v_mfma_f32_16x16x32_bf16 v[48:51], a[44:47], v[132:135], v[48:51]
    v_mfma_f32_16x16x32_bf16 v[52:55], a[48:51], v[132:135], v[52:55]
    buffer_load_dwordx4 v[132:135], v186, s[16:19], s36 offen offset:2048 sc1
    s_waitcnt vmcnt(9)
    v_mfma_f32_16x16x32_bf16 v[36:39], a[52:55], v[96:99], v[36:39]
    v_mfma_f32_16x16x32_bf16 v[40:43], a[56:59], v[96:99], v[40:43]
    v_mfma_f32_16x16x32_bf16 v[44:47], a[60:63], v[96:99], v[44:47]
    v_mfma_f32_16x16x32_bf16 v[48:51], a[64:67], v[96:99], v[48:51]
    v_mfma_f32_16x16x32_bf16 v[52:55], a[68:71], v[96:99], v[52:55]
    buffer_load_dwordx4 v[96:99], v186, s[16:19], s38 offen offset:0 sc1
    s_waitcnt vmcnt(9)
    v_mfma_f32_16x16x32_bf16 v[36:39], a[72:75], v[100:103], v[36:39]
    v_mfma_f32_16x16x32_bf16 v[40:43], a[76:79], v[100:103], v[40:43]
    v_mfma_f32_16x16x32_bf16 v[44:47], a[80:83], v[100:103], v[44:47]
    v_mfma_f32_16x16x32_bf16 v[48:51], a[84:87], v[100:103], v[48:51]
    v_mfma_f32_16x16x32_bf16 v[52:55], a[88:91], v[100:103], v[52:55]
    buffer_load_dwordx4 v[100:103], v186, s[16:19], s38 offen offset:2048 sc1
    s_waitcnt vmcnt(9)
    v_mfma_f32_16x16x32_bf16 v[36:39], a[92:95], v[104:107], v[36:39]
    v_mfma_f32_16x16x32_bf16 v[40:43], a[96:99], v[104:107], v[40:43]
    s_mov_b32 exec_lo, 0xffffffff
    s_mov_b32 exec_hi, 0x0
    v_cmp_ne_u32 vcc, s43, v4
    s_mov_b32 s51, 0
    s_cbranch_vccz L_ok22
L_lp23:
    s_sleep 1
    buffer_load_dword v4, v3, s[16:19], 0 offen sc1
    s_waitcnt vmcnt(0)
    v_cmp_ne_u32 vcc, s43, v4
    s_add_u32 s51, s51, 1
    s_cmp_gt_u32 s51, 100000
    s_cbranch_scc1 L_ok22
    s_cbranch_vccnz L_lp23
L_ok22:
    s_mov_b64 exec, -1
    v_mfma_f32_16x16x32_bf16 v[44:47], a[100:103], v[104:107], v[44:47]
    v_mfma_f32_16x16x32_bf16 v[48:51], a[104:107], v[104:107], v[48:51]
    buffer_load_dwordx4 a[176:179], v5, s[16:19], s65 offen sc1
    v_mfma_f32_16x16x32_bf16 v[52:55], a[108:111], v[104:107], v[52:55]
    buffer_load_dwordx4 v[104:107], v186, s[16:19], s40 offen offset:0 sc1
    s_waitcnt vmcnt(10)
    v_mfma_f32_16x16x32_bf16 v[36:39], a[112:115], v[108:111], v[36:39]
    v_mfma_f32_16x16x32_bf16 v[40:43], a[116:119], v[108:111], v[40:43]
    v_mfma_f32_16x16x32_bf16 v[44:47], a[120:123], v[108:111], v[44:47]
    v_mfma_f32_16x16x32_bf16 v[48:51], a[124:127], v[108:111], v[48:51]
    buffer_load_dwordx4 a[180:183], v6, s[16:19], s65 offen sc1
    v_mfma_f32_16x16x32_bf16 v[52:55], a[128:131], v[108:111], v[52:55]
    buffer_load_dwordx4 v[108:111], v186, s[16:19], s40 offen offset:2048 sc1
    s_waitcnt vmcnt(11)
    v_mfma_f32_16x16x32_bf16 v[36:39], a[132:135], v[112:115], v[36:39]
    v_mfma_f32_16x16x32_bf16 v[40:43], a[136:139], v[112:115], v[40:43]
    v_mfma_f32_16x16x32_bf16 v[44:47], a[140:143], v[112:115], v[44:47]
    v_mfma_f32_16x16x32_bf16 v[48:51], a[144:147], v[112:115], v[48:51]
    buffer_load_dwordx4 a[184:187], v7, s[16:19], s65 offen sc1
    v_mfma_f32_16x16x32_bf16 v[52:55], a[148:151], v[112:115], v[52:55]
    buffer_load_dwordx4 v[112:115], v186, s[16:19], s54 offen offset:0 sc1
    s_waitcnt vmcnt(12)
    v_mfma_f32_16x16x32_bf16 v[36:39], a[240:243], v[116:119], v[36:39]
    v_mfma_f32_16x16x32_bf16 v[40:43], a[244:247], v[116:119], v[40:43]
    v_mfma_f32_16x16x32_bf16 v[44:47], a[248:251], v[116:119], v[44:47]
    v_mfma_f32_16x16x32_bf16 v[48:51], a[252:255], v[116:119], v[48:51]
    buffer_load_dwordx4 a[188:191], v8, s[16:19], s65 offen sc1
    v_mfma_f32_16x16x32_bf16 v[52:55], a[152:155], v[116:119], v[52:55]
    buffer_load_dwordx4 v[116:119], v186, s[16:19], s54 offen offset:2048 sc1
    s_waitcnt vmcnt(13)
    v_mfma_f32_16x16x32_bf16 v[36:39], a[0:3], v[120:123], v[36:39]
    v_mfma_f32_16x16x32_bf16 v[40:43], a[4:7], v[120:123], v[40:43]
    v_mfma_f32_16x16x32_bf16 v[44:47], a[8:11], v[120:123], v[44:47]
    v_mfma_f32_16x16x32_bf16 v[48:51], a[12:15], v[120:123], v[48:51]
    buffer_load_dwordx4 a[192:195], v9, s[16:19], s65 offen sc1
    v_mfma_f32_16x16x32_bf16 v[52:55], a[156:159], v[120:123], v[52:55]
    buffer_load_dwordx4 v[120:123], v186, s[16:19], s56 offen offset:0 sc1
    s_waitcnt vmcnt(14)
    v_mfma_f32_16x16x32_bf16 v[36:39], a[16:19], v[124:127], v[36:39]
    v_mfma_f32_16x16x32_bf16 v[40:43], a[20:23], v[124:127], v[40:43]
    v_mfma_f32_16x16x32_bf16 v[44:47], a[24:27], v[124:127], v[44:47]
    v_mfma_f32_16x16x32_bf16 v[48:51], a[28:31], v[124:127], v[48:51]
    v_mfma_f32_16x16x32_bf16 v[52:55], a[196:199], v[124:127], v[52:55]
    buffer_load_dwordx4 v[124:127], v186, s[16:19], s56 offen offset:2048 sc1
    s_waitcnt vmcnt(14)
    v_mfma_f32_16x16x32_bf16 v[56:59], v[196:199], v[128:131], 0
    v_mfma_f32_16x16x32_bf16 v[60:63], v[200:203], v[128:131], 0
    v_mfma_f32_16x16x32_bf16 v[64:67], v[204:207], v[128:131], 0
    v_mfma_f32_16x16x32_bf16 v[68:71], v[208:211], v[128:131], 0
    v_mfma_f32_16x16x32_bf16 v[72:75], v[212:215], v[128:131], 0
    buffer_load_dwordx4 v[128:131], v186, s[16:19], s59 offen offset:0 sc1
    s_waitcnt vmcnt(14)
    v_mfma_f32_16x16x32_bf16 v[56:59], v[216:219], v[132:135], v[56:59]
    v_mfma_f32_16x16x32_bf16 v[60:63], v[220:223], v[132:135], v[60:63]
    v_mfma_f32_16x16x32_bf16 v[64:67], v[224:227], v[132:135], v[64:67]
    v_mfma_f32_16x16x32_bf16 v[68:71], v[228:231], v[132:135], v[68:71]
    v_mfma_f32_16x16x32_bf16 v[72:75], v[232:235], v[132:135], v[72:75]
    buffer_load_dwordx4 v[132:135], v186, s[16:19], s59 offen offset:2048 sc1
    s_waitcnt vmcnt(14)
    v_mfma_f32_16x16x32_bf16 v[56:59], v[236:239], v[96:99], v[56:59]
    v_mfma_f32_16x16x32_bf16 v[60:63], v[240:243], v[96:99], v[60:63]
    v_mfma_f32_16x16x32_bf16 v[64:67], v[244:247], v[96:99], v[64:67]
    v_mfma_f32_16x16x32_bf16 v[68:71], v[248:251], v[96:99], v[68:71]
    v_mfma_f32_16x16x32_bf16 v[72:75], v[252:255], v[96:99], v[72:75]
    buffer_load_dwordx4 v[96:99], v186, s[16:19], s63 offen offset:0 sc1
    s_waitcnt vmcnt(14)
    v_mfma_f32_16x16x32_bf16 v[56:59], a[200:203], v[100:103], v[56:59]
    v_mfma_f32_16x16x32_bf16 v[60:63], a[204:207], v[100:103], v[60:63]
    v_mfma_f32_16x16x32_bf16 v[64:67], a[208:211], v[100:103], v[64:67]
    v_mfma_f32_16x16x32_bf16 v[68:71], a[212:215], v[100:103], v[68:71]
    v_mfma_f32_16x16x32_bf16 v[72:75], a[216:219], v[100:103], v[72:75]
    buffer_load_dwordx4 v[100:103], v190, s[16:19], s63 offen offset:2048 sc1
    s_waitcnt vmcnt(13)
    v_mfma_f32_16x16x32_bf16 v[56:59], a[220:223], v[104:107], v[56:59]
    v_mfma_f32_16x16x32_bf16 v[60:63], a[224:227], v[104:107], v[60:63]
    v_mfma_f32_16x16x32_bf16 v[64:67], a[228:231], v[104:107], v[64:67]
    v_mfma_f32_16x16x32_bf16 v[68:71], a[232:235], v[104:107], v[68:71]
    v_mfma_f32_16x16x32_bf16 v[72:75], a[236:239], v[104:107], v[72:75]
    buffer_load_dwordx4 v[104:107], v187, s[16:19], s36 offen offset:0 sc1
    s_waitcnt vmcnt(12)
    v_mfma_f32_16x16x32_bf16 v[56:59], a[32:35], v[108:111], v[56:59]
    v_mfma_f32_16x16x32_bf16 v[60:63], a[36:39], v[108:111], v[60:63]
    v_mfma_f32_16x16x32_bf16 v[64:67], a[40:43], v[108:111], v[64:67]
    v_mfma_f32_16x16x32_bf16 v[68:71], a[44:47], v[108:111], v[68:71]
    v_mfma_f32_16x16x32_bf16 v[72:75], a[48:51], v[108:111], v[72:75]
    buffer_load_dwordx4 v[108:111], v187, s[16:19], s36 offen offset:2048 sc1
    s_waitcnt vmcnt(8)
    v_mfma_f32_16x16x32_bf16 v[36:39], a[176:179], a[164:167], v[36:39]
    v_mfma_f32_16x16x32_bf16 v[40:43], a[180:183], a[164:167], v[40:43]
    v_mfma_f32_16x16x32_bf16 v[44:47], a[184:187], a[164:167], v[44:47]
    v_mfma_f32_16x16x32_bf16 v[48:51], a[188:191], a[164:167], v[48:51]
    v_mfma_f32_16x16x32_bf16 v[52:55], a[192:195], a[164:167], v[52:55]
    v_mfma_f32_16x16x32_bf16 v[16:19], a[176:179], a[160:163], v[16:19]
    v_mfma_f32_16x16x32_bf16 v[20:23], a[180:183], a[160:163], v[20:23]
    v_mfma_f32_16x16x32_bf16 v[24:27], a[184:187], a[160:163], v[24:27]
    v_mfma_f32_16x16x32_bf16 v[28:31], a[188:191], a[160:163], v[28:31]
    v_mfma_f32_16x16x32_bf16 v[32:35], a[192:195], a[160:163], v[32:35]
    v_mfma_f32_16x16x32_bf16 v[56:59], a[52:55], v[112:115], v[56:59]
    v_mfma_f32_16x16x32_bf16 v[60:63], a[56:59], v[112:115], v[60:63]
    ds_write_b128 v13, v[36:39] offset:5120
    v_mfma_f32_16x16x32_bf16 v[64:67], a[60:63], v[112:115], v[64:67]
    v_mfma_f32_16x16x32_bf16 v[68:71], a[64:67], v[112:115], v[68:71]
    v_mfma_f32_16x16x32_bf16 v[72:75], a[68:71], v[112:115], v[72:75]
    buffer_load_dwordx4 v[112:115], v187, s[16:19], s38 offen offset:0 sc1
    ds_write_b128 v13, v[40:43] offset:6144
    v_mfma_f32_16x16x32_bf16 v[56:59], a[72:75], v[116:119], v[56:59]
    v_mfma_f32_16x16x32_bf16 v[60:63], a[76:79], v[116:119], v[60:63]
    v_mfma_f32_16x16x32_bf16 v[64:67], a[80:83], v[116:119], v[64:67]
    ds_write_b128 v13, v[44:47] offset:7168
    v_mfma_f32_16x16x32_bf16 v[68:71], a[84:87], v[116:119], v[68:71]
    v_mfma_f32_16x16x32_bf16 v[72:75], a[88:91], v[116:119], v[72:75]
    buffer_load_dwordx4 v[116:119], v187, s[16:19], s38 offen offset:2048 sc1
    s_waitcnt vmcnt(9)
    v_mfma_f32_16x16x32_bf16 v[56:59], a[92:95], v[120:123], v[56:59]
    ds_write_b128 v13, v[48:51] offset:8192
    v_mfma_f32_16x16x32_bf16 v[60:63], a[96:99], v[120:123], v[60:63]
    v_mfma_f32_16x16x32_bf16 v[64:67], a[100:103], v[120:123], v[64:67]
    v_mfma_f32_16x16x32_bf16 v[68:71], a[104:107], v[120:123], v[68:71]
    ds_write_b128 v13, v[52:55] offset:9216
    v_mfma_f32_16x16x32_bf16 v[72:75], a[108:111], v[120:123], v[72:75]
    buffer_load_dwordx4 v[120:123], v187, s[16:19], s40 offen offset:0 sc1
    s_waitcnt vmcnt(9)
    v_mfma_f32_16x16x32_bf16 v[56:59], a[112:115], v[124:127], v[56:59]
    v_mfma_f32_16x16x32_bf16 v[60:63], a[116:119], v[124:127], v[60:63]
    v_mfma_f32_16x16x32_bf16 v[64:67], a[120:123], v[124:127], v[64:67]
    v_mfma_f32_16x16x32_bf16 v[68:71], a[124:127], v[124:127], v[68:71]
    v_mfma_f32_16x16x32_bf16 v[72:75], a[128:131], v[124:127], v[72:75]
    buffer_load_dwordx4 v[124:127], v187, s[16:19], s40 offen offset:2048 sc1
    s_waitcnt vmcnt(9)
    v_mfma_f32_16x16x32_bf16 v[56:59], a[132:135], v[128:131], v[56:59]
    v_mfma_f32_16x16x32_bf16 v[60:63], a[136:139], v[128:131], v[60:63]
    s_waitcnt lgkmcnt(0)
    s_barrier
    v_mfma_f32_16x16x32_bf16 v[64:67], a[140:143], v[128:131], v[64:67]
    v_mfma_f32_16x16x32_bf16 v[68:71], a[144:147], v[128:131], v[68:71]
    ds_read_b128 v[76:79], v14 offset:5120
    v_mfma_f32_16x16x32_bf16 v[72:75], a[148:151], v[128:131], v[72:75]
    buffer_load_dwordx4 v[128:131], v187, s[16:19], s54 offen offset:0 sc1
    s_waitcnt vmcnt(9)
    v_mfma_f32_16x16x32_bf16 v[56:59], a[240:243], v[132:135], v[56:59]
    v_mfma_f32_16x16x32_bf16 v[60:63], a[244:247], v[132:135], v[60:63]
    ds_write_b128 v13, v[16:19] offset:0
    v_mfma_f32_16x16x32_bf16 v[64:67], a[248:251], v[132:135], v[64:67]
    ds_read_b128 v[80:83], v14 offset:6144
    v_mfma_f32_16x16x32_bf16 v[68:71], a[252:255], v[132:135], v[68:71]
    v_mfma_f32_16x16x32_bf16 v[72:75], a[152:155], v[132:135], v[72:75]
    buffer_load_dwordx4 v[132:135], v187, s[16:19], s54 offen offset:2048 sc1
    s_waitcnt vmcnt(9)
    v_mfma_f32_16x16x32_bf16 v[56:59], a[0:3], v[96:99], v[56:59]
    ds_write_b128 v13, v[20:23] offset:1024
    v_mfma_f32_16x16x32_bf16 v[60:63], a[4:7], v[96:99], v[60:63]
    ds_read_b128 v[84:87], v14 offset:7168
    v_mfma_f32_16x16x32_bf16 v[64:67], a[8:11], v[96:99], v[64:67]
    v_mfma_f32_16x16x32_bf16 v[68:71], a[12:15], v[96:99], v[68:71]
    v_mfma_f32_16x16x32_bf16 v[72:75], a[156:159], v[96:99], v[72:75]
    buffer_load_dwordx4 v[96:99], v187, s[16:19], s56 offen offset:0 sc1
    ds_write_b128 v13, v[24:27] offset:2048
    s_waitcnt vmcnt(9)
    v_mfma_f32_16x16x32_bf16 v[56:59], a[16:19], v[100:103], v[56:59]
    ds_read_b128 v[88:91], v14 offset:8192
    v_mfma_f32_16x16x32_bf16 v[60:63], a[20:23], v[100:103], v[60:63]
    v_mfma_f32_16x16x32_bf16 v[64:67], a[24:27], v[100:103], v[64:67]
    v_mfma_f32_16x16x32_bf16 v[68:71], a[28:31], v[100:103], v[68:71]
    ds_write_b128 v13, v[28:31] offset:3072
    v_mfma_f32_16x16x32_bf16 v[72:75], a[196:199], v[100:103], v[72:75]
    buffer_load_dwordx4 v[100:103], v187, s[16:19], s56 offen offset:2048 sc1
    ds_read_b128 v[92:95], v14 offset:9216
    v_mfma_f32_16x16x32_bf16 v[56:59], a[176:179], a[168:171], v[56:59]
    v_mfma_f32_16x16x32_bf16 v[60:63], a[180:183], a[168:171], v[60:63]
    v_mfma_f32_16x16x32_bf16 v[64:67], a[184:187], a[168:171], v[64:67]
    ds_write_b128 v13, v[32:35] offset:4096
    v_mfma_f32_16x16x32_bf16 v[68:71], a[188:191], a[168:171], v[68:71]
    v_mfma_f32_16x16x32_bf16 v[72:75], a[192:195], a[168:171], v[72:75]
    s_waitcnt vmcnt(9)
    s_waitcnt lgkmcnt(1)
    v_mfma_f32_16x16x32_bf16 v[76:79], v[196:199], v[104:107], v[76:79]
    v_mfma_f32_16x16x32_bf16 v[80:83], v[200:203], v[104:107], v[80:83]
    v_mfma_f32_16x16x32_bf16 v[84:87], v[204:207], v[104:107], v[84:87]
    v_mfma_f32_16x16x32_bf16 v[88:91], v[208:211], v[104:107], v[88:91]
    v_mfma_f32_16x16x32_bf16 v[92:95], v[212:215], v[104:107], v[92:95]
    buffer_load_dwordx4 v[104:107], v187, s[16:19], s59 offen offset:0 sc1
    s_waitcnt vmcnt(9)
    v_mfma_f32_16x16x32_bf16 v[76:79], v[216:219], v[108:111], v[76:79]
    v_mfma_f32_16x16x32_bf16 v[80:83], v[220:223], v[108:111], v[80:83]
    ds_write_b128 v13, v[56:59] offset:10240
    v_mfma_f32_16x16x32_bf16 v[84:87], v[224:227], v[108:111], v[84:87]
    v_mfma_f32_16x16x32_bf16 v[88:91], v[228:231], v[108:111], v[88:91]
    v_mfma_f32_16x16x32_bf16 v[92:95], v[232:235], v[108:111], v[92:95]
    buffer_load_dwordx4 v[108:111], v187, s[16:19], s59 offen offset:2048 sc1
    ds_write_b128 v13, v[60:63] offset:11264
    s_waitcnt vmcnt(9)
    v_mfma_f32_16x16x32_bf16 v[76:79], v[236:239], v[112:115], v[76:79]
    v_mfma_f32_16x16x32_bf16 v[80:83], v[240:243], v[112:115], v[80:83]
    v_mfma_f32_16x16x32_bf16 v[84:87], v[244:247], v[112:115], v[84:87]
    ds_write_b128 v13, v[64:67] offset:12288
    v_mfma_f32_16x16x32_bf16 v[88:91], v[248:251], v[112:115], v[88:91]
    v_mfma_f32_16x16x32_bf16 v[92:95], v[252:255], v[112:115], v[92:95]
    buffer_load_dwordx4 v[112:115], v187, s[16:19], s63 offen offset:0 sc1
    s_waitcnt vmcnt(9)
    v_mfma_f32_16x16x32_bf16 v[76:79], a[200:203], v[116:119], v[76:79]
    ds_write_b128 v13, v[68:71] offset:13312
    v_mfma_f32_16x16x32_bf16 v[80:83], a[204:207], v[116:119], v[80:83]
    v_mfma_f32_16x16x32_bf16 v[84:87], a[208:211], v[116:119], v[84:87]
    v_mfma_f32_16x16x32_bf16 v[88:91], a[212:215], v[116:119], v[88:91]
    ds_write_b128 v13, v[72:75] offset:14336
    v_mfma_f32_16x16x32_bf16 v[92:95], a[216:219], v[116:119], v[92:95]
    buffer_load_dwordx4 v[116:119], v191, s[16:19], s63 offen offset:2048 sc1
    s_waitcnt vmcnt(9)
    v_mfma_f32_16x16x32_bf16 v[76:79], a[220:223], v[120:123], v[76:79]
    v_mfma_f32_16x16x32_bf16 v[80:83], a[224:227], v[120:123], v[80:83]
    v_mfma_f32_16x16x32_bf16 v[84:87], a[228:231], v[120:123], v[84:87]
    v_mfma_f32_16x16x32_bf16 v[88:91], a[232:235], v[120:123], v[88:91]
    v_mfma_f32_16x16x32_bf16 v[92:95], a[236:239], v[120:123], v[92:95]
    s_waitcnt vmcnt(8)
    v_mfma_f32_16x16x32_bf16 v[76:79], a[32:35], v[124:127], v[76:79]
    v_mfma_f32_16x16x32_bf16 v[80:83], a[36:39], v[124:127], v[80:83]
    s_waitcnt lgkmcnt(0)
    s_barrier
    v_mfma_f32_16x16x32_bf16 v[84:87], a[40:43], v[124:127], v[84:87]
    v_mfma_f32_16x16x32_bf16 v[88:91], a[44:47], v[124:127], v[88:91]
    ds_read_b128 v[144:147], v15 offset:10240
    v_mfma_f32_16x16x32_bf16 v[92:95], a[48:51], v[124:127], v[92:95]
    s_waitcnt vmcnt(7)
    v_mfma_f32_16x16x32_bf16 v[76:79], a[52:55], v[128:131], v[76:79]
    ds_read_b128 v[148:151], v15 offset:11264
    v_mfma_f32_16x16x32_bf16 v[80:83], a[56:59], v[128:131], v[80:83]
    v_mfma_f32_16x16x32_bf16 v[84:87], a[60:63], v[128:131], v[84:87]
    ds_read_b128 v[152:155], v15 offset:12288
    v_mfma_f32_16x16x32_bf16 v[88:91], a[64:67], v[128:131], v[88:91]
    v_mfma_f32_16x16x32_bf16 v[92:95], a[68:71], v[128:131], v[92:95]
    ds_read_b128 v[156:159], v15 offset:13312
    s_waitcnt vmcnt(6)
    v_mfma_f32_16x16x32_bf16 v[76:79], a[72:75], v[132:135], v[76:79]
    v_mfma_f32_16x16x32_bf16 v[80:83], a[76:79], v[132:135], v[80:83]
    ds_read_b128 v[160:163], v15 offset:14336
    v_mfma_f32_16x16x32_bf16 v[84:87], a[80:83], v[132:135], v[84:87]
    v_mfma_f32_16x16x32_bf16 v[88:91], a[84:87], v[132:135], v[88:91]
    ds_read_b128 v[164:167], v0 offset:0
    v_mfma_f32_16x16x32_bf16 v[92:95], a[88:91], v[132:135], v[92:95]
    s_waitcnt vmcnt(5)
    v_mfma_f32_16x16x32_bf16 v[76:79], a[92:95], v[96:99], v[76:79]
    ds_read_b128 v[168:171], v0 offset:1024
    v_mfma_f32_16x16x32_bf16 v[80:83], a[96:99], v[96:99], v[80:83]
    v_mfma_f32_16x16x32_bf16 v[84:87], a[100:103], v[96:99], v[84:87]
    ds_read_b128 v[172:175], v0 offset:2048
    v_mfma_f32_16x16x32_bf16 v[88:91], a[104:107], v[96:99], v[88:91]
    v_mfma_f32_16x16x32_bf16 v[92:95], a[108:111], v[96:99], v[92:95]
    ds_read_b128 v[176:179], v0 offset:3072
    s_waitcnt vmcnt(4)
    v_mfma_f32_16x16x32_bf16 v[76:79], a[112:115], v[100:103], v[76:79]
    v_mfma_f32_16x16x32_bf16 v[80:83], a[116:119], v[100:103], v[80:83]
    ds_read_b128 v[180:183], v0 offset:4096
    v_mfma_f32_16x16x32_bf16 v[84:87], a[120:123], v[100:103], v[84:87]
    v_mfma_f32_16x16x32_bf16 v[88:91], a[124:127], v[100:103], v[88:91]
    v_mfma_f32_16x16x32_bf16 v[92:95], a[128:131], v[100:103], v[92:95]
    s_waitcnt vmcnt(3)
    v_mfma_f32_16x16x32_bf16 v[76:79], a[132:135], v[104:107], v[76:79]
    s_waitcnt lgkmcnt(0)
    v_mfma_f32_16x16x32_bf16 v[80:83], a[136:139], v[104:107], v[80:83]
    v_add_f32 v144, v144, v164
    v_mfma_f32_16x16x32_bf16 v[84:87], a[140:143], v[104:107], v[84:87]
    v_add_f32 v145, v145, v165
    v_mfma_f32_16x16x32_bf16 v[88:91], a[144:147], v[104:107], v[88:91]
    v_add_f32 v146, v146, v166
    v_mfma_f32_16x16x32_bf16 v[92:95], a[148:151], v[104:107], v[92:95]
    v_add_f32 v147, v147, v167
    s_waitcnt vmcnt(2)
    v_mfma_f32_16x16x32_bf16 v[76:79], a[240:243], v[108:111], v[76:79]
    v_add_f32 v148, v148, v168
    v_mfma_f32_16x16x32_bf16 v[80:83], a[244:247], v[108:111], v[80:83]
    v_add_f32 v149, v149, v169
    v_mfma_f32_16x16x32_bf16 v[84:87], a[248:251], v[108:111], v[84:87]
    v_mfma_f32_16x16x32_bf16 v[88:91], a[252:255], v[108:111], v[88:91]
    v_add_f32 v150, v150, v170
    v_mfma_f32_16x16x32_bf16 v[92:95], a[152:155], v[108:111], v[92:95]
    v_add_f32 v151, v151, v171
    s_waitcnt vmcnt(1)
    v_mfma_f32_16x16x32_bf16 v[76:79], a[0:3], v[112:115], v[76:79]
    v_add_f32 v152, v152, v172
    v_mfma_f32_16x16x32_bf16 v[80:83], a[4:7], v[112:115], v[80:83]
    v_add_f32 v153, v153, v173
    v_mfma_f32_16x16x32_bf16 v[84:87], a[8:11], v[112:115], v[84:87]
    v_add_f32 v154, v154, v174
    v_mfma_f32_16x16x32_bf16 v[88:91], a[12:15], v[112:115], v[88:91]
    v_add_f32 v155, v155, v175
    v_mfma_f32_16x16x32_bf16 v[92:95], a[156:159], v[112:115], v[92:95]
    v_add_f32 v156, v156, v176
    s_waitcnt vmcnt(0)
    v_mfma_f32_16x16x32_bf16 v[76:79], a[16:19], v[116:119], v[76:79]
    v_mfma_f32_16x16x32_bf16 v[80:83], a[20:23], v[116:119], v[80:83]
    v_add_f32 v157, v157, v177
    v_mfma_f32_16x16x32_bf16 v[84:87], a[24:27], v[116:119], v[84:87]
    v_add_f32 v158, v158, v178
    v_mfma_f32_16x16x32_bf16 v[88:91], a[28:31], v[116:119], v[88:91]
    v_add_f32 v159, v159, v179
    v_mfma_f32_16x16x32_bf16 v[92:95], a[196:199], v[116:119], v[92:95]
    v_add_f32 v160, v160, v180
    v_mfma_f32_16x16x32_bf16 v[76:79], a[176:179], a[172:175], v[76:79]
    v_add_f32 v161, v161, v181
    v_mfma_f32_16x16x32_bf16 v[80:83], a[180:183], a[172:175], v[80:83]
    v_add_f32 v162, v162, v182
    v_mfma_f32_16x16x32_bf16 v[84:87], a[184:187], a[172:175], v[84:87]
    v_add_f32 v163, v163, v183
    v_mfma_f32_16x16x32_bf16 v[88:91], a[188:191], a[172:175], v[88:91]
    v_mfma_f32_16x16x32_bf16 v[92:95], a[192:195], a[172:175], v[92:95]
    s_nop 0
    v_add_f32 v76, v76, v144
    v_add_f32 v77, v77, v145
    v_add_f32 v78, v78, v146
    v_add_f32 v79, v79, v147
    v_cvt_pk_bf16_f32 v96, v76, v77
    v_cvt_pk_bf16_f32 v97, v78, v79
    v_add_f32 v80, v80, v148
    v_add_f32 v81, v81, v149
    v_add_f32 v82, v82, v150
    v_add_f32 v83, v83, v151
    v_cvt_pk_bf16_f32 v98, v80, v81
    v_cvt_pk_bf16_f32 v99, v82, v83
    buffer_store_dwordx4 v[96:99], v10, s[20:23], s82 offen
    v_add_f32 v84, v84, v152
    v_add_f32 v85, v85, v153
    v_add_f32 v86, v86, v154
    v_add_f32 v87, v87, v155
    v_cvt_pk_bf16_f32 v100, v84, v85
    v_cvt_pk_bf16_f32 v101, v86, v87
    v_add_f32 v88, v88, v156
    v_add_f32 v89, v89, v157
    v_add_f32 v90, v90, v158
    v_add_f32 v91, v91, v159
    v_cvt_pk_bf16_f32 v102, v88, v89
    v_cvt_pk_bf16_f32 v103, v90, v91
    buffer_store_dwordx4 v[100:103], v10, s[20:23], s82 offen offset:64
    v_add_f32 v92, v92, v160
    v_add_f32 v93, v93, v161
    v_add_f32 v94, v94, v162
    v_add_f32 v95, v95, v163
    v_cvt_pk_bf16_f32 v104, v92, v93
    v_cvt_pk_bf16_f32 v105, v94, v95
    buffer_store_dwordx2 v[104:105], v11, s[20:23], s82 offen offset:128
    s_endpgm
L_end:
    s_endpgm
.p2align 8
.type L_ftab,@object
L_ftab:
.long 0x3f803f80, 0x3f803f80, 0x3f803f80, 0x3f803f80, 0x3f7b3f80, 0x3f553f6d, 0xbe480000, 0xbf0ebec4
.long 0x3f6d3f80, 0x3ec43f35, 0xbf6dbf80, 0xbec4bf35, 0x3f553f80, 0xbe483ec4, 0x3f0e8000, 0x3f7b3f6d
.long 0x3f353f80, 0xbf350000, 0x3f353f80, 0xbf350000, 0x3f0e3f80, 0xbf7bbec4, 0xbf550000, 0xbe48bf6d
.long 0x3ec43f80, 0xbf6dbf35, 0xbec4bf80, 0x3f6d3f35, 0x3e483f80, 0xbf0ebf6d, 0x3f7b8000, 0xbf553ec4
.long 0x00003f80, 0x8000bf80, 0x00003f80, 0x8000bf80, 0xbe483f80, 0x3f0ebf6d, 0xbf7b0000, 0x3f553ec4
.long 0xbec43f80, 0x3f6dbf35, 0x3ec4bf80, 0xbf6d3f35, 0xbf0e3f80, 0x3f7bbec4, 0x3f558000, 0x3e48bf6d
.long 0xbf353f80, 0x3f358000, 0xbf353f80, 0x3f358000, 0xbf553f80, 0x3e483ec4, 0xbf0e0000, 0xbf7b3f6d
.long 0xbf6d3f80, 0xbec43f35, 0x3f6dbf80, 0x3ec4bf35, 0xbf7b3f80, 0xbf553f6d, 0x3e488000, 0x3f0ebec4
.long 0xbf803f80, 0xbf803f80, 0xbf803f80, 0xbf803f80, 0xbf7b3f80, 0xbf553f6d, 0x3e480000, 0x3f0ebec4
.long 0xbf6d3f80, 0xbec43f35, 0x3f6dbf80, 0x3ec4bf35, 0xbf553f80, 0x3e483ec4, 0xbf0e8000, 0xbf7b3f6d
.long 0xbf353f80, 0x3f350000, 0xbf353f80, 0x3f350000, 0xbf0e3f80, 0x3f7bbec4, 0x3f550000, 0x3e48bf6d
.long 0xbec43f80, 0x3f6dbf35, 0x3ec4bf80, 0xbf6d3f35, 0xbe483f80, 0x3f0ebf6d, 0xbf7b8000, 0x3f553ec4
.long 0x80003f80, 0x0000bf80, 0x80003f80, 0x0000bf80, 0x3e483f80, 0xbf0ebf6d, 0x3f7b0000, 0xbf553ec4
.long 0x3ec43f80, 0xbf6dbf35, 0xbec4bf80, 0x3f6d3f35, 0x3f0e3f80, 0xbf7bbec4, 0xbf558000, 0xbe48bf6d
.long 0x3f353f80, 0xbf358000, 0x3f353f80, 0xbf358000, 0x3f553f80, 0xbe483ec4, 0x3f0e0000, 0x3f7b3f6d
.long 0x3f6d3f80, 0x3ec43f35, 0xbf6dbf80, 0xbec4bf35, 0x3f7b3f80, 0x3f553f6d, 0xbe488000, 0xbf0ebec4
.long 0x3f803f80, 0x3f803f80, 0x3f803f80, 0x3f803f80, 0x3f0e3f35, 0x3e483ec4, 0xbf55bf35, 0xbf7bbf6d
.long 0xbec40000, 0xbf6dbf35, 0x3ec48000, 0x3f6d3f35, 0xbf7bbf35, 0xbf0ebf6d, 0x3e483f35, 0xbf55bec4
.long 0xbf35bf80, 0x3f358000, 0xbf35bf80, 0x3f358000, 0x3e48bf35, 0x3f553f6d, 0x3f7b3f35, 0xbf0e3ec4
.long 0x3f6d8000, 0xbec43f35, 0xbf6d0000, 0x3ec4bf35, 0x3f553f35, 0xbf7bbec4, 0x3f0ebf35, 0xbe483f6d
.long 0x00003f80, 0x8000bf80, 0x00003f80, 0x8000bf80, 0xbf553f35, 0x3f7bbec4, 0xbf0ebf35, 0x3e483f6d
.long 0xbf6d0000, 0x3ec43f35, 0x3f6d8000, 0xbec4bf35, 0xbe48bf35, 0xbf553f6d, 0xbf7b3f35, 0x3f0e3ec4
.long 0x3f35bf80, 0xbf350000, 0x3f35bf80, 0xbf350000, 0x3f7bbf35, 0x3f0ebf6d, 0xbe483f35, 0x3f55bec4
.long 0x3ec48000, 0x3f6dbf35, 0xbec40000, 0xbf6d3f35, 0xbf0e3f35, 0xbe483ec4, 0x3f55bf35, 0x3f7bbf6d
.long 0xbf803f80, 0xbf803f80, 0xbf803f80, 0xbf803f80, 0xbf0e3f35, 0xbe483ec4, 0x3f55bf35, 0x3f7bbf6d
.long 0x3ec40000, 0x3f6dbf35, 0xbec48000, 0xbf6d3f35, 0x3f7bbf35, 0x3f0ebf6d, 0xbe483f35, 0x3f55bec4
.long 0x3f35bf80, 0xbf358000, 0x3f35bf80, 0xbf358000, 0xbe48bf35, 0xbf553f6d, 0xbf7b3f35, 0x3f0e3ec4
.long 0xbf6d8000, 0x3ec43f35, 0x3f6d0000, 0xbec4bf35, 0xbf553f35, 0x3f7bbec4, 0xbf0ebf35, 0x3e483f6d
.long 0x80003f80, 0x0000bf80, 0x80003f80, 0x0000bf80, 0x3f553f35, 0xbf7bbec4, 0x3f0ebf35, 0xbe483f6d
.long 0x3f6d0000, 0xbec43f35, 0xbf6d8000, 0x3ec4bf35, 0x3e48bf35, 0x3f553f6d, 0x3f7b3f35, 0xbf0e3ec4
.long 0xbf35bf80, 0x3f350000, 0xbf35bf80, 0x3f350000, 0xbf7bbf35, 0xbf0ebf6d, 0x3e483f35, 0xbf55bec4
.long 0xbec48000, 0xbf6dbf35, 0x3ec40000, 0x3f6d3f35, 0x3f0e3f35, 0x3e483ec4, 0xbf55bf35, 0xbf7bbf6d
.long 0x3f803f80, 0x3f803f80, 0x3f803f80, 0x3f803f80, 0xbf7bbf80, 0xbf55bf6d, 0x3e488000, 0x3f0e3ec4
.long 0x3f6d3f80, 0x3ec43f35, 0xbf6dbf80, 0xbec4bf35, 0xbf55bf80, 0x3e48bec4, 0xbf0e0000, 0xbf7bbf6d
.long 0x3f353f80, 0xbf350000, 0x3f353f80, 0xbf350000, 0xbf0ebf80, 0x3f7b3ec4, 0x3f558000, 0x3e483f6d
.long 0x3ec43f80, 0xbf6dbf35, 0xbec4bf80, 0x3f6d3f35, 0xbe48bf80, 0x3f0e3f6d, 0xbf7b0000, 0x3f55bec4
.long 0x00003f80, 0x8000bf80, 0x00003f80, 0x8000bf80, 0x3e48bf80, 0xbf0e3f6d, 0x3f7b8000, 0xbf55bec4
.long 0xbec43f80, 0x3f6dbf35, 0x3ec4bf80, 0xbf6d3f35, 0x3f0ebf80, 0xbf7b3ec4, 0xbf550000, 0xbe483f6d
.long 0xbf353f80, 0x3f358000, 0xbf353f80, 0x3f358000, 0x3f55bf80, 0xbe48bec4, 0x3f0e8000, 0x3f7bbf6d
.long 0xbf6d3f80, 0xbec43f35, 0x3f6dbf80, 0x3ec4bf35, 0x3f7bbf80, 0x3f55bf6d, 0xbe480000, 0xbf0e3ec4
.long 0xbf803f80, 0xbf803f80, 0xbf803f80, 0xbf803f80, 0x3f7bbf80, 0x3f55bf6d, 0xbe488000, 0xbf0e3ec4
.long 0xbf6d3f80, 0xbec43f35, 0x3f6dbf80, 0x3ec4bf35, 0x3f55bf80, 0xbe48bec4, 0x3f0e0000, 0x3f7bbf6d
.long 0xbf353f80, 0x3f350000, 0xbf353f80, 0x3f350000, 0x3f0ebf80, 0xbf7b3ec4, 0xbf558000, 0xbe483f6d
.long 0xbec43f80, 0x3f6dbf35, 0x3ec4bf80, 0xbf6d3f35, 0x3e48bf80, 0xbf0e3f6d, 0x3f7b0000, 0xbf55bec4
.long 0x80003f80, 0x0000bf80, 0x80003f80, 0x0000bf80, 0xbe48bf80, 0x3f0e3f6d, 0xbf7b8000, 0x3f55bec4
.long 0x3ec43f80, 0xbf6dbf35, 0xbec4bf80, 0x3f6d3f35, 0xbf0ebf80, 0x3f7b3ec4, 0x3f550000, 0x3e483f6d
.long 0x3f353f80, 0xbf358000, 0x3f353f80, 0xbf358000, 0xbf55bf80, 0x3e48bec4, 0xbf0e8000, 0xbf7bbf6d
.long 0x3f6d3f80, 0x3ec43f35, 0xbf6dbf80, 0xbec4bf35, 0xbf7bbf80, 0xbf55bf6d, 0x3e480000, 0x3f0e3ec4
.long 0x3f803f80, 0x3f803f80, 0x3f803f80, 0x3f803f80, 0xbf0ebf35, 0xbe48bec4, 0x3f553f35, 0x3f7b3f6d
.long 0xbec40000, 0xbf6dbf35, 0x3ec48000, 0x3f6d3f35, 0x3f7b3f35, 0x3f0e3f6d, 0xbe48bf35, 0x3f553ec4
.long 0xbf35bf80, 0x3f358000, 0xbf35bf80, 0x3f358000, 0xbe483f35, 0xbf55bf6d, 0xbf7bbf35, 0x3f0ebec4
.long 0x3f6d8000, 0xbec43f35, 0xbf6d0000, 0x3ec4bf35, 0xbf55bf35, 0x3f7b3ec4, 0xbf0e3f35, 0x3e48bf6d
.long 0x00003f80, 0x8000bf80, 0x00003f80, 0x8000bf80, 0x3f55bf35, 0xbf7b3ec4, 0x3f0e3f35, 0xbe48bf6d
.long 0xbf6d0000, 0x3ec43f35, 0x3f6d8000, 0xbec4bf35, 0x3e483f35, 0x3f55bf6d, 0x3f7bbf35, 0xbf0ebec4
.long 0x3f35bf80, 0xbf350000, 0x3f35bf80, 0xbf350000, 0xbf7b3f35, 0xbf0e3f6d, 0x3e48bf35, 0xbf553ec4
.long 0x3ec48000, 0x3f6dbf35, 0xbec40000, 0xbf6d3f35, 0x3f0ebf35, 0x3e48bec4, 0xbf553f35, 0xbf7b3f6d
.long 0xbf803f80, 0xbf803f80, 0xbf803f80, 0xbf803f80, 0x3f0ebf35, 0x3e48bec4, 0xbf553f35, 0xbf7b3f6d
.long 0x3ec40000, 0x3f6dbf35, 0xbec48000, 0xbf6d3f35, 0xbf7b3f35, 0xbf0e3f6d, 0x3e48bf35, 0xbf553ec4
.long 0x3f35bf80, 0xbf358000, 0x3f35bf80, 0xbf358000, 0x3e483f35, 0x3f55bf6d, 0x3f7bbf35, 0xbf0ebec4
.long 0xbf6d8000, 0x3ec43f35, 0x3f6d0000, 0xbec4bf35, 0x3f55bf35, 0xbf7b3ec4, 0x3f0e3f35, 0xbe48bf6d
.long 0x80003f80, 0x0000bf80, 0x80003f80, 0x0000bf80, 0xbf55bf35, 0x3f7b3ec4, 0xbf0e3f35, 0x3e48bf6d
.long 0x3f6d0000, 0xbec43f35, 0xbf6d8000, 0x3ec4bf35, 0xbe483f35, 0xbf55bf6d, 0xbf7bbf35, 0x3f0ebec4
.long 0xbf35bf80, 0x3f350000, 0xbf35bf80, 0x3f350000, 0x3f7b3f35, 0x3f0e3f6d, 0xbe48bf35, 0x3f553ec4
.long 0xbec48000, 0xbf6dbf35, 0x3ec40000, 0x3f6d3f35, 0xbf0ebf35, 0xbe48bec4, 0x3f553f35, 0x3f7b3f6d
.long 0x00000000, 0x00000000, 0x00000000, 0x00000000, 0x3e480000, 0x3f0e3ec4, 0x3f7b3f80, 0x3f553f6d
.long 0x3ec40000, 0x3f6d3f35, 0xbec40000, 0xbf6dbf35, 0x3f0e0000, 0x3f7b3f6d, 0xbf55bf80, 0x3e48bec4
.long 0x3f350000, 0x3f353f80, 0x3f350000, 0x3f353f80, 0x3f550000, 0x3e483f6d, 0x3f0e3f80, 0xbf7bbec4
.long 0x3f6d0000, 0xbec43f35, 0xbf6d0000, 0x3ec4bf35, 0x3f7b0000, 0xbf553ec4, 0xbe48bf80, 0x3f0e3f6d
.long 0x3f800000, 0xbf800000, 0x3f800000, 0xbf800000, 0x3f7b0000, 0xbf55bec4, 0xbe483f80, 0x3f0ebf6d
.long 0x3f6d0000, 0xbec4bf35, 0xbf6d0000, 0x3ec43f35, 0x3f550000, 0x3e48bf6d, 0x3f0ebf80, 0xbf7b3ec4
.long 0x3f350000, 0x3f35bf80, 0x3f350000, 0x3f35bf80, 0x3f0e0000, 0x3f7bbf6d, 0xbf553f80, 0x3e483ec4
.long 0x3ec40000, 0x3f6dbf35, 0xbec40000, 0xbf6d3f35, 0x3e480000, 0x3f0ebec4, 0x3f7bbf80, 0x3f55bf6d
.long 0x00000000, 0x00000000, 0x00000000, 0x00000000, 0xbe480000, 0xbf0e3ec4, 0xbf7b3f80, 0xbf553f6d
.long 0xbec40000, 0xbf6d3f35, 0x3ec40000, 0x3f6dbf35, 0xbf0e0000, 0xbf7b3f6d, 0x3f55bf80, 0xbe48bec4
.long 0xbf350000, 0xbf353f80, 0xbf350000, 0xbf353f80, 0xbf550000, 0xbe483f6d, 0xbf0e3f80, 0x3f7bbec4
.long 0xbf6d0000, 0x3ec43f35, 0x3f6d0000, 0xbec4bf35, 0xbf7b0000, 0x3f553ec4, 0x3e48bf80, 0xbf0e3f6d
.long 0xbf800000, 0x3f800000, 0xbf800000, 0x3f800000, 0xbf7b0000, 0x3f55bec4, 0x3e483f80, 0xbf0ebf6d
.long 0xbf6d0000, 0x3ec4bf35, 0x3f6d0000, 0xbec43f35, 0xbf550000, 0xbe48bf6d, 0xbf0ebf80, 0x3f7b3ec4
.long 0xbf350000, 0xbf35bf80, 0xbf350000, 0xbf35bf80, 0xbf0e0000, 0xbf7bbf6d, 0x3f553f80, 0xbe483ec4
.long 0xbec40000, 0xbf6dbf35, 0x3ec40000, 0x3f6d3f35, 0xbe480000, 0xbf0ebec4, 0xbf7bbf80, 0xbf55bf6d
.long 0x00000000, 0x00000000, 0x00000000, 0x00000000, 0x3f553f35, 0x3f7b3f6d, 0x3f0e3f35, 0x3e483ec4
.long 0x3f6d3f80, 0x3ec43f35, 0xbf6dbf80, 0xbec4bf35, 0x3e483f35, 0xbf55bec4, 0x3f7b3f35, 0x3f0e3f6d
.long 0xbf350000, 0xbf35bf80, 0xbf350000, 0xbf35bf80, 0xbf7bbf35, 0x3f0ebec4, 0x3e48bf35, 0x3f553f6d
.long 0xbec4bf80, 0x3f6d3f35, 0x3ec43f80, 0xbf6dbf35, 0x3f0ebf35, 0xbe483f6d, 0xbf55bf35, 0x3f7b3ec4
.long 0x3f800000, 0xbf800000, 0x3f800000, 0xbf800000, 0x3f0e3f35, 0xbe48bf6d, 0xbf553f35, 0x3f7bbec4
.long 0xbec43f80, 0x3f6dbf35, 0x3ec4bf80, 0xbf6d3f35, 0xbf7b3f35, 0x3f0e3ec4, 0x3e483f35, 0x3f55bf6d
.long 0xbf350000, 0xbf353f80, 0xbf350000, 0xbf353f80, 0x3e48bf35, 0xbf553ec4, 0x3f7bbf35, 0x3f0ebf6d
.long 0x3f6dbf80, 0x3ec4bf35, 0xbf6d3f80, 0xbec43f35, 0x3f55bf35, 0x3f7bbf6d, 0x3f0ebf35, 0x3e48bec4
.long 0x00000000, 0x00000000, 0x00000000, 0x00000000, 0xbf553f35, 0xbf7b3f6d, 0xbf0e3f35, 0xbe483ec4
.long 0xbf6d3f80, 0xbec43f35, 0x3f6dbf80, 0x3ec4bf35, 0xbe483f35, 0x3f55bec4, 0xbf7b3f35, 0xbf0e3f6d
.long 0x3f350000, 0x3f35bf80, 0x3f350000, 0x3f35bf80, 0x3f7bbf35, 0xbf0ebec4, 0xbe48bf35, 0xbf553f6d
.long 0x3ec4bf80, 0xbf6d3f35, 0xbec43f80, 0x3f6dbf35, 0xbf0ebf35, 0x3e483f6d, 0x3f55bf35, 0xbf7b3ec4
.long 0xbf800000, 0x3f800000, 0xbf800000, 0x3f800000, 0xbf0e3f35, 0x3e48bf6d, 0x3f553f35, 0xbf7bbec4
.long 0x3ec43f80, 0xbf6dbf35, 0xbec4bf80, 0x3f6d3f35, 0x3f7b3f35, 0xbf0e3ec4, 0xbe483f35, 0xbf55bf6d
.long 0x3f350000, 0x3f353f80, 0x3f350000, 0x3f353f80, 0xbe48bf35, 0x3f553ec4, 0xbf7bbf35, 0xbf0ebf6d
.long 0xbf6dbf80, 0xbec4bf35, 0x3f6d3f80, 0x3ec43f35, 0xbf55bf35, 0xbf7bbf6d, 0xbf0ebf35, 0xbe48bec4
.long 0x00000000, 0x00000000, 0x00000000, 0x00000000, 0xbe480000, 0xbf0ebec4, 0xbf7bbf80, 0xbf55bf6d
.long 0x3ec40000, 0x3f6d3f35, 0xbec40000, 0xbf6dbf35, 0xbf0e0000, 0xbf7bbf6d, 0x3f553f80, 0xbe483ec4
.long 0x3f350000, 0x3f353f80, 0x3f350000, 0x3f353f80, 0xbf550000, 0xbe48bf6d, 0xbf0ebf80, 0x3f7b3ec4
.long 0x3f6d0000, 0xbec43f35, 0xbf6d0000, 0x3ec4bf35, 0xbf7b0000, 0x3f55bec4, 0x3e483f80, 0xbf0ebf6d
.long 0x3f800000, 0xbf800000, 0x3f800000, 0xbf800000, 0xbf7b0000, 0x3f553ec4, 0x3e48bf80, 0xbf0e3f6d
.long 0x3f6d0000, 0xbec4bf35, 0xbf6d0000, 0x3ec43f35, 0xbf550000, 0xbe483f6d, 0xbf0e3f80, 0x3f7bbec4
.long 0x3f350000, 0x3f35bf80, 0x3f350000, 0x3f35bf80, 0xbf0e0000, 0xbf7b3f6d, 0x3f55bf80, 0xbe48bec4
.long 0x3ec40000, 0x3f6dbf35, 0xbec40000, 0xbf6d3f35, 0xbe480000, 0xbf0e3ec4, 0xbf7b3f80, 0xbf553f6d
.long 0x00000000, 0x00000000, 0x00000000, 0x00000000, 0x3e480000, 0x3f0ebec4, 0x3f7bbf80, 0x3f55bf6d
.long 0xbec40000, 0xbf6d3f35, 0x3ec40000, 0x3f6dbf35, 0x3f0e0000, 0x3f7bbf6d, 0xbf553f80, 0x3e483ec4
.long 0xbf350000, 0xbf353f80, 0xbf350000, 0xbf353f80, 0x3f550000, 0x3e48bf6d, 0x3f0ebf80, 0xbf7b3ec4
.long 0xbf6d0000, 0x3ec43f35, 0x3f6d0000, 0xbec4bf35, 0x3f7b0000, 0xbf55bec4, 0xbe483f80, 0x3f0ebf6d
.long 0xbf800000, 0x3f800000, 0xbf800000, 0x3f800000, 0x3f7b0000, 0xbf553ec4, 0xbe48bf80, 0x3f0e3f6d
.long 0xbf6d0000, 0x3ec4bf35, 0x3f6d0000, 0xbec43f35, 0x3f550000, 0x3e483f6d, 0x3f0e3f80, 0xbf7bbec4
.long 0xbf350000, 0xbf35bf80, 0xbf350000, 0xbf35bf80, 0x3f0e0000, 0x3f7b3f6d, 0xbf55bf80, 0x3e48bec4
.long 0xbec40000, 0xbf6dbf35, 0x3ec40000, 0x3f6d3f35, 0x3e480000, 0x3f0e3ec4, 0x3f7b3f80, 0x3f553f6d
.long 0x00000000, 0x00000000, 0x00000000, 0x00000000, 0xbf55bf35, 0xbf7bbf6d, 0xbf0ebf35, 0xbe48bec4
.long 0x3f6d3f80, 0x3ec43f35, 0xbf6dbf80, 0xbec4bf35, 0xbe48bf35, 0x3f553ec4, 0xbf7bbf35, 0xbf0ebf6d
.long 0xbf350000, 0xbf35bf80, 0xbf350000, 0xbf35bf80, 0x3f7b3f35, 0xbf0e3ec4, 0xbe483f35, 0xbf55bf6d
.long 0xbec4bf80, 0x3f6d3f35, 0x3ec43f80, 0xbf6dbf35, 0xbf0e3f35, 0x3e48bf6d, 0x3f553f35, 0xbf7bbec4
.long 0x3f800000, 0xbf800000, 0x3f800000, 0xbf800000, 0xbf0ebf35, 0x3e483f6d, 0x3f55bf35, 0xbf7b3ec4
.long 0xbec43f80, 0x3f6dbf35, 0x3ec4bf80, 0xbf6d3f35, 0x3f7bbf35, 0xbf0ebec4, 0xbe48bf35, 0xbf553f6d
.long 0xbf350000, 0xbf353f80, 0xbf350000, 0xbf353f80, 0xbe483f35, 0x3f55bec4, 0xbf7b3f35, 0xbf0e3f6d
.long 0x3f6dbf80, 0x3ec4bf35, 0xbf6d3f80, 0xbec43f35, 0xbf553f35, 0xbf7b3f6d, 0xbf0e3f35, 0xbe483ec4
.long 0x00000000, 0x00000000, 0x00000000, 0x00000000, 0x3f55bf35, 0x3f7bbf6d, 0x3f0ebf35, 0x3e48bec4
.long 0xbf6d3f80, 0xbec43f35, 0x3f6dbf80, 0x3ec4bf35, 0x3e48bf35, 0xbf553ec4, 0x3f7bbf35, 0x3f0ebf6d
.long 0x3f350000, 0x3f35bf80, 0x3f350000, 0x3f35bf80, 0xbf7b3f35, 0x3f0e3ec4, 0x3e483f35, 0x3f55bf6d
.long 0x3ec4bf80, 0xbf6d3f35, 0xbec43f80, 0x3f6dbf35, 0x3f0e3f35, 0xbe48bf6d, 0xbf553f35, 0x3f7bbec4
.long 0xbf800000, 0x3f800000, 0xbf800000, 0x3f800000, 0x3f0ebf35, 0xbe483f6d, 0xbf55bf35, 0x3f7b3ec4
.long 0x3ec43f80, 0xbf6dbf35, 0xbec4bf80, 0x3f6d3f35, 0xbf7bbf35, 0x3f0ebec4, 0x3e48bf35, 0x3f553f6d
.long 0x3f350000, 0x3f353f80, 0x3f350000, 0x3f353f80, 0x3e483f35, 0xbf55bec4, 0x3f7b3f35, 0x3f0e3f6d
.long 0xbf6dbf80, 0xbec4bf35, 0x3f6d3f80, 0x3ec43f35, 0x3f553f35, 0x3f7b3f6d, 0x3f0e3f35, 0x3e483ec4
.long 0x80008000, 0x80008000, 0x80008000, 0x80008000, 0xbe488000, 0xbf0ebec4, 0xbf7bbf80, 0xbf55bf6d
.long 0xbec48000, 0xbf6dbf35, 0x3ec48000, 0x3f6d3f35, 0xbf0e8000, 0xbf7bbf6d, 0x3f553f80, 0xbe483ec4
.long 0xbf358000, 0xbf35bf80, 0xbf358000, 0xbf35bf80, 0xbf558000, 0xbe48bf6d, 0xbf0ebf80, 0x3f7b3ec4
.long 0xbf6d8000, 0x3ec4bf35, 0x3f6d8000, 0xbec43f35, 0xbf7b8000, 0x3f55bec4, 0x3e483f80, 0xbf0ebf6d
.long 0xbf808000, 0x3f808000, 0xbf808000, 0x3f808000, 0xbf7b8000, 0x3f553ec4, 0x3e48bf80, 0xbf0e3f6d
.long 0xbf6d8000, 0x3ec43f35, 0x3f6d8000, 0xbec4bf35, 0xbf558000, 0xbe483f6d, 0xbf0e3f80, 0x3f7bbec4
.long 0xbf358000, 0xbf353f80, 0xbf358000, 0xbf353f80, 0xbf0e8000, 0xbf7b3f6d, 0x3f55bf80, 0xbe48bec4
.long 0xbec48000, 0xbf6d3f35, 0x3ec48000, 0x3f6dbf35, 0xbe488000, 0xbf0e3ec4, 0xbf7b3f80, 0xbf553f6d
.long 0x80008000, 0x80008000, 0x80008000, 0x80008000, 0x3e488000, 0x3f0ebec4, 0x3f7bbf80, 0x3f55bf6d
.long 0x3ec48000, 0x3f6dbf35, 0xbec48000, 0xbf6d3f35, 0x3f0e8000, 0x3f7bbf6d, 0xbf553f80, 0x3e483ec4
.long 0x3f358000, 0x3f35bf80, 0x3f358000, 0x3f35bf80, 0x3f558000, 0x3e48bf6d, 0x3f0ebf80, 0xbf7b3ec4
.long 0x3f6d8000, 0xbec4bf35, 0xbf6d8000, 0x3ec43f35, 0x3f7b8000, 0xbf55bec4, 0xbe483f80, 0x3f0ebf6d
.long 0x3f808000, 0xbf808000, 0x3f808000, 0xbf808000, 0x3f7b8000, 0xbf553ec4, 0xbe48bf80, 0x3f0e3f6d
.long 0x3f6d8000, 0xbec43f35, 0xbf6d8000, 0x3ec4bf35, 0x3f558000, 0x3e483f6d, 0x3f0e3f80, 0xbf7bbec4
.long 0x3f358000, 0x3f353f80, 0x3f358000, 0x3f353f80, 0x3f0e8000, 0x3f7b3f6d, 0xbf55bf80, 0x3e48bec4
.long 0x3ec48000, 0x3f6d3f35, 0xbec48000, 0xbf6dbf35, 0x3e488000, 0x3f0e3ec4, 0x3f7b3f80, 0x3f553f6d
.long 0x80008000, 0x80008000, 0x80008000, 0x80008000, 0xbf55bf35, 0xbf7bbf6d, 0xbf0ebf35, 0xbe48bec4
.long 0xbf6dbf80, 0xbec4bf35, 0x3f6d3f80, 0x3ec43f35, 0xbe48bf35, 0x3f553ec4, 0xbf7bbf35, 0xbf0ebf6d
.long 0x3f358000, 0x3f353f80, 0x3f358000, 0x3f353f80, 0x3f7b3f35, 0xbf0e3ec4, 0xbe483f35, 0xbf55bf6d
.long 0x3ec43f80, 0xbf6dbf35, 0xbec4bf80, 0x3f6d3f35, 0xbf0e3f35, 0x3e48bf6d, 0x3f553f35, 0xbf7bbec4
.long 0xbf808000, 0x3f808000, 0xbf808000, 0x3f808000, 0xbf0ebf35, 0x3e483f6d, 0x3f55bf35, 0xbf7b3ec4
.long 0x3ec4bf80, 0xbf6d3f35, 0xbec43f80, 0x3f6dbf35, 0x3f7bbf35, 0xbf0ebec4, 0xbe48bf35, 0xbf553f6d
.long 0x3f358000, 0x3f35bf80, 0x3f358000, 0x3f35bf80, 0xbe483f35, 0x3f55bec4, 0xbf7b3f35, 0xbf0e3f6d
.long 0xbf6d3f80, 0xbec43f35, 0x3f6dbf80, 0x3ec4bf35, 0xbf553f35, 0xbf7b3f6d, 0xbf0e3f35, 0xbe483ec4
.long 0x80008000, 0x80008000, 0x80008000, 0x80008000, 0x3f55bf35, 0x3f7bbf6d, 0x3f0ebf35, 0x3e48bec4
.long 0x3f6dbf80, 0x3ec4bf35, 0xbf6d3f80, 0xbec43f35, 0x3e48bf35, 0xbf553ec4, 0x3f7bbf35, 0x3f0ebf6d
.long 0xbf358000, 0xbf353f80, 0xbf358000, 0xbf353f80, 0xbf7b3f35, 0x3f0e3ec4, 0x3e483f35, 0x3f55bf6d
.long 0xbec43f80, 0x3f6dbf35, 0x3ec4bf80, 0xbf6d3f35, 0x3f0e3f35, 0xbe48bf6d, 0xbf553f35, 0x3f7bbec4
.long 0x3f808000, 0xbf808000, 0x3f808000, 0xbf808000, 0x3f0ebf35, 0xbe483f6d, 0xbf55bf35, 0x3f7b3ec4
.long 0xbec4bf80, 0x3f6d3f35, 0x3ec43f80, 0xbf6dbf35, 0xbf7bbf35, 0x3f0ebec4, 0x3e48bf35, 0x3f553f6d
.long 0xbf358000, 0xbf35bf80, 0xbf358000, 0xbf35bf80, 0x3e483f35, 0xbf55bec4, 0x3f7b3f35, 0x3f0e3f6d
.long 0x3f6d3f80, 0x3ec43f35, 0xbf6dbf80, 0xbec4bf35, 0x3f553f35, 0x3f7b3f6d, 0x3f0e3f35, 0x3e483ec4
.long 0x80008000, 0x80008000, 0x80008000, 0x80008000, 0x3e488000, 0x3f0e3ec4, 0x3f7b3f80, 0x3f553f6d
.long 0xbec48000, 0xbf6dbf35, 0x3ec48000, 0x3f6d3f35, 0x3f0e8000, 0x3f7b3f6d, 0xbf55bf80, 0x3e48bec4
.long 0xbf358000, 0xbf35bf80, 0xbf358000, 0xbf35bf80, 0x3f558000, 0x3e483f6d, 0x3f0e3f80, 0xbf7bbec4
.long 0xbf6d8000, 0x3ec4bf35, 0x3f6d8000, 0xbec43f35, 0x3f7b8000, 0xbf553ec4, 0xbe48bf80, 0x3f0e3f6d
.long 0xbf808000, 0x3f808000, 0xbf808000, 0x3f808000, 0x3f7b8000, 0xbf55bec4, 0xbe483f80, 0x3f0ebf6d
.long 0xbf6d8000, 0x3ec43f35, 0x3f6d8000, 0xbec4bf35, 0x3f558000, 0x3e48bf6d, 0x3f0ebf80, 0xbf7b3ec4
.long 0xbf358000, 0xbf353f80, 0xbf358000, 0xbf353f80, 0x3f0e8000, 0x3f7bbf6d, 0xbf553f80, 0x3e483ec4
.long 0xbec48000, 0xbf6d3f35, 0x3ec48000, 0x3f6dbf35, 0x3e488000, 0x3f0ebec4, 0x3f7bbf80, 0x3f55bf6d
.long 0x80008000, 0x80008000, 0x80008000, 0x80008000, 0xbe488000, 0xbf0e3ec4, 0xbf7b3f80, 0xbf553f6d
.long 0x3ec48000, 0x3f6dbf35, 0xbec48000, 0xbf6d3f35, 0xbf0e8000, 0xbf7b3f6d, 0x3f55bf80, 0xbe48bec4
.long 0x3f358000, 0x3f35bf80, 0x3f358000, 0x3f35bf80, 0xbf558000, 0xbe483f6d, 0xbf0e3f80, 0x3f7bbec4
.long 0x3f6d8000, 0xbec4bf35, 0xbf6d8000, 0x3ec43f35, 0xbf7b8000, 0x3f553ec4, 0x3e48bf80, 0xbf0e3f6d
.long 0x3f808000, 0xbf808000, 0x3f808000, 0xbf808000, 0xbf7b8000, 0x3f55bec4, 0x3e483f80, 0xbf0ebf6d
.long 0x3f6d8000, 0xbec43f35, 0xbf6d8000, 0x3ec4bf35, 0xbf558000, 0xbe48bf6d, 0xbf0ebf80, 0x3f7b3ec4
.long 0x3f358000, 0x3f353f80, 0x3f358000, 0x3f353f80, 0xbf0e8000, 0xbf7bbf6d, 0x3f553f80, 0xbe483ec4
.long 0x3ec48000, 0x3f6d3f35, 0xbec48000, 0xbf6dbf35, 0xbe488000, 0xbf0ebec4, 0xbf7bbf80, 0xbf55bf6d
.long 0x80008000, 0x80008000, 0x80008000, 0x80008000, 0x3f553f35, 0x3f7b3f6d, 0x3f0e3f35, 0x3e483ec4
.long 0xbf6dbf80, 0xbec4bf35, 0x3f6d3f80, 0x3ec43f35, 0x3e483f35, 0xbf55bec4, 0x3f7b3f35, 0x3f0e3f6d
.long 0x3f358000, 0x3f353f80, 0x3f358000, 0x3f353f80, 0xbf7bbf35, 0x3f0ebec4, 0x3e48bf35, 0x3f553f6d
.long 0x3ec43f80, 0xbf6dbf35, 0xbec4bf80, 0x3f6d3f35, 0x3f0ebf35, 0xbe483f6d, 0xbf55bf35, 0x3f7b3ec4
.long 0xbf808000, 0x3f808000, 0xbf808000, 0x3f808000, 0x3f0e3f35, 0xbe48bf6d, 0xbf553f35, 0x3f7bbec4
.long 0x3ec4bf80, 0xbf6d3f35, 0xbec43f80, 0x3f6dbf35, 0xbf7b3f35, 0x3f0e3ec4, 0x3e483f35, 0x3f55bf6d
.long 0x3f358000, 0x3f35bf80, 0x3f358000, 0x3f35bf80, 0x3e48bf35, 0xbf553ec4, 0x3f7bbf35, 0x3f0ebf6d
.long 0xbf6d3f80, 0xbec43f35, 0x3f6dbf80, 0x3ec4bf35, 0x3f55bf35, 0x3f7bbf6d, 0x3f0ebf35, 0x3e48bec4
.long 0x80008000, 0x80008000, 0x80008000, 0x80008000, 0xbf553f35, 0xbf7b3f6d, 0xbf0e3f35, 0xbe483ec4
.long 0x3f6dbf80, 0x3ec4bf35, 0xbf6d3f80, 0xbec43f35, 0xbe483f35, 0x3f55bec4, 0xbf7b3f35, 0xbf0e3f6d
.long 0xbf358000, 0xbf353f80, 0xbf358000, 0xbf353f80, 0x3f7bbf35, 0xbf0ebec4, 0xbe48bf35, 0xbf553f6d
.long 0xbec43f80, 0x3f6dbf35, 0x3ec4bf80, 0xbf6d3f35, 0xbf0ebf35, 0x3e483f6d, 0x3f55bf35, 0xbf7b3ec4
.long 0x3f808000, 0xbf808000, 0x3f808000, 0xbf808000, 0xbf0e3f35, 0x3e48bf6d, 0x3f553f35, 0xbf7bbec4
.long 0xbec4bf80, 0x3f6d3f35, 0x3ec43f80, 0xbf6dbf35, 0x3f7b3f35, 0xbf0e3ec4, 0xbe483f35, 0xbf55bf6d
.long 0xbf358000, 0xbf35bf80, 0xbf358000, 0xbf35bf80, 0xbe48bf35, 0x3f553ec4, 0xbf7bbf35, 0xbf0ebf6d
.long 0x3f6d3f80, 0x3ec43f35, 0xbf6dbf80, 0xbec4bf35, 0xbf55bf35, 0xbf7bbf6d, 0xbf0ebf35, 0xbe48bec4
.fill 8192, 4, 0
.section .rodata,"a"
.p2align 6
.amdhsa_kernel parallel_sum__spectral_fnet__dense_activation_squared_relu__prompt_kernel
  .amdhsa_next_free_vgpr 512
  .amdhsa_next_free_sgpr 102
  .amdhsa_accum_offset 256
  .amdhsa_group_segment_fixed_size 0
  .amdhsa_kernarg_size 104
  .amdhsa_user_sgpr_count 2
  .amdhsa_user_sgpr_kernarg_segment_ptr 1
  .amdhsa_system_sgpr_workgroup_id_x 1
.end_amdhsa_kernel
```
